```python
import torch

def _softmax(x, axis=-1):
    return torch.softmax(x, dim=axis)
def _gelu(x):
    return torch.nn.functional.gelu(x, approximate="tanh")
def _silu(x):
    return torch.nn.functional.silu(x)
def _sigmoid(x):
    return torch.sigmoid(x)
def _layernorm(x, axis=-1, eps=1e-5):
    m = x.mean(dim=axis, keepdim=True)
    v = x.var(dim=axis, keepdim=True, unbiased=False)
    return (x - m) / torch.sqrt(v + eps)
def _scatter_add(tgt, idx, src, axis=0):
    return tgt.clone().index_add_(axis, idx, src)
def _segment_sum(src, seg, n):
    out = torch.zeros((n,) + src.shape[1:], dtype=src.dtype)
    return out.index_add_(0, seg, src)
def _pad(x, pw):
    flat = tuple(v for pair in reversed(pw) for v in pair)
    return torch.nn.functional.pad(x, flat)

kernel_name = 'interleave_layers__grouped_kv_mqa__sliding_block__prompt'

def setup_inputs():

    _w = (lambda a: (lambda t: t.to(torch.bfloat16) if t.is_floating_point() else t)(torch.as_tensor(a)))
    def _A_setup():
        B, S, D, H = 1, 2048, 640, 32
        Dh = D // H
        return {
            "x": _w((lambda *s: torch.randn(*s, dtype=torch.bfloat16) * 0.05)(B, S, D)),
            "wq": _w((lambda *s: torch.randn(*s, dtype=torch.bfloat16) * 0.05)(D, H * Dh)),
            "wk": _w((lambda *s: torch.randn(*s, dtype=torch.bfloat16) * 0.05)(D, Dh)),
            "wv": _w((lambda *s: torch.randn(*s, dtype=torch.bfloat16) * 0.05)(D, Dh)),
            "wo": _w((lambda *s: torch.randn(*s, dtype=torch.bfloat16) * 0.05)(H * Dh, D)),
        }
    _A_in = _A_setup()

    def _B_setup():
        B, S, D = 1, 2048, 640
        return {
            "x": _w((lambda *s: torch.randn(*s, dtype=torch.bfloat16) * 0.05)(B, S, D)),
            "wqkv": _w((lambda *s: torch.randn(*s, dtype=torch.bfloat16) * 0.05)(D, 3 * D)),
            "wo": _w((lambda *s: torch.randn(*s, dtype=torch.bfloat16) * 0.05)(D, D)),
        }
    _B_in = _B_setup()

    return {
        "A_x": _A_in["x"],
        "A_wq": _A_in["wq"],
        "A_wk": _A_in["wk"],
        "A_wv": _A_in["wv"],
        "A_wo": _A_in["wo"],
        "B_x": _B_in["x"],
        "B_wqkv": _B_in["wqkv"],
        "B_wo": _B_in["wo"],
    }

def reference(A_x, A_wq, A_wk, A_wv, A_wo, B_x, B_wqkv, B_wo):
    def _A_ref(x, wq, wk, wv, wo):
        B, S, D = x.shape
        H = 32
        Dh = D // H
        q = (lambda x, *d: x.permute(*d))((x @ wq).reshape(B, S, H, Dh), 0, 2, 1, 3)
        k = x @ wk
        v = x @ wv
        scores = torch.einsum("bhqd,bkd->bhqk", q, k) * (Dh ** -0.5)
        p = _softmax(scores, axis=-1)
        o = torch.einsum("bhqk,bkd->bhqd", p, v)
        return (lambda x, *d: x.permute(*d))(o, 0, 2, 1, 3).reshape(B, S, H * Dh) @ wo

    def _B_ref(x, wqkv, wo):
        B, S, D = x.shape
        H = 32; Dh = D // H; W = 256
        qkv = (lambda x, *d: x.permute(*d))((x @ wqkv).reshape(B, S, 3, H, Dh), 2, 0, 3, 1, 4)
        q, k, v = qkv[0], qkv[1], qkv[2]
        scores = torch.einsum("bhqd,bhkd->bhqk", q, k) * (Dh ** -0.5)
        idx = torch.arange(S)
        mask = (idx[:, None] - idx[None, :] >= 0) & (idx[:, None] - idx[None, :] < W)
        scores = torch.where(mask[None, None], scores, -1e9)
        p = _softmax(scores, axis=-1)
        o = torch.einsum("bhqk,bhkd->bhqd", p, v)
        return (lambda x, *d: x.permute(*d))(o, 0, 2, 1, 3).reshape(B, S, D) @ wo

    x = A_x
    x = x + _A_ref(_layernorm(x, axis=-1), A_wq, A_wk, A_wv, A_wo)
    x = x + _B_ref(_layernorm(x, axis=-1), B_wqkv, B_wo)
    x = x + _A_ref(_layernorm(x, axis=-1), A_wq, A_wk, A_wv, A_wo)
    x = x + _B_ref(_layernorm(x, axis=-1), B_wqkv, B_wo)
    return x
```

```asm
; @launch kernel=il_qkvA0_kernel grid=(176,1,1) block=(256,1,1) lds=50176
; @launch kernel=il_attnA_kernel grid=(256,1,1) block=(512,1,1) lds=65536
; @launch kernel=il_opA0_kernel grid=(160,1,1) block=(256,1,1) lds=50176
; @launch kernel=il_qkvB0_kernel grid=(240,1,1) block=(256,1,1) lds=67584
; @launch kernel=il_attnB_kernel grid=(512,1,1) block=(256,1,1) lds=81920
; @launch kernel=il_opB0_kernel grid=(160,1,1) block=(256,1,1) lds=50176
; @launch kernel=il_qkvA1_kernel grid=(176,1,1) block=(256,1,1) lds=50176
; @launch kernel=il_attnA_kernel grid=(256,1,1) block=(512,1,1) lds=65536
; @launch kernel=il_opA1_kernel grid=(160,1,1) block=(256,1,1) lds=50176
; @launch kernel=il_qkvB1_kernel grid=(240,1,1) block=(256,1,1) lds=67584
; @launch kernel=il_attnB_kernel grid=(512,1,1) block=(256,1,1) lds=81920
; @launch kernel=il_opB1_kernel grid=(160,1,1) block=(256,1,1) lds=50176
.amdgcn_target "amdgcn-amd-amdhsa--gfx950"
.text
.globl il_qkvA0_kernel
.p2align 8
.type il_qkvA0_kernel,@function
il_qkvA0_kernel:
    s_cmp_ge_u32 s2, 176
    s_cbranch_scc1 il_qkvA0_kernel_done
    s_load_dwordx2 s[4:5], s[0:1], 80
    s_load_dwordx2 s[6:7], s[0:1], 0
    s_load_dwordx2 s[12:13], s[0:1], 8
    s_load_dwordx2 s[40:41], s[0:1], 16
    s_load_dwordx2 s[16:17], s[0:1], 24
    s_and_b32 s34, s2, 15
    s_lshr_b32 s35, s2, 4
    s_mov_b32 s37, s35
    s_mul_i32 s34, s34, 128
    s_mul_i32 s35, s35, 64
    v_and_b32 v1, 63, v0
    v_lshrrev_b32 v2, 6, v0
    v_lshrrev_b32 v3, 5, v1
    s_waitcnt lgkmcnt(0)
    s_mov_b32 s8, s6
    s_mov_b32 s9, s7
    s_mov_b32 s10, 2621440
    s_mov_b32 s11, 0x00020000
    s_mov_b32 s14, 819200
    s_mov_b32 s15, 0x00020000
    s_mov_b32 s18, 25600
    s_mov_b32 s19, 0x00020000
    s_cmp_lg_u32 s37, 10
    s_cbranch_scc1 il_qkvA0_kernel_notkv
    s_mov_b32 s12, s40
    s_mov_b32 s13, s41
    s_mov_b32 s14, 25600
il_qkvA0_kernel_notkv:
    s_add_u32 s20, s4, 7864320
    s_addc_u32 s21, s5, 0
    s_mov_b32 s22, 2621440
    s_mov_b32 s23, 0x00020000
    s_add_u32 s24, s4, 13107200
    s_addc_u32 s25, s5, 0
    s_mov_b32 s26, 4194304
    s_mov_b32 s27, 0x00020000
    s_add_u32 s28, s4, 17301504
    s_addc_u32 s29, s5, 0
    s_mov_b32 s30, 4194304
    s_mov_b32 s31, 0x00020000
    s_mov_b32 s36, 0x3f803f80
    v_lshrrev_b32 v17, 3, v1
    v_mul_u32_u24 v18, 32, v2
    v_add_u32 v18, v18, v17
    v_and_b32 v19, 7, v1
    v_lshrrev_b32 v16, 1, v17
    v_xor_b32 v16, v16, v19
    v_lshlrev_b32 v16, 4, v16
    v_add_u32 v4, s34, v18
    v_add_u32 v4, 0, v4
    s_mov_b32 s3, 1280
    v_mul_lo_u32 v4, v4, s3
    v_add_u32 v4, v4, v16
    v_lshrrev_b32 v16, 1, v17
    v_xor_b32 v16, 4, v16
    v_xor_b32 v16, v16, v19
    v_lshlrev_b32 v16, 4, v16
    v_add_u32 v5, s34, v18
    v_add_u32 v5, 8, v5
    s_mov_b32 s3, 1280
    v_mul_lo_u32 v5, v5, s3
    v_add_u32 v5, v5, v16
    v_lshrrev_b32 v16, 1, v17
    v_xor_b32 v16, v16, v19
    v_lshlrev_b32 v16, 4, v16
    v_add_u32 v6, s34, v18
    v_add_u32 v6, 16, v6
    s_mov_b32 s3, 1280
    v_mul_lo_u32 v6, v6, s3
    v_add_u32 v6, v6, v16
    v_lshrrev_b32 v16, 1, v17
    v_xor_b32 v16, 4, v16
    v_xor_b32 v16, v16, v19
    v_lshlrev_b32 v16, 4, v16
    v_add_u32 v7, s34, v18
    v_add_u32 v7, 24, v7
    s_mov_b32 s3, 1280
    v_mul_lo_u32 v7, v7, s3
    v_add_u32 v7, v7, v16
    v_lshrrev_b32 v16, 2, v1
    v_lshl_add_u32 v16, v2, 4, v16
    v_and_b32 v17, 3, v1
    v_lshlrev_b32 v17, 4, v17
    s_mov_b32 s38, 1280
    s_cmp_lg_u32 s37, 10
    s_cselect_b32 s38, s38, 40
    s_cselect_b32 s39, s35, 0
    v_mul_lo_u32 v16, v16, s38
    v_add_u32 v16, v16, v17
    s_lshl_b32 s3, s39, 1
    v_add_u32 v8, s3, v16
    s_cmp_lg_u32 s37, 10
    s_cselect_b32 s3, 64, 0
    v_add_u32 v9, s3, v8
    v_and_b32 v16, 31, v1
    v_and_b32 v17, 1, v2
    v_mul_u32_u24 v17, 64, v17
    v_add_u32 v17, v17, v16
    v_lshrrev_b32 v16, 1, v16
    v_and_b32 v16, 7, v16
    v_lshlrev_b32 v17, 7, v17
    v_add_u32 v18, 0, v3
    v_xor_b32 v18, v18, v16
    v_lshl_add_u32 v12, v18, 4, v17
    v_add_u32 v18, 2, v3
    v_xor_b32 v18, v18, v16
    v_lshl_add_u32 v13, v18, 4, v17
    v_add_u32 v18, 4, v3
    v_xor_b32 v18, v18, v16
    v_lshl_add_u32 v14, v18, 4, v17
    v_add_u32 v18, 6, v3
    v_xor_b32 v18, v18, v16
    v_lshl_add_u32 v15, v18, 4, v17
    v_lshrrev_b32 v17, 4, v1
    v_and_b32 v17, 1, v17
    v_lshlrev_b32 v17, 5, v17
    v_and_b32 v18, 15, v1
    v_lshrrev_b32 v18, 2, v18
    v_lshl_add_u32 v18, v3, 3, v18
    v_lshl_add_u32 v17, v18, 6, v17
    v_and_b32 v18, 3, v1
    v_lshl_add_u32 v17, v18, 3, v17
    v_lshrrev_b32 v18, 1, v2
    v_mul_u32_u24 v18, 4096, v18
    v_add3_u32 v16, v17, v18, 0
    v_add_u32 v16, 16384, v16
    v_mov_b32 v64, 0
    v_mov_b32 v65, 0
    v_mov_b32 v66, 0
    v_mov_b32 v67, 0
    v_mov_b32 v68, 0
    v_mov_b32 v69, 0
    v_mov_b32 v70, 0
    v_mov_b32 v71, 0
    v_mov_b32 v72, 0
    v_mov_b32 v73, 0
    v_mov_b32 v74, 0
    v_mov_b32 v75, 0
    v_mov_b32 v76, 0
    v_mov_b32 v77, 0
    v_mov_b32 v78, 0
    v_mov_b32 v79, 0
    v_mov_b32 v80, 0
    v_mov_b32 v81, 0
    v_mov_b32 v82, 0
    v_mov_b32 v83, 0
    v_mov_b32 v84, 0
    v_mov_b32 v85, 0
    v_mov_b32 v86, 0
    v_mov_b32 v87, 0
    v_mov_b32 v88, 0
    v_mov_b32 v89, 0
    v_mov_b32 v90, 0
    v_mov_b32 v91, 0
    v_mov_b32 v92, 0
    v_mov_b32 v93, 0
    v_mov_b32 v94, 0
    v_mov_b32 v95, 0
    v_mov_b32 v20, 0
    v_mov_b32 v21, 0
    v_mov_b32 v22, 0
    v_mov_b32 v23, 0
    v_mov_b32 v24, 0
    v_mov_b32 v25, 0
    v_mov_b32 v26, 0
    v_mov_b32 v27, 0
    s_mov_b32 s32, 0
    s_mov_b32 s33, 0
    s_cmp_lg_u32 s37, 10
    s_cselect_b32 s44, s12, s16
    s_cselect_b32 s45, s13, s17
    s_cselect_b32 s46, s14, s18
    s_mov_b32 s47, 0x00020000
    v_readfirstlane_b32 s3, v2
    s_mul_i32 s3, s3, 4096
    s_add_u32 s3, s3, 0
    s_mov_b32 m0, s3
    s_nop 0
    buffer_load_dwordx4 v4, s[8:11], s32 offen lds
    v_readfirstlane_b32 s3, v2
    s_mul_i32 s3, s3, 4096
    s_add_u32 s3, s3, 1024
    s_mov_b32 m0, s3
    s_nop 0
    buffer_load_dwordx4 v5, s[8:11], s32 offen lds
    v_readfirstlane_b32 s3, v2
    s_mul_i32 s3, s3, 4096
    s_add_u32 s3, s3, 2048
    s_mov_b32 m0, s3
    s_nop 0
    buffer_load_dwordx4 v6, s[8:11], s32 offen lds
    v_readfirstlane_b32 s3, v2
    s_mul_i32 s3, s3, 4096
    s_add_u32 s3, s3, 3072
    s_mov_b32 m0, s3
    s_nop 0
    buffer_load_dwordx4 v7, s[8:11], s32 offen lds
    v_readfirstlane_b32 s3, v2
    s_lshl_b32 s3, s3, 10
    s_add_u32 s3, s3, 16384
    s_mov_b32 m0, s3
    s_nop 0
    buffer_load_dwordx4 v8, s[12:15], s33 offen lds
    v_readfirstlane_b32 s3, v2
    s_lshl_b32 s3, s3, 10
    s_add_u32 s3, s3, 20480
    s_mov_b32 m0, s3
    s_nop 0
    buffer_load_dwordx4 v9, s[44:47], s33 offen lds
    s_add_u32 s32, s32, 128
    s_mul_i32 s3, s38, 64
    s_add_u32 s33, s33, s3
    s_mov_b32 s48, 0
il_qkvA0_kernel_loop:
    s_waitcnt vmcnt(0)
    s_barrier
    s_add_u32 s3, s48, 0
    s_cmp_ge_u32 s3, 9
    s_cbranch_scc1 il_qkvA0_kernel_nopf0
    v_readfirstlane_b32 s3, v2
    s_mul_i32 s3, s3, 4096
    s_add_u32 s3, s3, 24576
    s_mov_b32 m0, s3
    s_nop 0
    buffer_load_dwordx4 v4, s[8:11], s32 offen lds
    v_readfirstlane_b32 s3, v2
    s_mul_i32 s3, s3, 4096
    s_add_u32 s3, s3, 25600
    s_mov_b32 m0, s3
    s_nop 0
    buffer_load_dwordx4 v5, s[8:11], s32 offen lds
    v_readfirstlane_b32 s3, v2
    s_mul_i32 s3, s3, 4096
    s_add_u32 s3, s3, 26624
    s_mov_b32 m0, s3
    s_nop 0
    buffer_load_dwordx4 v6, s[8:11], s32 offen lds
    v_readfirstlane_b32 s3, v2
    s_mul_i32 s3, s3, 4096
    s_add_u32 s3, s3, 27648
    s_mov_b32 m0, s3
    s_nop 0
    buffer_load_dwordx4 v7, s[8:11], s32 offen lds
    v_readfirstlane_b32 s3, v2
    s_lshl_b32 s3, s3, 10
    s_add_u32 s3, s3, 40960
    s_mov_b32 m0, s3
    s_nop 0
    buffer_load_dwordx4 v8, s[12:15], s33 offen lds
    v_readfirstlane_b32 s3, v2
    s_lshl_b32 s3, s3, 10
    s_add_u32 s3, s3, 45056
    s_mov_b32 m0, s3
    s_nop 0
    buffer_load_dwordx4 v9, s[44:47], s33 offen lds
    s_add_u32 s32, s32, 128
    s_mul_i32 s3, s38, 64
    s_add_u32 s33, s33, s3
il_qkvA0_kernel_nopf0:
    ds_read_b128 v[32:35], v12 offset:0
    ds_read_b128 v[36:39], v12 offset:4096
    ds_read_b64_tr_b16 v[40:41], v16 offset:0
    ds_read_b64_tr_b16 v[42:43], v16 offset:256
    s_waitcnt lgkmcnt(0)
    ds_read_b128 v[44:47], v13 offset:0
    ds_read_b128 v[48:51], v13 offset:4096
    ds_read_b64_tr_b16 v[52:53], v16 offset:1024
    ds_read_b64_tr_b16 v[54:55], v16 offset:1280
    v_mfma_f32_32x32x16_bf16 v[64:79], v[40:43], v[32:35], v[64:79]
    v_mfma_f32_32x32x16_bf16 v[80:95], v[40:43], v[36:39], v[80:95]
    v_dot2_f32_bf16 v22, v32, v32, v22
    v_dot2_f32_bf16 v20, v32, s36, v20
    v_dot2_f32_bf16 v22, v33, v33, v22
    v_dot2_f32_bf16 v20, v33, s36, v20
    v_dot2_f32_bf16 v22, v34, v34, v22
    v_dot2_f32_bf16 v20, v34, s36, v20
    v_dot2_f32_bf16 v22, v35, v35, v22
    v_dot2_f32_bf16 v20, v35, s36, v20
    v_dot2_f32_bf16 v23, v36, v36, v23
    v_dot2_f32_bf16 v21, v36, s36, v21
    v_dot2_f32_bf16 v23, v37, v37, v23
    v_dot2_f32_bf16 v21, v37, s36, v21
    v_dot2_f32_bf16 v23, v38, v38, v23
    v_dot2_f32_bf16 v21, v38, s36, v21
    v_dot2_f32_bf16 v23, v39, v39, v23
    v_dot2_f32_bf16 v21, v39, s36, v21
    v_dot2_f32_bf16 v24, v40, s36, v24
    v_dot2_f32_bf16 v24, v41, s36, v24
    v_dot2_f32_bf16 v24, v42, s36, v24
    v_dot2_f32_bf16 v24, v43, s36, v24
    s_waitcnt lgkmcnt(0)
    ds_read_b128 v[32:35], v14 offset:0
    ds_read_b128 v[36:39], v14 offset:4096
    ds_read_b64_tr_b16 v[40:41], v16 offset:2048
    ds_read_b64_tr_b16 v[42:43], v16 offset:2304
    v_mfma_f32_32x32x16_bf16 v[64:79], v[52:55], v[44:47], v[64:79]
    v_mfma_f32_32x32x16_bf16 v[80:95], v[52:55], v[48:51], v[80:95]
    v_dot2_f32_bf16 v22, v44, v44, v22
    v_dot2_f32_bf16 v20, v44, s36, v20
    v_dot2_f32_bf16 v22, v45, v45, v22
    v_dot2_f32_bf16 v20, v45, s36, v20
    v_dot2_f32_bf16 v22, v46, v46, v22
    v_dot2_f32_bf16 v20, v46, s36, v20
    v_dot2_f32_bf16 v22, v47, v47, v22
    v_dot2_f32_bf16 v20, v47, s36, v20
    v_dot2_f32_bf16 v23, v48, v48, v23
    v_dot2_f32_bf16 v21, v48, s36, v21
    v_dot2_f32_bf16 v23, v49, v49, v23
    v_dot2_f32_bf16 v21, v49, s36, v21
    v_dot2_f32_bf16 v23, v50, v50, v23
    v_dot2_f32_bf16 v21, v50, s36, v21
    v_dot2_f32_bf16 v23, v51, v51, v23
    v_dot2_f32_bf16 v21, v51, s36, v21
    v_dot2_f32_bf16 v24, v52, s36, v24
    v_dot2_f32_bf16 v24, v53, s36, v24
    v_dot2_f32_bf16 v24, v54, s36, v24
    v_dot2_f32_bf16 v24, v55, s36, v24
    s_waitcnt lgkmcnt(0)
    ds_read_b128 v[44:47], v15 offset:0
    ds_read_b128 v[48:51], v15 offset:4096
    ds_read_b64_tr_b16 v[52:53], v16 offset:3072
    ds_read_b64_tr_b16 v[54:55], v16 offset:3328
    v_mfma_f32_32x32x16_bf16 v[64:79], v[40:43], v[32:35], v[64:79]
    v_mfma_f32_32x32x16_bf16 v[80:95], v[40:43], v[36:39], v[80:95]
    v_dot2_f32_bf16 v22, v32, v32, v22
    v_dot2_f32_bf16 v20, v32, s36, v20
    v_dot2_f32_bf16 v22, v33, v33, v22
    v_dot2_f32_bf16 v20, v33, s36, v20
    v_dot2_f32_bf16 v22, v34, v34, v22
    v_dot2_f32_bf16 v20, v34, s36, v20
    v_dot2_f32_bf16 v22, v35, v35, v22
    v_dot2_f32_bf16 v20, v35, s36, v20
    v_dot2_f32_bf16 v23, v36, v36, v23
    v_dot2_f32_bf16 v21, v36, s36, v21
    v_dot2_f32_bf16 v23, v37, v37, v23
    v_dot2_f32_bf16 v21, v37, s36, v21
    v_dot2_f32_bf16 v23, v38, v38, v23
    v_dot2_f32_bf16 v21, v38, s36, v21
    v_dot2_f32_bf16 v23, v39, v39, v23
    v_dot2_f32_bf16 v21, v39, s36, v21
    v_dot2_f32_bf16 v24, v40, s36, v24
    v_dot2_f32_bf16 v24, v41, s36, v24
    v_dot2_f32_bf16 v24, v42, s36, v24
    v_dot2_f32_bf16 v24, v43, s36, v24
    s_waitcnt lgkmcnt(0)
    v_mfma_f32_32x32x16_bf16 v[64:79], v[52:55], v[44:47], v[64:79]
    v_mfma_f32_32x32x16_bf16 v[80:95], v[52:55], v[48:51], v[80:95]
    v_dot2_f32_bf16 v22, v44, v44, v22
    v_dot2_f32_bf16 v20, v44, s36, v20
    v_dot2_f32_bf16 v22, v45, v45, v22
    v_dot2_f32_bf16 v20, v45, s36, v20
    v_dot2_f32_bf16 v22, v46, v46, v22
    v_dot2_f32_bf16 v20, v46, s36, v20
    v_dot2_f32_bf16 v22, v47, v47, v22
    v_dot2_f32_bf16 v20, v47, s36, v20
    v_dot2_f32_bf16 v23, v48, v48, v23
    v_dot2_f32_bf16 v21, v48, s36, v21
    v_dot2_f32_bf16 v23, v49, v49, v23
    v_dot2_f32_bf16 v21, v49, s36, v21
    v_dot2_f32_bf16 v23, v50, v50, v23
    v_dot2_f32_bf16 v21, v50, s36, v21
    v_dot2_f32_bf16 v23, v51, v51, v23
    v_dot2_f32_bf16 v21, v51, s36, v21
    v_dot2_f32_bf16 v24, v52, s36, v24
    v_dot2_f32_bf16 v24, v53, s36, v24
    v_dot2_f32_bf16 v24, v54, s36, v24
    v_dot2_f32_bf16 v24, v55, s36, v24
    s_waitcnt vmcnt(0)
    s_barrier
    s_add_u32 s3, s48, 1
    s_cmp_ge_u32 s3, 9
    s_cbranch_scc1 il_qkvA0_kernel_nopf1
    v_readfirstlane_b32 s3, v2
    s_mul_i32 s3, s3, 4096
    s_add_u32 s3, s3, 0
    s_mov_b32 m0, s3
    s_nop 0
    buffer_load_dwordx4 v4, s[8:11], s32 offen lds
    v_readfirstlane_b32 s3, v2
    s_mul_i32 s3, s3, 4096
    s_add_u32 s3, s3, 1024
    s_mov_b32 m0, s3
    s_nop 0
    buffer_load_dwordx4 v5, s[8:11], s32 offen lds
    v_readfirstlane_b32 s3, v2
    s_mul_i32 s3, s3, 4096
    s_add_u32 s3, s3, 2048
    s_mov_b32 m0, s3
    s_nop 0
    buffer_load_dwordx4 v6, s[8:11], s32 offen lds
    v_readfirstlane_b32 s3, v2
    s_mul_i32 s3, s3, 4096
    s_add_u32 s3, s3, 3072
    s_mov_b32 m0, s3
    s_nop 0
    buffer_load_dwordx4 v7, s[8:11], s32 offen lds
    v_readfirstlane_b32 s3, v2
    s_lshl_b32 s3, s3, 10
    s_add_u32 s3, s3, 16384
    s_mov_b32 m0, s3
    s_nop 0
    buffer_load_dwordx4 v8, s[12:15], s33 offen lds
    v_readfirstlane_b32 s3, v2
    s_lshl_b32 s3, s3, 10
    s_add_u32 s3, s3, 20480
    s_mov_b32 m0, s3
    s_nop 0
    buffer_load_dwordx4 v9, s[44:47], s33 offen lds
    s_add_u32 s32, s32, 128
    s_mul_i32 s3, s38, 64
    s_add_u32 s33, s33, s3
il_qkvA0_kernel_nopf1:
    ds_read_b128 v[32:35], v12 offset:24576
    ds_read_b128 v[36:39], v12 offset:28672
    ds_read_b64_tr_b16 v[40:41], v16 offset:24576
    ds_read_b64_tr_b16 v[42:43], v16 offset:24832
    s_waitcnt lgkmcnt(0)
    ds_read_b128 v[44:47], v13 offset:24576
    ds_read_b128 v[48:51], v13 offset:28672
    ds_read_b64_tr_b16 v[52:53], v16 offset:25600
    ds_read_b64_tr_b16 v[54:55], v16 offset:25856
    v_mfma_f32_32x32x16_bf16 v[64:79], v[40:43], v[32:35], v[64:79]
    v_mfma_f32_32x32x16_bf16 v[80:95], v[40:43], v[36:39], v[80:95]
    v_dot2_f32_bf16 v22, v32, v32, v22
    v_dot2_f32_bf16 v20, v32, s36, v20
    v_dot2_f32_bf16 v22, v33, v33, v22
    v_dot2_f32_bf16 v20, v33, s36, v20
    v_dot2_f32_bf16 v22, v34, v34, v22
    v_dot2_f32_bf16 v20, v34, s36, v20
    v_dot2_f32_bf16 v22, v35, v35, v22
    v_dot2_f32_bf16 v20, v35, s36, v20
    v_dot2_f32_bf16 v23, v36, v36, v23
    v_dot2_f32_bf16 v21, v36, s36, v21
    v_dot2_f32_bf16 v23, v37, v37, v23
    v_dot2_f32_bf16 v21, v37, s36, v21
    v_dot2_f32_bf16 v23, v38, v38, v23
    v_dot2_f32_bf16 v21, v38, s36, v21
    v_dot2_f32_bf16 v23, v39, v39, v23
    v_dot2_f32_bf16 v21, v39, s36, v21
    v_dot2_f32_bf16 v24, v40, s36, v24
    v_dot2_f32_bf16 v24, v41, s36, v24
    v_dot2_f32_bf16 v24, v42, s36, v24
    v_dot2_f32_bf16 v24, v43, s36, v24
    s_waitcnt lgkmcnt(0)
    ds_read_b128 v[32:35], v14 offset:24576
    ds_read_b128 v[36:39], v14 offset:28672
    ds_read_b64_tr_b16 v[40:41], v16 offset:26624
    ds_read_b64_tr_b16 v[42:43], v16 offset:26880
    v_mfma_f32_32x32x16_bf16 v[64:79], v[52:55], v[44:47], v[64:79]
    v_mfma_f32_32x32x16_bf16 v[80:95], v[52:55], v[48:51], v[80:95]
    v_dot2_f32_bf16 v22, v44, v44, v22
    v_dot2_f32_bf16 v20, v44, s36, v20
    v_dot2_f32_bf16 v22, v45, v45, v22
    v_dot2_f32_bf16 v20, v45, s36, v20
    v_dot2_f32_bf16 v22, v46, v46, v22
    v_dot2_f32_bf16 v20, v46, s36, v20
    v_dot2_f32_bf16 v22, v47, v47, v22
    v_dot2_f32_bf16 v20, v47, s36, v20
    v_dot2_f32_bf16 v23, v48, v48, v23
    v_dot2_f32_bf16 v21, v48, s36, v21
    v_dot2_f32_bf16 v23, v49, v49, v23
    v_dot2_f32_bf16 v21, v49, s36, v21
    v_dot2_f32_bf16 v23, v50, v50, v23
    v_dot2_f32_bf16 v21, v50, s36, v21
    v_dot2_f32_bf16 v23, v51, v51, v23
    v_dot2_f32_bf16 v21, v51, s36, v21
    v_dot2_f32_bf16 v24, v52, s36, v24
    v_dot2_f32_bf16 v24, v53, s36, v24
    v_dot2_f32_bf16 v24, v54, s36, v24
    v_dot2_f32_bf16 v24, v55, s36, v24
    s_waitcnt lgkmcnt(0)
    ds_read_b128 v[44:47], v15 offset:24576
    ds_read_b128 v[48:51], v15 offset:28672
    ds_read_b64_tr_b16 v[52:53], v16 offset:27648
    ds_read_b64_tr_b16 v[54:55], v16 offset:27904
    v_mfma_f32_32x32x16_bf16 v[64:79], v[40:43], v[32:35], v[64:79]
    v_mfma_f32_32x32x16_bf16 v[80:95], v[40:43], v[36:39], v[80:95]
    v_dot2_f32_bf16 v22, v32, v32, v22
    v_dot2_f32_bf16 v20, v32, s36, v20
    v_dot2_f32_bf16 v22, v33, v33, v22
    v_dot2_f32_bf16 v20, v33, s36, v20
    v_dot2_f32_bf16 v22, v34, v34, v22
    v_dot2_f32_bf16 v20, v34, s36, v20
    v_dot2_f32_bf16 v22, v35, v35, v22
    v_dot2_f32_bf16 v20, v35, s36, v20
    v_dot2_f32_bf16 v23, v36, v36, v23
    v_dot2_f32_bf16 v21, v36, s36, v21
    v_dot2_f32_bf16 v23, v37, v37, v23
    v_dot2_f32_bf16 v21, v37, s36, v21
    v_dot2_f32_bf16 v23, v38, v38, v23
    v_dot2_f32_bf16 v21, v38, s36, v21
    v_dot2_f32_bf16 v23, v39, v39, v23
    v_dot2_f32_bf16 v21, v39, s36, v21
    v_dot2_f32_bf16 v24, v40, s36, v24
    v_dot2_f32_bf16 v24, v41, s36, v24
    v_dot2_f32_bf16 v24, v42, s36, v24
    v_dot2_f32_bf16 v24, v43, s36, v24
    s_waitcnt lgkmcnt(0)
    v_mfma_f32_32x32x16_bf16 v[64:79], v[52:55], v[44:47], v[64:79]
    v_mfma_f32_32x32x16_bf16 v[80:95], v[52:55], v[48:51], v[80:95]
    v_dot2_f32_bf16 v22, v44, v44, v22
    v_dot2_f32_bf16 v20, v44, s36, v20
    v_dot2_f32_bf16 v22, v45, v45, v22
    v_dot2_f32_bf16 v20, v45, s36, v20
    v_dot2_f32_bf16 v22, v46, v46, v22
    v_dot2_f32_bf16 v20, v46, s36, v20
    v_dot2_f32_bf16 v22, v47, v47, v22
    v_dot2_f32_bf16 v20, v47, s36, v20
    v_dot2_f32_bf16 v23, v48, v48, v23
    v_dot2_f32_bf16 v21, v48, s36, v21
    v_dot2_f32_bf16 v23, v49, v49, v23
    v_dot2_f32_bf16 v21, v49, s36, v21
    v_dot2_f32_bf16 v23, v50, v50, v23
    v_dot2_f32_bf16 v21, v50, s36, v21
    v_dot2_f32_bf16 v23, v51, v51, v23
    v_dot2_f32_bf16 v21, v51, s36, v21
    v_dot2_f32_bf16 v24, v52, s36, v24
    v_dot2_f32_bf16 v24, v53, s36, v24
    v_dot2_f32_bf16 v24, v54, s36, v24
    v_dot2_f32_bf16 v24, v55, s36, v24
    s_add_u32 s48, s48, 2
    s_cmp_lt_u32 s48, 10
    s_cbranch_scc1 il_qkvA0_kernel_loop
    s_nop 15
    s_nop 7
    v_and_b32 v4, 31, v1
    v_and_b32 v5, 1, v2
    v_mul_u32_u24 v5, 64, v5
    v_add3_u32 v4, v4, v5, s34
    v_lshrrev_b32 v5, 1, v2
    v_mul_u32_u24 v5, 32, v5
    v_lshl_add_u32 v5, v3, 2, v5
    v_add_u32 v5, s35, v5
    v_mov_b32 v6, v20
    s_nop 1
    v_permlane32_swap_b32 v6, v20
    s_nop 1
    v_add_f32 v20, v20, v6
    v_mov_b32 v6, v22
    s_nop 1
    v_permlane32_swap_b32 v6, v22
    s_nop 1
    v_add_f32 v22, v22, v6
    v_mov_b32 v6, v21
    s_nop 1
    v_permlane32_swap_b32 v6, v21
    s_nop 1
    v_add_f32 v21, v21, v6
    v_mov_b32 v6, v23
    s_nop 1
    v_permlane32_swap_b32 v6, v23
    s_nop 1
    v_add_f32 v23, v23, v6
    v_mov_b32 v6, v24
    s_nop 1
    v_permlane32_swap_b32 v6, v24
    s_nop 1
    v_add_f32 v24, v24, v6
    s_mov_b32 s3, 0x3acccccd
    v_mul_f32 v20, s3, v20
    v_mul_f32 v22, s3, v22
    v_fma_f32 v22, -v20, v20, v22
    v_max_f32 v22, 0, v22
    v_add_f32 v22, 0x3727c5ac, v22
    v_rsq_f32 v22, v22
    v_mul_f32 v21, s3, v21
    v_mul_f32 v23, s3, v23
    v_fma_f32 v23, -v21, v21, v23
    v_max_f32 v23, 0, v23
    v_add_f32 v23, 0x3727c5ac, v23
    v_rsq_f32 v23, v23
    v_lshlrev_b32 v6, 2, v1
    v_mul_u32_u24 v7, 256, v2
    v_add_u32 v6, v6, v7
    v_add_u32 v6, 49152, v6
    ds_write_b32 v6, v24 offset:0
    s_waitcnt lgkmcnt(0)
    v_lshlrev_b32 v6, 4, v3
    v_add3_u32 v6, v6, v7, 0
    v_add_u32 v6, 49152, v6
    ds_read_b128 v[32:35], v6 offset:0
    ds_read_b128 v[36:39], v6 offset:32
    ds_read_b128 v[40:43], v6 offset:64
    ds_read_b128 v[44:47], v6 offset:96
    s_waitcnt lgkmcnt(0)
    s_mov_b32 s49, 0x3ea52b5c
    s_mov_b32 s56, 640
    v_add_u32 v8, 0, v4
    v_fma_f32 v64, -v20, v32, v64
    v_mul_f32 v64, v22, v64
    v_fma_f32 v65, -v20, v33, v65
    v_mul_f32 v65, v22, v65
    v_fma_f32 v66, -v20, v34, v66
    v_mul_f32 v66, v22, v66
    v_fma_f32 v67, -v20, v35, v67
    v_mul_f32 v67, v22, v67
    v_fma_f32 v68, -v20, v36, v68
    v_mul_f32 v68, v22, v68
    v_fma_f32 v69, -v20, v37, v69
    v_mul_f32 v69, v22, v69
    v_fma_f32 v70, -v20, v38, v70
    v_mul_f32 v70, v22, v70
    v_fma_f32 v71, -v20, v39, v71
    v_mul_f32 v71, v22, v71
    v_fma_f32 v72, -v20, v40, v72
    v_mul_f32 v72, v22, v72
    v_fma_f32 v73, -v20, v41, v73
    v_mul_f32 v73, v22, v73
    v_fma_f32 v74, -v20, v42, v74
    v_mul_f32 v74, v22, v74
    v_fma_f32 v75, -v20, v43, v75
    v_mul_f32 v75, v22, v75
    v_fma_f32 v76, -v20, v44, v76
    v_mul_f32 v76, v22, v76
    v_fma_f32 v77, -v20, v45, v77
    v_mul_f32 v77, v22, v77
    v_fma_f32 v78, -v20, v46, v78
    v_mul_f32 v78, v22, v78
    v_fma_f32 v79, -v20, v47, v79
    v_mul_f32 v79, v22, v79
    v_add_u32 v9, 0, v5
    v_cmp_gt_u32 vcc, 640, v9
    s_and_saveexec_b64 s[50:51], vcc
    v_mul_f32 v16, s49, v64
    v_mul_f32 v17, s49, v65
    v_mul_f32 v18, s49, v66
    v_mul_f32 v19, s49, v67
    v_cvt_pk_bf16_f32 v14, v16, v17
    v_cvt_pk_bf16_f32 v15, v18, v19
    v_mul_u32_u24 v10, 1280, v8
    v_lshl_add_u32 v10, v9, 1, v10
    buffer_store_dwordx2 v[14:15], v10, s[20:23], 0 offen
    s_mov_b64 exec, s[50:51]
    v_cvt_pk_bf16_f32 v14, v64, v65
    v_cvt_pk_bf16_f32 v15, v66, v67
    v_subrev_u32 v11, 640, v9
    v_mov_b32 v12, 0
    v_and_b32 v13, 31, v11
    v_lshrrev_b32 v11, 5, v11
    v_cmp_le_u32 vcc, 640, v9
    v_cmp_gt_u32 s[52:53], 20, v13
    s_nop 1
    s_and_b64 vcc, vcc, s[52:53]
    s_and_saveexec_b64 s[50:51], vcc
    v_lshlrev_b32 v16, 17, v12
    v_lshl_add_u32 v16, v8, 6, v16
    v_lshrrev_b32 v17, 3, v13
    v_lshrrev_b32 v18, 2, v8
    v_and_b32 v18, 3, v18
    v_xor_b32 v17, v17, v18
    v_lshl_add_u32 v17, v17, 4, v16
    v_and_b32 v18, 7, v13
    v_lshl_add_u32 v17, v18, 1, v17
    v_lshl_add_u32 v16, v13, 1, v16
    v_cmp_eq_u32 vcc, 0, v11
    s_and_saveexec_b64 s[52:53], vcc
    buffer_store_dwordx2 v[14:15], v17, s[24:27], 0 offen
    v_cmp_eq_u32 vcc, 16, v13
    s_and_saveexec_b64 s[54:55], vcc
    v_mov_b32 v18, 0
    v_mov_b32 v19, 0
    buffer_store_dwordx2 v[18:19], v17, s[24:27], 0 offen offset:8
    v_lshrrev_b32 v18, 2, v8
    v_and_b32 v18, 3, v18
    v_xor_b32 v18, 3, v18
    v_and_b32 v19, 0xffffffc0, v17
    v_lshl_add_u32 v18, v18, 4, v19
    v_mov_b32 v28, 0
    v_mov_b32 v29, 0
    v_mov_b32 v30, 0
    v_mov_b32 v31, 0
    buffer_store_dwordx4 v[28:31], v18, s[24:27], 0 offen
    s_mov_b64 exec, s[50:51]
    v_cmp_ne_u32 vcc, 0, v11
    v_cmp_le_u32 s[52:53], s56, v9
    s_and_b64 vcc, vcc, s[52:53]
    v_cmp_gt_u32 s[52:53], 20, v13
    s_nop 1
    s_and_b64 vcc, vcc, s[52:53]
    s_and_saveexec_b64 s[52:53], vcc
    buffer_store_dwordx2 v[14:15], v16, s[28:31], 0 offen
    v_cmp_eq_u32 vcc, 16, v13
    s_and_saveexec_b64 s[54:55], vcc
    v_mov_b32 v18, 0x3f80
    v_mov_b32 v19, 0
    buffer_store_dwordx2 v[18:19], v16, s[28:31], 0 offen offset:8
    s_mov_b64 exec, -1
    v_add_u32 v9, 8, v5
    v_cmp_gt_u32 vcc, 640, v9
    s_and_saveexec_b64 s[50:51], vcc
    v_mul_f32 v16, s49, v68
    v_mul_f32 v17, s49, v69
    v_mul_f32 v18, s49, v70
    v_mul_f32 v19, s49, v71
    v_cvt_pk_bf16_f32 v14, v16, v17
    v_cvt_pk_bf16_f32 v15, v18, v19
    v_mul_u32_u24 v10, 1280, v8
    v_lshl_add_u32 v10, v9, 1, v10
    buffer_store_dwordx2 v[14:15], v10, s[20:23], 0 offen
    s_mov_b64 exec, s[50:51]
    v_cvt_pk_bf16_f32 v14, v68, v69
    v_cvt_pk_bf16_f32 v15, v70, v71
    v_subrev_u32 v11, 640, v9
    v_mov_b32 v12, 0
    v_and_b32 v13, 31, v11
    v_lshrrev_b32 v11, 5, v11
    v_cmp_le_u32 vcc, 640, v9
    v_cmp_gt_u32 s[52:53], 20, v13
    s_nop 1
    s_and_b64 vcc, vcc, s[52:53]
    s_and_saveexec_b64 s[50:51], vcc
    v_lshlrev_b32 v16, 17, v12
    v_lshl_add_u32 v16, v8, 6, v16
    v_lshrrev_b32 v17, 3, v13
    v_lshrrev_b32 v18, 2, v8
    v_and_b32 v18, 3, v18
    v_xor_b32 v17, v17, v18
    v_lshl_add_u32 v17, v17, 4, v16
    v_and_b32 v18, 7, v13
    v_lshl_add_u32 v17, v18, 1, v17
    v_lshl_add_u32 v16, v13, 1, v16
    v_cmp_eq_u32 vcc, 0, v11
    s_and_saveexec_b64 s[52:53], vcc
    buffer_store_dwordx2 v[14:15], v17, s[24:27], 0 offen
    v_cmp_eq_u32 vcc, 16, v13
    s_and_saveexec_b64 s[54:55], vcc
    v_mov_b32 v18, 0
    v_mov_b32 v19, 0
    buffer_store_dwordx2 v[18:19], v17, s[24:27], 0 offen offset:8
    v_lshrrev_b32 v18, 2, v8
    v_and_b32 v18, 3, v18
    v_xor_b32 v18, 3, v18
    v_and_b32 v19, 0xffffffc0, v17
    v_lshl_add_u32 v18, v18, 4, v19
    v_mov_b32 v28, 0
    v_mov_b32 v29, 0
    v_mov_b32 v30, 0
    v_mov_b32 v31, 0
    buffer_store_dwordx4 v[28:31], v18, s[24:27], 0 offen
    s_mov_b64 exec, s[50:51]
    v_cmp_ne_u32 vcc, 0, v11
    v_cmp_le_u32 s[52:53], s56, v9
    s_and_b64 vcc, vcc, s[52:53]
    v_cmp_gt_u32 s[52:53], 20, v13
    s_nop 1
    s_and_b64 vcc, vcc, s[52:53]
    s_and_saveexec_b64 s[52:53], vcc
    buffer_store_dwordx2 v[14:15], v16, s[28:31], 0 offen
    v_cmp_eq_u32 vcc, 16, v13
    s_and_saveexec_b64 s[54:55], vcc
    v_mov_b32 v18, 0x3f80
    v_mov_b32 v19, 0
    buffer_store_dwordx2 v[18:19], v16, s[28:31], 0 offen offset:8
    s_mov_b64 exec, -1
    v_add_u32 v9, 16, v5
    v_cmp_gt_u32 vcc, 640, v9
    s_and_saveexec_b64 s[50:51], vcc
    v_mul_f32 v16, s49, v72
    v_mul_f32 v17, s49, v73
    v_mul_f32 v18, s49, v74
    v_mul_f32 v19, s49, v75
    v_cvt_pk_bf16_f32 v14, v16, v17
    v_cvt_pk_bf16_f32 v15, v18, v19
    v_mul_u32_u24 v10, 1280, v8
    v_lshl_add_u32 v10, v9, 1, v10
    buffer_store_dwordx2 v[14:15], v10, s[20:23], 0 offen
    s_mov_b64 exec, s[50:51]
    v_cvt_pk_bf16_f32 v14, v72, v73
    v_cvt_pk_bf16_f32 v15, v74, v75
    v_subrev_u32 v11, 640, v9
    v_mov_b32 v12, 0
    v_and_b32 v13, 31, v11
    v_lshrrev_b32 v11, 5, v11
    v_cmp_le_u32 vcc, 640, v9
    v_cmp_gt_u32 s[52:53], 20, v13
    s_nop 1
    s_and_b64 vcc, vcc, s[52:53]
    s_and_saveexec_b64 s[50:51], vcc
    v_lshlrev_b32 v16, 17, v12
    v_lshl_add_u32 v16, v8, 6, v16
    v_lshrrev_b32 v17, 3, v13
    v_lshrrev_b32 v18, 2, v8
    v_and_b32 v18, 3, v18
    v_xor_b32 v17, v17, v18
    v_lshl_add_u32 v17, v17, 4, v16
    v_and_b32 v18, 7, v13
    v_lshl_add_u32 v17, v18, 1, v17
    v_lshl_add_u32 v16, v13, 1, v16
    v_cmp_eq_u32 vcc, 0, v11
    s_and_saveexec_b64 s[52:53], vcc
    buffer_store_dwordx2 v[14:15], v17, s[24:27], 0 offen
    v_cmp_eq_u32 vcc, 16, v13
    s_and_saveexec_b64 s[54:55], vcc
    v_mov_b32 v18, 0
    v_mov_b32 v19, 0
    buffer_store_dwordx2 v[18:19], v17, s[24:27], 0 offen offset:8
    v_lshrrev_b32 v18, 2, v8
    v_and_b32 v18, 3, v18
    v_xor_b32 v18, 3, v18
    v_and_b32 v19, 0xffffffc0, v17
    v_lshl_add_u32 v18, v18, 4, v19
    v_mov_b32 v28, 0
    v_mov_b32 v29, 0
    v_mov_b32 v30, 0
    v_mov_b32 v31, 0
    buffer_store_dwordx4 v[28:31], v18, s[24:27], 0 offen
    s_mov_b64 exec, s[50:51]
    v_cmp_ne_u32 vcc, 0, v11
    v_cmp_le_u32 s[52:53], s56, v9
    s_and_b64 vcc, vcc, s[52:53]
    v_cmp_gt_u32 s[52:53], 20, v13
    s_nop 1
    s_and_b64 vcc, vcc, s[52:53]
    s_and_saveexec_b64 s[52:53], vcc
    buffer_store_dwordx2 v[14:15], v16, s[28:31], 0 offen
    v_cmp_eq_u32 vcc, 16, v13
    s_and_saveexec_b64 s[54:55], vcc
    v_mov_b32 v18, 0x3f80
    v_mov_b32 v19, 0
    buffer_store_dwordx2 v[18:19], v16, s[28:31], 0 offen offset:8
    s_mov_b64 exec, -1
    v_add_u32 v9, 24, v5
    v_cmp_gt_u32 vcc, 640, v9
    s_and_saveexec_b64 s[50:51], vcc
    v_mul_f32 v16, s49, v76
    v_mul_f32 v17, s49, v77
    v_mul_f32 v18, s49, v78
    v_mul_f32 v19, s49, v79
    v_cvt_pk_bf16_f32 v14, v16, v17
    v_cvt_pk_bf16_f32 v15, v18, v19
    v_mul_u32_u24 v10, 1280, v8
    v_lshl_add_u32 v10, v9, 1, v10
    buffer_store_dwordx2 v[14:15], v10, s[20:23], 0 offen
    s_mov_b64 exec, s[50:51]
    v_cvt_pk_bf16_f32 v14, v76, v77
    v_cvt_pk_bf16_f32 v15, v78, v79
    v_subrev_u32 v11, 640, v9
    v_mov_b32 v12, 0
    v_and_b32 v13, 31, v11
    v_lshrrev_b32 v11, 5, v11
    v_cmp_le_u32 vcc, 640, v9
    v_cmp_gt_u32 s[52:53], 20, v13
    s_nop 1
    s_and_b64 vcc, vcc, s[52:53]
    s_and_saveexec_b64 s[50:51], vcc
    v_lshlrev_b32 v16, 17, v12
    v_lshl_add_u32 v16, v8, 6, v16
    v_lshrrev_b32 v17, 3, v13
    v_lshrrev_b32 v18, 2, v8
    v_and_b32 v18, 3, v18
    v_xor_b32 v17, v17, v18
    v_lshl_add_u32 v17, v17, 4, v16
    v_and_b32 v18, 7, v13
    v_lshl_add_u32 v17, v18, 1, v17
    v_lshl_add_u32 v16, v13, 1, v16
    v_cmp_eq_u32 vcc, 0, v11
    s_and_saveexec_b64 s[52:53], vcc
    buffer_store_dwordx2 v[14:15], v17, s[24:27], 0 offen
    v_cmp_eq_u32 vcc, 16, v13
    s_and_saveexec_b64 s[54:55], vcc
    v_mov_b32 v18, 0
    v_mov_b32 v19, 0
    buffer_store_dwordx2 v[18:19], v17, s[24:27], 0 offen offset:8
    v_lshrrev_b32 v18, 2, v8
    v_and_b32 v18, 3, v18
    v_xor_b32 v18, 3, v18
    v_and_b32 v19, 0xffffffc0, v17
    v_lshl_add_u32 v18, v18, 4, v19
    v_mov_b32 v28, 0
    v_mov_b32 v29, 0
    v_mov_b32 v30, 0
    v_mov_b32 v31, 0
    buffer_store_dwordx4 v[28:31], v18, s[24:27], 0 offen
    s_mov_b64 exec, s[50:51]
    v_cmp_ne_u32 vcc, 0, v11
    v_cmp_le_u32 s[52:53], s56, v9
    s_and_b64 vcc, vcc, s[52:53]
    v_cmp_gt_u32 s[52:53], 20, v13
    s_nop 1
    s_and_b64 vcc, vcc, s[52:53]
    s_and_saveexec_b64 s[52:53], vcc
    buffer_store_dwordx2 v[14:15], v16, s[28:31], 0 offen
    v_cmp_eq_u32 vcc, 16, v13
    s_and_saveexec_b64 s[54:55], vcc
    v_mov_b32 v18, 0x3f80
    v_mov_b32 v19, 0
    buffer_store_dwordx2 v[18:19], v16, s[28:31], 0 offen offset:8
    s_mov_b64 exec, -1
    v_add_u32 v8, 32, v4
    v_fma_f32 v80, -v21, v32, v80
    v_mul_f32 v80, v23, v80
    v_fma_f32 v81, -v21, v33, v81
    v_mul_f32 v81, v23, v81
    v_fma_f32 v82, -v21, v34, v82
    v_mul_f32 v82, v23, v82
    v_fma_f32 v83, -v21, v35, v83
    v_mul_f32 v83, v23, v83
    v_fma_f32 v84, -v21, v36, v84
    v_mul_f32 v84, v23, v84
    v_fma_f32 v85, -v21, v37, v85
    v_mul_f32 v85, v23, v85
    v_fma_f32 v86, -v21, v38, v86
    v_mul_f32 v86, v23, v86
    v_fma_f32 v87, -v21, v39, v87
    v_mul_f32 v87, v23, v87
    v_fma_f32 v88, -v21, v40, v88
    v_mul_f32 v88, v23, v88
    v_fma_f32 v89, -v21, v41, v89
    v_mul_f32 v89, v23, v89
    v_fma_f32 v90, -v21, v42, v90
    v_mul_f32 v90, v23, v90
    v_fma_f32 v91, -v21, v43, v91
    v_mul_f32 v91, v23, v91
    v_fma_f32 v92, -v21, v44, v92
    v_mul_f32 v92, v23, v92
    v_fma_f32 v93, -v21, v45, v93
    v_mul_f32 v93, v23, v93
    v_fma_f32 v94, -v21, v46, v94
    v_mul_f32 v94, v23, v94
    v_fma_f32 v95, -v21, v47, v95
    v_mul_f32 v95, v23, v95
    v_add_u32 v9, 0, v5
    v_cmp_gt_u32 vcc, 640, v9
    s_and_saveexec_b64 s[50:51], vcc
    v_mul_f32 v16, s49, v80
    v_mul_f32 v17, s49, v81
    v_mul_f32 v18, s49, v82
    v_mul_f32 v19, s49, v83
    v_cvt_pk_bf16_f32 v14, v16, v17
    v_cvt_pk_bf16_f32 v15, v18, v19
    v_mul_u32_u24 v10, 1280, v8
    v_lshl_add_u32 v10, v9, 1, v10
    buffer_store_dwordx2 v[14:15], v10, s[20:23], 0 offen
    s_mov_b64 exec, s[50:51]
    v_cvt_pk_bf16_f32 v14, v80, v81
    v_cvt_pk_bf16_f32 v15, v82, v83
    v_subrev_u32 v11, 640, v9
    v_mov_b32 v12, 0
    v_and_b32 v13, 31, v11
    v_lshrrev_b32 v11, 5, v11
    v_cmp_le_u32 vcc, 640, v9
    v_cmp_gt_u32 s[52:53], 20, v13
    s_nop 1
    s_and_b64 vcc, vcc, s[52:53]
    s_and_saveexec_b64 s[50:51], vcc
    v_lshlrev_b32 v16, 17, v12
    v_lshl_add_u32 v16, v8, 6, v16
    v_lshrrev_b32 v17, 3, v13
    v_lshrrev_b32 v18, 2, v8
    v_and_b32 v18, 3, v18
    v_xor_b32 v17, v17, v18
    v_lshl_add_u32 v17, v17, 4, v16
    v_and_b32 v18, 7, v13
    v_lshl_add_u32 v17, v18, 1, v17
    v_lshl_add_u32 v16, v13, 1, v16
    v_cmp_eq_u32 vcc, 0, v11
    s_and_saveexec_b64 s[52:53], vcc
    buffer_store_dwordx2 v[14:15], v17, s[24:27], 0 offen
    v_cmp_eq_u32 vcc, 16, v13
    s_and_saveexec_b64 s[54:55], vcc
    v_mov_b32 v18, 0
    v_mov_b32 v19, 0
    buffer_store_dwordx2 v[18:19], v17, s[24:27], 0 offen offset:8
    v_lshrrev_b32 v18, 2, v8
    v_and_b32 v18, 3, v18
    v_xor_b32 v18, 3, v18
    v_and_b32 v19, 0xffffffc0, v17
    v_lshl_add_u32 v18, v18, 4, v19
    v_mov_b32 v28, 0
    v_mov_b32 v29, 0
    v_mov_b32 v30, 0
    v_mov_b32 v31, 0
    buffer_store_dwordx4 v[28:31], v18, s[24:27], 0 offen
    s_mov_b64 exec, s[50:51]
    v_cmp_ne_u32 vcc, 0, v11
    v_cmp_le_u32 s[52:53], s56, v9
    s_and_b64 vcc, vcc, s[52:53]
    v_cmp_gt_u32 s[52:53], 20, v13
    s_nop 1
    s_and_b64 vcc, vcc, s[52:53]
    s_and_saveexec_b64 s[52:53], vcc
    buffer_store_dwordx2 v[14:15], v16, s[28:31], 0 offen
    v_cmp_eq_u32 vcc, 16, v13
    s_and_saveexec_b64 s[54:55], vcc
    v_mov_b32 v18, 0x3f80
    v_mov_b32 v19, 0
    buffer_store_dwordx2 v[18:19], v16, s[28:31], 0 offen offset:8
    s_mov_b64 exec, -1
    v_add_u32 v9, 8, v5
    v_cmp_gt_u32 vcc, 640, v9
    s_and_saveexec_b64 s[50:51], vcc
    v_mul_f32 v16, s49, v84
    v_mul_f32 v17, s49, v85
    v_mul_f32 v18, s49, v86
    v_mul_f32 v19, s49, v87
    v_cvt_pk_bf16_f32 v14, v16, v17
    v_cvt_pk_bf16_f32 v15, v18, v19
    v_mul_u32_u24 v10, 1280, v8
    v_lshl_add_u32 v10, v9, 1, v10
    buffer_store_dwordx2 v[14:15], v10, s[20:23], 0 offen
    s_mov_b64 exec, s[50:51]
    v_cvt_pk_bf16_f32 v14, v84, v85
    v_cvt_pk_bf16_f32 v15, v86, v87
    v_subrev_u32 v11, 640, v9
    v_mov_b32 v12, 0
    v_and_b32 v13, 31, v11
    v_lshrrev_b32 v11, 5, v11
    v_cmp_le_u32 vcc, 640, v9
    v_cmp_gt_u32 s[52:53], 20, v13
    s_nop 1
    s_and_b64 vcc, vcc, s[52:53]
    s_and_saveexec_b64 s[50:51], vcc
    v_lshlrev_b32 v16, 17, v12
    v_lshl_add_u32 v16, v8, 6, v16
    v_lshrrev_b32 v17, 3, v13
    v_lshrrev_b32 v18, 2, v8
    v_and_b32 v18, 3, v18
    v_xor_b32 v17, v17, v18
    v_lshl_add_u32 v17, v17, 4, v16
    v_and_b32 v18, 7, v13
    v_lshl_add_u32 v17, v18, 1, v17
    v_lshl_add_u32 v16, v13, 1, v16
    v_cmp_eq_u32 vcc, 0, v11
    s_and_saveexec_b64 s[52:53], vcc
    buffer_store_dwordx2 v[14:15], v17, s[24:27], 0 offen
    v_cmp_eq_u32 vcc, 16, v13
    s_and_saveexec_b64 s[54:55], vcc
    v_mov_b32 v18, 0
    v_mov_b32 v19, 0
    buffer_store_dwordx2 v[18:19], v17, s[24:27], 0 offen offset:8
    v_lshrrev_b32 v18, 2, v8
    v_and_b32 v18, 3, v18
    v_xor_b32 v18, 3, v18
    v_and_b32 v19, 0xffffffc0, v17
    v_lshl_add_u32 v18, v18, 4, v19
    v_mov_b32 v28, 0
    v_mov_b32 v29, 0
    v_mov_b32 v30, 0
    v_mov_b32 v31, 0
    buffer_store_dwordx4 v[28:31], v18, s[24:27], 0 offen
    s_mov_b64 exec, s[50:51]
    v_cmp_ne_u32 vcc, 0, v11
    v_cmp_le_u32 s[52:53], s56, v9
    s_and_b64 vcc, vcc, s[52:53]
    v_cmp_gt_u32 s[52:53], 20, v13
    s_nop 1
    s_and_b64 vcc, vcc, s[52:53]
    s_and_saveexec_b64 s[52:53], vcc
    buffer_store_dwordx2 v[14:15], v16, s[28:31], 0 offen
    v_cmp_eq_u32 vcc, 16, v13
    s_and_saveexec_b64 s[54:55], vcc
    v_mov_b32 v18, 0x3f80
    v_mov_b32 v19, 0
    buffer_store_dwordx2 v[18:19], v16, s[28:31], 0 offen offset:8
    s_mov_b64 exec, -1
    v_add_u32 v9, 16, v5
    v_cmp_gt_u32 vcc, 640, v9
    s_and_saveexec_b64 s[50:51], vcc
    v_mul_f32 v16, s49, v88
    v_mul_f32 v17, s49, v89
    v_mul_f32 v18, s49, v90
    v_mul_f32 v19, s49, v91
    v_cvt_pk_bf16_f32 v14, v16, v17
    v_cvt_pk_bf16_f32 v15, v18, v19
    v_mul_u32_u24 v10, 1280, v8
    v_lshl_add_u32 v10, v9, 1, v10
    buffer_store_dwordx2 v[14:15], v10, s[20:23], 0 offen
    s_mov_b64 exec, s[50:51]
    v_cvt_pk_bf16_f32 v14, v88, v89
    v_cvt_pk_bf16_f32 v15, v90, v91
    v_subrev_u32 v11, 640, v9
    v_mov_b32 v12, 0
    v_and_b32 v13, 31, v11
    v_lshrrev_b32 v11, 5, v11
    v_cmp_le_u32 vcc, 640, v9
    v_cmp_gt_u32 s[52:53], 20, v13
    s_nop 1
    s_and_b64 vcc, vcc, s[52:53]
    s_and_saveexec_b64 s[50:51], vcc
    v_lshlrev_b32 v16, 17, v12
    v_lshl_add_u32 v16, v8, 6, v16
    v_lshrrev_b32 v17, 3, v13
    v_lshrrev_b32 v18, 2, v8
    v_and_b32 v18, 3, v18
    v_xor_b32 v17, v17, v18
    v_lshl_add_u32 v17, v17, 4, v16
    v_and_b32 v18, 7, v13
    v_lshl_add_u32 v17, v18, 1, v17
    v_lshl_add_u32 v16, v13, 1, v16
    v_cmp_eq_u32 vcc, 0, v11
    s_and_saveexec_b64 s[52:53], vcc
    buffer_store_dwordx2 v[14:15], v17, s[24:27], 0 offen
    v_cmp_eq_u32 vcc, 16, v13
    s_and_saveexec_b64 s[54:55], vcc
    v_mov_b32 v18, 0
    v_mov_b32 v19, 0
    buffer_store_dwordx2 v[18:19], v17, s[24:27], 0 offen offset:8
    v_lshrrev_b32 v18, 2, v8
    v_and_b32 v18, 3, v18
    v_xor_b32 v18, 3, v18
    v_and_b32 v19, 0xffffffc0, v17
    v_lshl_add_u32 v18, v18, 4, v19
    v_mov_b32 v28, 0
    v_mov_b32 v29, 0
    v_mov_b32 v30, 0
    v_mov_b32 v31, 0
    buffer_store_dwordx4 v[28:31], v18, s[24:27], 0 offen
    s_mov_b64 exec, s[50:51]
    v_cmp_ne_u32 vcc, 0, v11
    v_cmp_le_u32 s[52:53], s56, v9
    s_and_b64 vcc, vcc, s[52:53]
    v_cmp_gt_u32 s[52:53], 20, v13
    s_nop 1
    s_and_b64 vcc, vcc, s[52:53]
    s_and_saveexec_b64 s[52:53], vcc
    buffer_store_dwordx2 v[14:15], v16, s[28:31], 0 offen
    v_cmp_eq_u32 vcc, 16, v13
    s_and_saveexec_b64 s[54:55], vcc
    v_mov_b32 v18, 0x3f80
    v_mov_b32 v19, 0
    buffer_store_dwordx2 v[18:19], v16, s[28:31], 0 offen offset:8
    s_mov_b64 exec, -1
    v_add_u32 v9, 24, v5
    v_cmp_gt_u32 vcc, 640, v9
    s_and_saveexec_b64 s[50:51], vcc
    v_mul_f32 v16, s49, v92
    v_mul_f32 v17, s49, v93
    v_mul_f32 v18, s49, v94
    v_mul_f32 v19, s49, v95
    v_cvt_pk_bf16_f32 v14, v16, v17
    v_cvt_pk_bf16_f32 v15, v18, v19
    v_mul_u32_u24 v10, 1280, v8
    v_lshl_add_u32 v10, v9, 1, v10
    buffer_store_dwordx2 v[14:15], v10, s[20:23], 0 offen
    s_mov_b64 exec, s[50:51]
    v_cvt_pk_bf16_f32 v14, v92, v93
    v_cvt_pk_bf16_f32 v15, v94, v95
    v_subrev_u32 v11, 640, v9
    v_mov_b32 v12, 0
    v_and_b32 v13, 31, v11
    v_lshrrev_b32 v11, 5, v11
    v_cmp_le_u32 vcc, 640, v9
    v_cmp_gt_u32 s[52:53], 20, v13
    s_nop 1
    s_and_b64 vcc, vcc, s[52:53]
    s_and_saveexec_b64 s[50:51], vcc
    v_lshlrev_b32 v16, 17, v12
    v_lshl_add_u32 v16, v8, 6, v16
    v_lshrrev_b32 v17, 3, v13
    v_lshrrev_b32 v18, 2, v8
    v_and_b32 v18, 3, v18
    v_xor_b32 v17, v17, v18
    v_lshl_add_u32 v17, v17, 4, v16
    v_and_b32 v18, 7, v13
    v_lshl_add_u32 v17, v18, 1, v17
    v_lshl_add_u32 v16, v13, 1, v16
    v_cmp_eq_u32 vcc, 0, v11
    s_and_saveexec_b64 s[52:53], vcc
    buffer_store_dwordx2 v[14:15], v17, s[24:27], 0 offen
    v_cmp_eq_u32 vcc, 16, v13
    s_and_saveexec_b64 s[54:55], vcc
    v_mov_b32 v18, 0
    v_mov_b32 v19, 0
    buffer_store_dwordx2 v[18:19], v17, s[24:27], 0 offen offset:8
    v_lshrrev_b32 v18, 2, v8
    v_and_b32 v18, 3, v18
    v_xor_b32 v18, 3, v18
    v_and_b32 v19, 0xffffffc0, v17
    v_lshl_add_u32 v18, v18, 4, v19
    v_mov_b32 v28, 0
    v_mov_b32 v29, 0
    v_mov_b32 v30, 0
    v_mov_b32 v31, 0
    buffer_store_dwordx4 v[28:31], v18, s[24:27], 0 offen
    s_mov_b64 exec, s[50:51]
    v_cmp_ne_u32 vcc, 0, v11
    v_cmp_le_u32 s[52:53], s56, v9
    s_and_b64 vcc, vcc, s[52:53]
    v_cmp_gt_u32 s[52:53], 20, v13
    s_nop 1
    s_and_b64 vcc, vcc, s[52:53]
    s_and_saveexec_b64 s[52:53], vcc
    buffer_store_dwordx2 v[14:15], v16, s[28:31], 0 offen
    v_cmp_eq_u32 vcc, 16, v13
    s_and_saveexec_b64 s[54:55], vcc
    v_mov_b32 v18, 0x3f80
    v_mov_b32 v19, 0
    buffer_store_dwordx2 v[18:19], v16, s[28:31], 0 offen offset:8
    s_mov_b64 exec, -1
    s_waitcnt vmcnt(0)
il_qkvA0_kernel_done:
    s_endpgm
.globl il_attnA_kernel
.p2align 8
.type il_attnA_kernel,@function
il_attnA_kernel:
    s_cmp_ge_u32 s2, 256
    s_cbranch_scc1 il_attnA_kernel_done
    s_load_dwordx2 s[4:5], s[0:1], 80
    v_and_b32 v1, 63, v0
    v_lshrrev_b32 v2, 6, v0
    v_lshrrev_b32 v3, 5, v1
    s_waitcnt lgkmcnt(0)
    s_add_u32 s8, s4, 7864320
    s_addc_u32 s9, s5, 0
    s_mov_b32 s10, 2621440
    s_mov_b32 s11, 0x00020000
    s_add_u32 s12, s4, 13107200
    s_addc_u32 s13, s5, 0
    s_mov_b32 s14, 4194304
    s_mov_b32 s15, 0x00020000
    s_add_u32 s16, s4, 17301504
    s_addc_u32 s17, s5, 0
    s_mov_b32 s18, 4194304
    s_mov_b32 s19, 0x00020000
    s_add_u32 s20, s4, 10485760
    s_addc_u32 s21, s5, 0
    s_mov_b32 s22, 2621440
    s_mov_b32 s23, 0x00020000
    s_mov_b32 s60, 0x41000000
    v_and_b32 v4, 31, v1
    v_lshrrev_b32 v5, 2, v4
    v_and_b32 v5, 3, v5
    v_xor_b32 v6, v3, v5
    v_lshlrev_b32 v4, 6, v4
    v_lshl_add_u32 v10, v6, 4, v4
    v_add_u32 v6, 2, v3
    v_xor_b32 v6, v6, v5
    v_lshl_add_u32 v11, v6, 4, v4
    v_and_b32 v4, 15, v1
    v_lshrrev_b32 v4, 2, v4
    v_lshl_add_u32 v4, v3, 2, v4
    v_lshlrev_b32 v4, 6, v4
    v_lshrrev_b32 v5, 4, v1
    v_and_b32 v5, 1, v5
    v_lshl_add_u32 v4, v5, 5, v4
    v_and_b32 v5, 3, v1
    v_lshl_add_u32 v12, v5, 3, v4
    s_lshl_b32 s3, s2, 3
    v_add_u32 v4, s3, v2
    v_mul_u32_u24 v4, 1280, v4
    v_and_b32 v5, 31, v1
    v_mul_u32_u24 v5, 40, v5
    v_add_u32 v13, v4, v5
    v_lshl_add_u32 v4, v3, 4, v13
    buffer_load_dwordx4 v[16:19], v4, s[8:11], 0 offen
    v_lshlrev_b32 v5, 4, v3
    v_sub_u32 v5, v4, v5
    buffer_load_dwordx2 v[20:21], v5, s[8:11], 0 offen offset:32
    v_mov_b32 v22, 0
    v_mov_b32 v23, 0
    s_waitcnt vmcnt(0)
    v_cmp_eq_u32 vcc, 0, v3
    s_nop 1
    v_cndmask_b32 v20, 0, v20, vcc
    v_cndmask_b32 v21, 0, v21, vcc
    v_mov_b32 v96, 0
    v_mov_b32 v80, 0
    v_mov_b32 v97, 0
    v_mov_b32 v81, 0
    v_mov_b32 v98, 0
    v_mov_b32 v82, 0
    v_mov_b32 v99, 0
    v_mov_b32 v83, 0
    v_mov_b32 v100, 0
    v_mov_b32 v84, 0
    v_mov_b32 v101, 0
    v_mov_b32 v85, 0
    v_mov_b32 v102, 0
    v_mov_b32 v86, 0
    v_mov_b32 v103, 0
    v_mov_b32 v87, 0
    v_mov_b32 v104, 0
    v_mov_b32 v88, 0
    v_mov_b32 v105, 0
    v_mov_b32 v89, 0
    v_mov_b32 v106, 0
    v_mov_b32 v90, 0
    v_mov_b32 v107, 0
    v_mov_b32 v91, 0
    v_mov_b32 v108, 0
    v_mov_b32 v92, 0
    v_mov_b32 v109, 0
    v_mov_b32 v93, 0
    v_mov_b32 v110, 0
    v_mov_b32 v94, 0
    v_mov_b32 v111, 0
    v_mov_b32 v95, 0
    v_lshlrev_b32 v14, 4, v1
    v_lshl_add_u32 v14, v2, 11, v14
    s_mov_b32 s32, 0
    v_readfirstlane_b32 s3, v2
    s_lshl_b32 s3, s3, 11
    s_add_u32 s33, s3, 0
    s_mov_b32 m0, s33
    s_nop 0
    buffer_load_dwordx4 v14, s[12:15], s32 offen offset:0 lds
    s_add_u32 s33, s3, 0
    s_mov_b32 m0, s33
    s_nop 0
    buffer_load_dwordx4 v14, s[12:15], s32 offen offset:1024 lds
    s_add_u32 s33, s3, 16384
    s_mov_b32 m0, s33
    s_nop 0
    buffer_load_dwordx4 v14, s[16:19], s32 offen offset:0 lds
    s_add_u32 s33, s3, 16384
    s_mov_b32 m0, s33
    s_nop 0
    buffer_load_dwordx4 v14, s[16:19], s32 offen offset:1024 lds
    s_add_u32 s32, s32, 16384
    s_mov_b32 s48, 0
il_attnA_kernel_loop:
    s_waitcnt vmcnt(0)
    s_barrier
    s_add_u32 s3, s48, 0
    s_cmp_ge_u32 s3, 7
    s_cbranch_scc1 il_attnA_kernel_nopf0
    v_readfirstlane_b32 s3, v2
    s_lshl_b32 s3, s3, 11
    s_add_u32 s33, s3, 32768
    s_mov_b32 m0, s33
    s_nop 0
    buffer_load_dwordx4 v14, s[12:15], s32 offen offset:0 lds
    s_add_u32 s33, s3, 32768
    s_mov_b32 m0, s33
    s_nop 0
    buffer_load_dwordx4 v14, s[12:15], s32 offen offset:1024 lds
    s_add_u32 s33, s3, 49152
    s_mov_b32 m0, s33
    s_nop 0
    buffer_load_dwordx4 v14, s[16:19], s32 offen offset:0 lds
    s_add_u32 s33, s3, 49152
    s_mov_b32 m0, s33
    s_nop 0
    buffer_load_dwordx4 v14, s[16:19], s32 offen offset:1024 lds
    s_add_u32 s32, s32, 16384
il_attnA_kernel_nopf0:
    ds_read_b128 v[24:27], v10 offset:0
    ds_read_b128 v[28:31], v11 offset:0
    ds_read_b64_tr_b16 v[32:33], v12 offset:16384
    ds_read_b64_tr_b16 v[34:35], v12 offset:16896
    ds_read_b64_tr_b16 v[36:37], v12 offset:17408
    ds_read_b64_tr_b16 v[38:39], v12 offset:17920
    s_waitcnt lgkmcnt(0)
    v_mfma_f32_32x32x16_bf16 v[64:79], v[24:27], v[16:19], v[80:95]
    v_mfma_f32_32x32x16_bf16 v[64:79], v[28:31], v[20:23], v[64:79]
    s_nop 15
    s_cmp_lg_u32 s48, 0
    s_cbranch_scc1 il_attnA_kernel_nf
    v_max3_f32 v40, v64, v65, v66
    v_max3_f32 v40, v40, v67, v68
    v_max3_f32 v40, v40, v69, v70
    v_max3_f32 v40, v40, v71, v72
    v_max3_f32 v40, v40, v73, v74
    v_max3_f32 v40, v40, v75, v76
    v_max3_f32 v40, v40, v77, v78
    v_max_f32 v40, v40, v79
    v_mov_b32 v41, v40
    s_nop 1
    v_permlane32_swap_b32 v41, v40
    s_nop 1
    v_max_f32 v40, v40, v41
    v_sub_f32 v64, v64, v40
    v_sub_f32 v80, 0, v40
    v_sub_f32 v65, v65, v40
    v_sub_f32 v81, 0, v40
    v_sub_f32 v66, v66, v40
    v_sub_f32 v82, 0, v40
    v_sub_f32 v67, v67, v40
    v_sub_f32 v83, 0, v40
    v_sub_f32 v68, v68, v40
    v_sub_f32 v84, 0, v40
    v_sub_f32 v69, v69, v40
    v_sub_f32 v85, 0, v40
    v_sub_f32 v70, v70, v40
    v_sub_f32 v86, 0, v40
    v_sub_f32 v71, v71, v40
    v_sub_f32 v87, 0, v40
    v_sub_f32 v72, v72, v40
    v_sub_f32 v88, 0, v40
    v_sub_f32 v73, v73, v40
    v_sub_f32 v89, 0, v40
    v_sub_f32 v74, v74, v40
    v_sub_f32 v90, 0, v40
    v_sub_f32 v75, v75, v40
    v_sub_f32 v91, 0, v40
    v_sub_f32 v76, v76, v40
    v_sub_f32 v92, 0, v40
    v_sub_f32 v77, v77, v40
    v_sub_f32 v93, 0, v40
    v_sub_f32 v78, v78, v40
    v_sub_f32 v94, 0, v40
    v_sub_f32 v79, v79, v40
    v_sub_f32 v95, 0, v40
il_attnA_kernel_nf:
    v_max3_f32 v40, v64, v65, v66
    v_max3_f32 v40, v40, v67, v68
    v_max3_f32 v40, v40, v69, v70
    v_max3_f32 v40, v40, v71, v72
    v_max3_f32 v40, v40, v73, v74
    v_max3_f32 v40, v40, v75, v76
    v_max3_f32 v40, v40, v77, v78
    v_max_f32 v40, v40, v79
    v_cmp_lt_f32 vcc, s60, v40
    s_cbranch_vccz il_attnA_kernel_ok_0_0
    v_mov_b32 v41, v40
    s_nop 1
    v_permlane32_swap_b32 v41, v40
    s_nop 1
    v_max_f32 v40, v40, v41
    v_max_f32 v40, 0, v40
    v_sub_f32 v41, 0, v40
    v_exp_f32 v41, v41
    s_nop 0
    v_mul_f32 v96, v96, v41
    v_sub_f32 v64, v64, v40
    v_sub_f32 v80, v80, v40
    v_mul_f32 v97, v97, v41
    v_sub_f32 v65, v65, v40
    v_sub_f32 v81, v81, v40
    v_mul_f32 v98, v98, v41
    v_sub_f32 v66, v66, v40
    v_sub_f32 v82, v82, v40
    v_mul_f32 v99, v99, v41
    v_sub_f32 v67, v67, v40
    v_sub_f32 v83, v83, v40
    v_mul_f32 v100, v100, v41
    v_sub_f32 v68, v68, v40
    v_sub_f32 v84, v84, v40
    v_mul_f32 v101, v101, v41
    v_sub_f32 v69, v69, v40
    v_sub_f32 v85, v85, v40
    v_mul_f32 v102, v102, v41
    v_sub_f32 v70, v70, v40
    v_sub_f32 v86, v86, v40
    v_mul_f32 v103, v103, v41
    v_sub_f32 v71, v71, v40
    v_sub_f32 v87, v87, v40
    v_mul_f32 v104, v104, v41
    v_sub_f32 v72, v72, v40
    v_sub_f32 v88, v88, v40
    v_mul_f32 v105, v105, v41
    v_sub_f32 v73, v73, v40
    v_sub_f32 v89, v89, v40
    v_mul_f32 v106, v106, v41
    v_sub_f32 v74, v74, v40
    v_sub_f32 v90, v90, v40
    v_mul_f32 v107, v107, v41
    v_sub_f32 v75, v75, v40
    v_sub_f32 v91, v91, v40
    v_mul_f32 v108, v108, v41
    v_sub_f32 v76, v76, v40
    v_sub_f32 v92, v92, v40
    v_mul_f32 v109, v109, v41
    v_sub_f32 v77, v77, v40
    v_sub_f32 v93, v93, v40
    v_mul_f32 v110, v110, v41
    v_sub_f32 v78, v78, v40
    v_sub_f32 v94, v94, v40
    v_mul_f32 v111, v111, v41
    v_sub_f32 v79, v79, v40
    v_sub_f32 v95, v95, v40
il_attnA_kernel_ok_0_0:
    v_exp_f32 v64, v64
    v_exp_f32 v65, v65
    v_exp_f32 v66, v66
    v_exp_f32 v67, v67
    v_exp_f32 v68, v68
    v_exp_f32 v69, v69
    v_exp_f32 v70, v70
    v_exp_f32 v71, v71
    v_exp_f32 v72, v72
    v_exp_f32 v73, v73
    v_exp_f32 v74, v74
    v_exp_f32 v75, v75
    v_exp_f32 v76, v76
    v_exp_f32 v77, v77
    v_exp_f32 v78, v78
    v_exp_f32 v79, v79
    s_nop 0
    v_cvt_pk_bf16_f32 v112, v64, v65
    v_cvt_pk_bf16_f32 v113, v66, v67
    v_cvt_pk_bf16_f32 v114, v68, v69
    v_cvt_pk_bf16_f32 v115, v70, v71
    v_cvt_pk_bf16_f32 v116, v72, v73
    v_cvt_pk_bf16_f32 v117, v74, v75
    v_cvt_pk_bf16_f32 v118, v76, v77
    v_cvt_pk_bf16_f32 v119, v78, v79
    s_nop 1
    v_mfma_f32_32x32x16_bf16 v[96:111], v[32:35], v[112:115], v[96:111]
    v_mfma_f32_32x32x16_bf16 v[96:111], v[36:39], v[116:119], v[96:111]
    ds_read_b128 v[24:27], v10 offset:2048
    ds_read_b128 v[28:31], v11 offset:2048
    ds_read_b64_tr_b16 v[32:33], v12 offset:18432
    ds_read_b64_tr_b16 v[34:35], v12 offset:18944
    ds_read_b64_tr_b16 v[36:37], v12 offset:19456
    ds_read_b64_tr_b16 v[38:39], v12 offset:19968
    s_waitcnt lgkmcnt(0)
    v_mfma_f32_32x32x16_bf16 v[64:79], v[24:27], v[16:19], v[80:95]
    v_mfma_f32_32x32x16_bf16 v[64:79], v[28:31], v[20:23], v[64:79]
    s_nop 15
    v_max3_f32 v40, v64, v65, v66
    v_max3_f32 v40, v40, v67, v68
    v_max3_f32 v40, v40, v69, v70
    v_max3_f32 v40, v40, v71, v72
    v_max3_f32 v40, v40, v73, v74
    v_max3_f32 v40, v40, v75, v76
    v_max3_f32 v40, v40, v77, v78
    v_max_f32 v40, v40, v79
    v_cmp_lt_f32 vcc, s60, v40
    s_cbranch_vccz il_attnA_kernel_ok_0_1
    v_mov_b32 v41, v40
    s_nop 1
    v_permlane32_swap_b32 v41, v40
    s_nop 1
    v_max_f32 v40, v40, v41
    v_max_f32 v40, 0, v40
    v_sub_f32 v41, 0, v40
    v_exp_f32 v41, v41
    s_nop 0
    v_mul_f32 v96, v96, v41
    v_sub_f32 v64, v64, v40
    v_sub_f32 v80, v80, v40
    v_mul_f32 v97, v97, v41
    v_sub_f32 v65, v65, v40
    v_sub_f32 v81, v81, v40
    v_mul_f32 v98, v98, v41
    v_sub_f32 v66, v66, v40
    v_sub_f32 v82, v82, v40
    v_mul_f32 v99, v99, v41
    v_sub_f32 v67, v67, v40
    v_sub_f32 v83, v83, v40
    v_mul_f32 v100, v100, v41
    v_sub_f32 v68, v68, v40
    v_sub_f32 v84, v84, v40
    v_mul_f32 v101, v101, v41
    v_sub_f32 v69, v69, v40
    v_sub_f32 v85, v85, v40
    v_mul_f32 v102, v102, v41
    v_sub_f32 v70, v70, v40
    v_sub_f32 v86, v86, v40
    v_mul_f32 v103, v103, v41
    v_sub_f32 v71, v71, v40
    v_sub_f32 v87, v87, v40
    v_mul_f32 v104, v104, v41
    v_sub_f32 v72, v72, v40
    v_sub_f32 v88, v88, v40
    v_mul_f32 v105, v105, v41
    v_sub_f32 v73, v73, v40
    v_sub_f32 v89, v89, v40
    v_mul_f32 v106, v106, v41
    v_sub_f32 v74, v74, v40
    v_sub_f32 v90, v90, v40
    v_mul_f32 v107, v107, v41
    v_sub_f32 v75, v75, v40
    v_sub_f32 v91, v91, v40
    v_mul_f32 v108, v108, v41
    v_sub_f32 v76, v76, v40
    v_sub_f32 v92, v92, v40
    v_mul_f32 v109, v109, v41
    v_sub_f32 v77, v77, v40
    v_sub_f32 v93, v93, v40
    v_mul_f32 v110, v110, v41
    v_sub_f32 v78, v78, v40
    v_sub_f32 v94, v94, v40
    v_mul_f32 v111, v111, v41
    v_sub_f32 v79, v79, v40
    v_sub_f32 v95, v95, v40
il_attnA_kernel_ok_0_1:
    v_exp_f32 v64, v64
    v_exp_f32 v65, v65
    v_exp_f32 v66, v66
    v_exp_f32 v67, v67
    v_exp_f32 v68, v68
    v_exp_f32 v69, v69
    v_exp_f32 v70, v70
    v_exp_f32 v71, v71
    v_exp_f32 v72, v72
    v_exp_f32 v73, v73
    v_exp_f32 v74, v74
    v_exp_f32 v75, v75
    v_exp_f32 v76, v76
    v_exp_f32 v77, v77
    v_exp_f32 v78, v78
    v_exp_f32 v79, v79
    s_nop 0
    v_cvt_pk_bf16_f32 v112, v64, v65
    v_cvt_pk_bf16_f32 v113, v66, v67
    v_cvt_pk_bf16_f32 v114, v68, v69
    v_cvt_pk_bf16_f32 v115, v70, v71
    v_cvt_pk_bf16_f32 v116, v72, v73
    v_cvt_pk_bf16_f32 v117, v74, v75
    v_cvt_pk_bf16_f32 v118, v76, v77
    v_cvt_pk_bf16_f32 v119, v78, v79
    s_nop 1
    v_mfma_f32_32x32x16_bf16 v[96:111], v[32:35], v[112:115], v[96:111]
    v_mfma_f32_32x32x16_bf16 v[96:111], v[36:39], v[116:119], v[96:111]
    ds_read_b128 v[24:27], v10 offset:4096
    ds_read_b128 v[28:31], v11 offset:4096
    ds_read_b64_tr_b16 v[32:33], v12 offset:20480
    ds_read_b64_tr_b16 v[34:35], v12 offset:20992
    ds_read_b64_tr_b16 v[36:37], v12 offset:21504
    ds_read_b64_tr_b16 v[38:39], v12 offset:22016
    s_waitcnt lgkmcnt(0)
    v_mfma_f32_32x32x16_bf16 v[64:79], v[24:27], v[16:19], v[80:95]
    v_mfma_f32_32x32x16_bf16 v[64:79], v[28:31], v[20:23], v[64:79]
    s_nop 15
    v_max3_f32 v40, v64, v65, v66
    v_max3_f32 v40, v40, v67, v68
    v_max3_f32 v40, v40, v69, v70
    v_max3_f32 v40, v40, v71, v72
    v_max3_f32 v40, v40, v73, v74
    v_max3_f32 v40, v40, v75, v76
    v_max3_f32 v40, v40, v77, v78
    v_max_f32 v40, v40, v79
    v_cmp_lt_f32 vcc, s60, v40
    s_cbranch_vccz il_attnA_kernel_ok_0_2
    v_mov_b32 v41, v40
    s_nop 1
    v_permlane32_swap_b32 v41, v40
    s_nop 1
    v_max_f32 v40, v40, v41
    v_max_f32 v40, 0, v40
    v_sub_f32 v41, 0, v40
    v_exp_f32 v41, v41
    s_nop 0
    v_mul_f32 v96, v96, v41
    v_sub_f32 v64, v64, v40
    v_sub_f32 v80, v80, v40
    v_mul_f32 v97, v97, v41
    v_sub_f32 v65, v65, v40
    v_sub_f32 v81, v81, v40
    v_mul_f32 v98, v98, v41
    v_sub_f32 v66, v66, v40
    v_sub_f32 v82, v82, v40
    v_mul_f32 v99, v99, v41
    v_sub_f32 v67, v67, v40
    v_sub_f32 v83, v83, v40
    v_mul_f32 v100, v100, v41
    v_sub_f32 v68, v68, v40
    v_sub_f32 v84, v84, v40
    v_mul_f32 v101, v101, v41
    v_sub_f32 v69, v69, v40
    v_sub_f32 v85, v85, v40
    v_mul_f32 v102, v102, v41
    v_sub_f32 v70, v70, v40
    v_sub_f32 v86, v86, v40
    v_mul_f32 v103, v103, v41
    v_sub_f32 v71, v71, v40
    v_sub_f32 v87, v87, v40
    v_mul_f32 v104, v104, v41
    v_sub_f32 v72, v72, v40
    v_sub_f32 v88, v88, v40
    v_mul_f32 v105, v105, v41
    v_sub_f32 v73, v73, v40
    v_sub_f32 v89, v89, v40
    v_mul_f32 v106, v106, v41
    v_sub_f32 v74, v74, v40
    v_sub_f32 v90, v90, v40
    v_mul_f32 v107, v107, v41
    v_sub_f32 v75, v75, v40
    v_sub_f32 v91, v91, v40
    v_mul_f32 v108, v108, v41
    v_sub_f32 v76, v76, v40
    v_sub_f32 v92, v92, v40
    v_mul_f32 v109, v109, v41
    v_sub_f32 v77, v77, v40
    v_sub_f32 v93, v93, v40
    v_mul_f32 v110, v110, v41
    v_sub_f32 v78, v78, v40
    v_sub_f32 v94, v94, v40
    v_mul_f32 v111, v111, v41
    v_sub_f32 v79, v79, v40
    v_sub_f32 v95, v95, v40
il_attnA_kernel_ok_0_2:
    v_exp_f32 v64, v64
    v_exp_f32 v65, v65
    v_exp_f32 v66, v66
    v_exp_f32 v67, v67
    v_exp_f32 v68, v68
    v_exp_f32 v69, v69
    v_exp_f32 v70, v70
    v_exp_f32 v71, v71
    v_exp_f32 v72, v72
    v_exp_f32 v73, v73
    v_exp_f32 v74, v74
    v_exp_f32 v75, v75
    v_exp_f32 v76, v76
    v_exp_f32 v77, v77
    v_exp_f32 v78, v78
    v_exp_f32 v79, v79
    s_nop 0
    v_cvt_pk_bf16_f32 v112, v64, v65
    v_cvt_pk_bf16_f32 v113, v66, v67
    v_cvt_pk_bf16_f32 v114, v68, v69
    v_cvt_pk_bf16_f32 v115, v70, v71
    v_cvt_pk_bf16_f32 v116, v72, v73
    v_cvt_pk_bf16_f32 v117, v74, v75
    v_cvt_pk_bf16_f32 v118, v76, v77
    v_cvt_pk_bf16_f32 v119, v78, v79
    s_nop 1
    v_mfma_f32_32x32x16_bf16 v[96:111], v[32:35], v[112:115], v[96:111]
    v_mfma_f32_32x32x16_bf16 v[96:111], v[36:39], v[116:119], v[96:111]
    ds_read_b128 v[24:27], v10 offset:6144
    ds_read_b128 v[28:31], v11 offset:6144
    ds_read_b64_tr_b16 v[32:33], v12 offset:22528
    ds_read_b64_tr_b16 v[34:35], v12 offset:23040
    ds_read_b64_tr_b16 v[36:37], v12 offset:23552
    ds_read_b64_tr_b16 v[38:39], v12 offset:24064
    s_waitcnt lgkmcnt(0)
    v_mfma_f32_32x32x16_bf16 v[64:79], v[24:27], v[16:19], v[80:95]
    v_mfma_f32_32x32x16_bf16 v[64:79], v[28:31], v[20:23], v[64:79]
    s_nop 15
    v_max3_f32 v40, v64, v65, v66
    v_max3_f32 v40, v40, v67, v68
    v_max3_f32 v40, v40, v69, v70
    v_max3_f32 v40, v40, v71, v72
    v_max3_f32 v40, v40, v73, v74
    v_max3_f32 v40, v40, v75, v76
    v_max3_f32 v40, v40, v77, v78
    v_max_f32 v40, v40, v79
    v_cmp_lt_f32 vcc, s60, v40
    s_cbranch_vccz il_attnA_kernel_ok_0_3
    v_mov_b32 v41, v40
    s_nop 1
    v_permlane32_swap_b32 v41, v40
    s_nop 1
    v_max_f32 v40, v40, v41
    v_max_f32 v40, 0, v40
    v_sub_f32 v41, 0, v40
    v_exp_f32 v41, v41
    s_nop 0
    v_mul_f32 v96, v96, v41
    v_sub_f32 v64, v64, v40
    v_sub_f32 v80, v80, v40
    v_mul_f32 v97, v97, v41
    v_sub_f32 v65, v65, v40
    v_sub_f32 v81, v81, v40
    v_mul_f32 v98, v98, v41
    v_sub_f32 v66, v66, v40
    v_sub_f32 v82, v82, v40
    v_mul_f32 v99, v99, v41
    v_sub_f32 v67, v67, v40
    v_sub_f32 v83, v83, v40
    v_mul_f32 v100, v100, v41
    v_sub_f32 v68, v68, v40
    v_sub_f32 v84, v84, v40
    v_mul_f32 v101, v101, v41
    v_sub_f32 v69, v69, v40
    v_sub_f32 v85, v85, v40
    v_mul_f32 v102, v102, v41
    v_sub_f32 v70, v70, v40
    v_sub_f32 v86, v86, v40
    v_mul_f32 v103, v103, v41
    v_sub_f32 v71, v71, v40
    v_sub_f32 v87, v87, v40
    v_mul_f32 v104, v104, v41
    v_sub_f32 v72, v72, v40
    v_sub_f32 v88, v88, v40
    v_mul_f32 v105, v105, v41
    v_sub_f32 v73, v73, v40
    v_sub_f32 v89, v89, v40
    v_mul_f32 v106, v106, v41
    v_sub_f32 v74, v74, v40
    v_sub_f32 v90, v90, v40
    v_mul_f32 v107, v107, v41
    v_sub_f32 v75, v75, v40
    v_sub_f32 v91, v91, v40
    v_mul_f32 v108, v108, v41
    v_sub_f32 v76, v76, v40
    v_sub_f32 v92, v92, v40
    v_mul_f32 v109, v109, v41
    v_sub_f32 v77, v77, v40
    v_sub_f32 v93, v93, v40
    v_mul_f32 v110, v110, v41
    v_sub_f32 v78, v78, v40
    v_sub_f32 v94, v94, v40
    v_mul_f32 v111, v111, v41
    v_sub_f32 v79, v79, v40
    v_sub_f32 v95, v95, v40
il_attnA_kernel_ok_0_3:
    v_exp_f32 v64, v64
    v_exp_f32 v65, v65
    v_exp_f32 v66, v66
    v_exp_f32 v67, v67
    v_exp_f32 v68, v68
    v_exp_f32 v69, v69
    v_exp_f32 v70, v70
    v_exp_f32 v71, v71
    v_exp_f32 v72, v72
    v_exp_f32 v73, v73
    v_exp_f32 v74, v74
    v_exp_f32 v75, v75
    v_exp_f32 v76, v76
    v_exp_f32 v77, v77
    v_exp_f32 v78, v78
    v_exp_f32 v79, v79
    s_nop 0
    v_cvt_pk_bf16_f32 v112, v64, v65
    v_cvt_pk_bf16_f32 v113, v66, v67
    v_cvt_pk_bf16_f32 v114, v68, v69
    v_cvt_pk_bf16_f32 v115, v70, v71
    v_cvt_pk_bf16_f32 v116, v72, v73
    v_cvt_pk_bf16_f32 v117, v74, v75
    v_cvt_pk_bf16_f32 v118, v76, v77
    v_cvt_pk_bf16_f32 v119, v78, v79
    s_nop 1
    v_mfma_f32_32x32x16_bf16 v[96:111], v[32:35], v[112:115], v[96:111]
    v_mfma_f32_32x32x16_bf16 v[96:111], v[36:39], v[116:119], v[96:111]
    ds_read_b128 v[24:27], v10 offset:8192
    ds_read_b128 v[28:31], v11 offset:8192
    ds_read_b64_tr_b16 v[32:33], v12 offset:24576
    ds_read_b64_tr_b16 v[34:35], v12 offset:25088
    ds_read_b64_tr_b16 v[36:37], v12 offset:25600
    ds_read_b64_tr_b16 v[38:39], v12 offset:26112
    s_waitcnt lgkmcnt(0)
    v_mfma_f32_32x32x16_bf16 v[64:79], v[24:27], v[16:19], v[80:95]
    v_mfma_f32_32x32x16_bf16 v[64:79], v[28:31], v[20:23], v[64:79]
    s_nop 15
    v_max3_f32 v40, v64, v65, v66
    v_max3_f32 v40, v40, v67, v68
    v_max3_f32 v40, v40, v69, v70
    v_max3_f32 v40, v40, v71, v72
    v_max3_f32 v40, v40, v73, v74
    v_max3_f32 v40, v40, v75, v76
    v_max3_f32 v40, v40, v77, v78
    v_max_f32 v40, v40, v79
    v_cmp_lt_f32 vcc, s60, v40
    s_cbranch_vccz il_attnA_kernel_ok_0_4
    v_mov_b32 v41, v40
    s_nop 1
    v_permlane32_swap_b32 v41, v40
    s_nop 1
    v_max_f32 v40, v40, v41
    v_max_f32 v40, 0, v40
    v_sub_f32 v41, 0, v40
    v_exp_f32 v41, v41
    s_nop 0
    v_mul_f32 v96, v96, v41
    v_sub_f32 v64, v64, v40
    v_sub_f32 v80, v80, v40
    v_mul_f32 v97, v97, v41
    v_sub_f32 v65, v65, v40
    v_sub_f32 v81, v81, v40
    v_mul_f32 v98, v98, v41
    v_sub_f32 v66, v66, v40
    v_sub_f32 v82, v82, v40
    v_mul_f32 v99, v99, v41
    v_sub_f32 v67, v67, v40
    v_sub_f32 v83, v83, v40
    v_mul_f32 v100, v100, v41
    v_sub_f32 v68, v68, v40
    v_sub_f32 v84, v84, v40
    v_mul_f32 v101, v101, v41
    v_sub_f32 v69, v69, v40
    v_sub_f32 v85, v85, v40
    v_mul_f32 v102, v102, v41
    v_sub_f32 v70, v70, v40
    v_sub_f32 v86, v86, v40
    v_mul_f32 v103, v103, v41
    v_sub_f32 v71, v71, v40
    v_sub_f32 v87, v87, v40
    v_mul_f32 v104, v104, v41
    v_sub_f32 v72, v72, v40
    v_sub_f32 v88, v88, v40
    v_mul_f32 v105, v105, v41
    v_sub_f32 v73, v73, v40
    v_sub_f32 v89, v89, v40
    v_mul_f32 v106, v106, v41
    v_sub_f32 v74, v74, v40
    v_sub_f32 v90, v90, v40
    v_mul_f32 v107, v107, v41
    v_sub_f32 v75, v75, v40
    v_sub_f32 v91, v91, v40
    v_mul_f32 v108, v108, v41
    v_sub_f32 v76, v76, v40
    v_sub_f32 v92, v92, v40
    v_mul_f32 v109, v109, v41
    v_sub_f32 v77, v77, v40
    v_sub_f32 v93, v93, v40
    v_mul_f32 v110, v110, v41
    v_sub_f32 v78, v78, v40
    v_sub_f32 v94, v94, v40
    v_mul_f32 v111, v111, v41
    v_sub_f32 v79, v79, v40
    v_sub_f32 v95, v95, v40
il_attnA_kernel_ok_0_4:
    v_exp_f32 v64, v64
    v_exp_f32 v65, v65
    v_exp_f32 v66, v66
    v_exp_f32 v67, v67
    v_exp_f32 v68, v68
    v_exp_f32 v69, v69
    v_exp_f32 v70, v70
    v_exp_f32 v71, v71
    v_exp_f32 v72, v72
    v_exp_f32 v73, v73
    v_exp_f32 v74, v74
    v_exp_f32 v75, v75
    v_exp_f32 v76, v76
    v_exp_f32 v77, v77
    v_exp_f32 v78, v78
    v_exp_f32 v79, v79
    s_nop 0
    v_cvt_pk_bf16_f32 v112, v64, v65
    v_cvt_pk_bf16_f32 v113, v66, v67
    v_cvt_pk_bf16_f32 v114, v68, v69
    v_cvt_pk_bf16_f32 v115, v70, v71
    v_cvt_pk_bf16_f32 v116, v72, v73
    v_cvt_pk_bf16_f32 v117, v74, v75
    v_cvt_pk_bf16_f32 v118, v76, v77
    v_cvt_pk_bf16_f32 v119, v78, v79
    s_nop 1
    v_mfma_f32_32x32x16_bf16 v[96:111], v[32:35], v[112:115], v[96:111]
    v_mfma_f32_32x32x16_bf16 v[96:111], v[36:39], v[116:119], v[96:111]
    ds_read_b128 v[24:27], v10 offset:10240
    ds_read_b128 v[28:31], v11 offset:10240
    ds_read_b64_tr_b16 v[32:33], v12 offset:26624
    ds_read_b64_tr_b16 v[34:35], v12 offset:27136
    ds_read_b64_tr_b16 v[36:37], v12 offset:27648
    ds_read_b64_tr_b16 v[38:39], v12 offset:28160
    s_waitcnt lgkmcnt(0)
    v_mfma_f32_32x32x16_bf16 v[64:79], v[24:27], v[16:19], v[80:95]
    v_mfma_f32_32x32x16_bf16 v[64:79], v[28:31], v[20:23], v[64:79]
    s_nop 15
    v_max3_f32 v40, v64, v65, v66
    v_max3_f32 v40, v40, v67, v68
    v_max3_f32 v40, v40, v69, v70
    v_max3_f32 v40, v40, v71, v72
    v_max3_f32 v40, v40, v73, v74
    v_max3_f32 v40, v40, v75, v76
    v_max3_f32 v40, v40, v77, v78
    v_max_f32 v40, v40, v79
    v_cmp_lt_f32 vcc, s60, v40
    s_cbranch_vccz il_attnA_kernel_ok_0_5
    v_mov_b32 v41, v40
    s_nop 1
    v_permlane32_swap_b32 v41, v40
    s_nop 1
    v_max_f32 v40, v40, v41
    v_max_f32 v40, 0, v40
    v_sub_f32 v41, 0, v40
    v_exp_f32 v41, v41
    s_nop 0
    v_mul_f32 v96, v96, v41
    v_sub_f32 v64, v64, v40
    v_sub_f32 v80, v80, v40
    v_mul_f32 v97, v97, v41
    v_sub_f32 v65, v65, v40
    v_sub_f32 v81, v81, v40
    v_mul_f32 v98, v98, v41
    v_sub_f32 v66, v66, v40
    v_sub_f32 v82, v82, v40
    v_mul_f32 v99, v99, v41
    v_sub_f32 v67, v67, v40
    v_sub_f32 v83, v83, v40
    v_mul_f32 v100, v100, v41
    v_sub_f32 v68, v68, v40
    v_sub_f32 v84, v84, v40
    v_mul_f32 v101, v101, v41
    v_sub_f32 v69, v69, v40
    v_sub_f32 v85, v85, v40
    v_mul_f32 v102, v102, v41
    v_sub_f32 v70, v70, v40
    v_sub_f32 v86, v86, v40
    v_mul_f32 v103, v103, v41
    v_sub_f32 v71, v71, v40
    v_sub_f32 v87, v87, v40
    v_mul_f32 v104, v104, v41
    v_sub_f32 v72, v72, v40
    v_sub_f32 v88, v88, v40
    v_mul_f32 v105, v105, v41
    v_sub_f32 v73, v73, v40
    v_sub_f32 v89, v89, v40
    v_mul_f32 v106, v106, v41
    v_sub_f32 v74, v74, v40
    v_sub_f32 v90, v90, v40
    v_mul_f32 v107, v107, v41
    v_sub_f32 v75, v75, v40
    v_sub_f32 v91, v91, v40
    v_mul_f32 v108, v108, v41
    v_sub_f32 v76, v76, v40
    v_sub_f32 v92, v92, v40
    v_mul_f32 v109, v109, v41
    v_sub_f32 v77, v77, v40
    v_sub_f32 v93, v93, v40
    v_mul_f32 v110, v110, v41
    v_sub_f32 v78, v78, v40
    v_sub_f32 v94, v94, v40
    v_mul_f32 v111, v111, v41
    v_sub_f32 v79, v79, v40
    v_sub_f32 v95, v95, v40
il_attnA_kernel_ok_0_5:
    v_exp_f32 v64, v64
    v_exp_f32 v65, v65
    v_exp_f32 v66, v66
    v_exp_f32 v67, v67
    v_exp_f32 v68, v68
    v_exp_f32 v69, v69
    v_exp_f32 v70, v70
    v_exp_f32 v71, v71
    v_exp_f32 v72, v72
    v_exp_f32 v73, v73
    v_exp_f32 v74, v74
    v_exp_f32 v75, v75
    v_exp_f32 v76, v76
    v_exp_f32 v77, v77
    v_exp_f32 v78, v78
    v_exp_f32 v79, v79
    s_nop 0
    v_cvt_pk_bf16_f32 v112, v64, v65
    v_cvt_pk_bf16_f32 v113, v66, v67
    v_cvt_pk_bf16_f32 v114, v68, v69
    v_cvt_pk_bf16_f32 v115, v70, v71
    v_cvt_pk_bf16_f32 v116, v72, v73
    v_cvt_pk_bf16_f32 v117, v74, v75
    v_cvt_pk_bf16_f32 v118, v76, v77
    v_cvt_pk_bf16_f32 v119, v78, v79
    s_nop 1
    v_mfma_f32_32x32x16_bf16 v[96:111], v[32:35], v[112:115], v[96:111]
    v_mfma_f32_32x32x16_bf16 v[96:111], v[36:39], v[116:119], v[96:111]
    ds_read_b128 v[24:27], v10 offset:12288
    ds_read_b128 v[28:31], v11 offset:12288
    ds_read_b64_tr_b16 v[32:33], v12 offset:28672
    ds_read_b64_tr_b16 v[34:35], v12 offset:29184
    ds_read_b64_tr_b16 v[36:37], v12 offset:29696
    ds_read_b64_tr_b16 v[38:39], v12 offset:30208
    s_waitcnt lgkmcnt(0)
    v_mfma_f32_32x32x16_bf16 v[64:79], v[24:27], v[16:19], v[80:95]
    v_mfma_f32_32x32x16_bf16 v[64:79], v[28:31], v[20:23], v[64:79]
    s_nop 15
    v_max3_f32 v40, v64, v65, v66
    v_max3_f32 v40, v40, v67, v68
    v_max3_f32 v40, v40, v69, v70
    v_max3_f32 v40, v40, v71, v72
    v_max3_f32 v40, v40, v73, v74
    v_max3_f32 v40, v40, v75, v76
    v_max3_f32 v40, v40, v77, v78
    v_max_f32 v40, v40, v79
    v_cmp_lt_f32 vcc, s60, v40
    s_cbranch_vccz il_attnA_kernel_ok_0_6
    v_mov_b32 v41, v40
    s_nop 1
    v_permlane32_swap_b32 v41, v40
    s_nop 1
    v_max_f32 v40, v40, v41
    v_max_f32 v40, 0, v40
    v_sub_f32 v41, 0, v40
    v_exp_f32 v41, v41
    s_nop 0
    v_mul_f32 v96, v96, v41
    v_sub_f32 v64, v64, v40
    v_sub_f32 v80, v80, v40
    v_mul_f32 v97, v97, v41
    v_sub_f32 v65, v65, v40
    v_sub_f32 v81, v81, v40
    v_mul_f32 v98, v98, v41
    v_sub_f32 v66, v66, v40
    v_sub_f32 v82, v82, v40
    v_mul_f32 v99, v99, v41
    v_sub_f32 v67, v67, v40
    v_sub_f32 v83, v83, v40
    v_mul_f32 v100, v100, v41
    v_sub_f32 v68, v68, v40
    v_sub_f32 v84, v84, v40
    v_mul_f32 v101, v101, v41
    v_sub_f32 v69, v69, v40
    v_sub_f32 v85, v85, v40
    v_mul_f32 v102, v102, v41
    v_sub_f32 v70, v70, v40
    v_sub_f32 v86, v86, v40
    v_mul_f32 v103, v103, v41
    v_sub_f32 v71, v71, v40
    v_sub_f32 v87, v87, v40
    v_mul_f32 v104, v104, v41
    v_sub_f32 v72, v72, v40
    v_sub_f32 v88, v88, v40
    v_mul_f32 v105, v105, v41
    v_sub_f32 v73, v73, v40
    v_sub_f32 v89, v89, v40
    v_mul_f32 v106, v106, v41
    v_sub_f32 v74, v74, v40
    v_sub_f32 v90, v90, v40
    v_mul_f32 v107, v107, v41
    v_sub_f32 v75, v75, v40
    v_sub_f32 v91, v91, v40
    v_mul_f32 v108, v108, v41
    v_sub_f32 v76, v76, v40
    v_sub_f32 v92, v92, v40
    v_mul_f32 v109, v109, v41
    v_sub_f32 v77, v77, v40
    v_sub_f32 v93, v93, v40
    v_mul_f32 v110, v110, v41
    v_sub_f32 v78, v78, v40
    v_sub_f32 v94, v94, v40
    v_mul_f32 v111, v111, v41
    v_sub_f32 v79, v79, v40
    v_sub_f32 v95, v95, v40
il_attnA_kernel_ok_0_6:
    v_exp_f32 v64, v64
    v_exp_f32 v65, v65
    v_exp_f32 v66, v66
    v_exp_f32 v67, v67
    v_exp_f32 v68, v68
    v_exp_f32 v69, v69
    v_exp_f32 v70, v70
    v_exp_f32 v71, v71
    v_exp_f32 v72, v72
    v_exp_f32 v73, v73
    v_exp_f32 v74, v74
    v_exp_f32 v75, v75
    v_exp_f32 v76, v76
    v_exp_f32 v77, v77
    v_exp_f32 v78, v78
    v_exp_f32 v79, v79
    s_nop 0
    v_cvt_pk_bf16_f32 v112, v64, v65
    v_cvt_pk_bf16_f32 v113, v66, v67
    v_cvt_pk_bf16_f32 v114, v68, v69
    v_cvt_pk_bf16_f32 v115, v70, v71
    v_cvt_pk_bf16_f32 v116, v72, v73
    v_cvt_pk_bf16_f32 v117, v74, v75
    v_cvt_pk_bf16_f32 v118, v76, v77
    v_cvt_pk_bf16_f32 v119, v78, v79
    s_nop 1
    v_mfma_f32_32x32x16_bf16 v[96:111], v[32:35], v[112:115], v[96:111]
    v_mfma_f32_32x32x16_bf16 v[96:111], v[36:39], v[116:119], v[96:111]
    ds_read_b128 v[24:27], v10 offset:14336
    ds_read_b128 v[28:31], v11 offset:14336
    ds_read_b64_tr_b16 v[32:33], v12 offset:30720
    ds_read_b64_tr_b16 v[34:35], v12 offset:31232
    ds_read_b64_tr_b16 v[36:37], v12 offset:31744
    ds_read_b64_tr_b16 v[38:39], v12 offset:32256
    s_waitcnt lgkmcnt(0)
    v_mfma_f32_32x32x16_bf16 v[64:79], v[24:27], v[16:19], v[80:95]
    v_mfma_f32_32x32x16_bf16 v[64:79], v[28:31], v[20:23], v[64:79]
    s_nop 15
    v_max3_f32 v40, v64, v65, v66
    v_max3_f32 v40, v40, v67, v68
    v_max3_f32 v40, v40, v69, v70
    v_max3_f32 v40, v40, v71, v72
    v_max3_f32 v40, v40, v73, v74
    v_max3_f32 v40, v40, v75, v76
    v_max3_f32 v40, v40, v77, v78
    v_max_f32 v40, v40, v79
    v_cmp_lt_f32 vcc, s60, v40
    s_cbranch_vccz il_attnA_kernel_ok_0_7
    v_mov_b32 v41, v40
    s_nop 1
    v_permlane32_swap_b32 v41, v40
    s_nop 1
    v_max_f32 v40, v40, v41
    v_max_f32 v40, 0, v40
    v_sub_f32 v41, 0, v40
    v_exp_f32 v41, v41
    s_nop 0
    v_mul_f32 v96, v96, v41
    v_sub_f32 v64, v64, v40
    v_sub_f32 v80, v80, v40
    v_mul_f32 v97, v97, v41
    v_sub_f32 v65, v65, v40
    v_sub_f32 v81, v81, v40
    v_mul_f32 v98, v98, v41
    v_sub_f32 v66, v66, v40
    v_sub_f32 v82, v82, v40
    v_mul_f32 v99, v99, v41
    v_sub_f32 v67, v67, v40
    v_sub_f32 v83, v83, v40
    v_mul_f32 v100, v100, v41
    v_sub_f32 v68, v68, v40
    v_sub_f32 v84, v84, v40
    v_mul_f32 v101, v101, v41
    v_sub_f32 v69, v69, v40
    v_sub_f32 v85, v85, v40
    v_mul_f32 v102, v102, v41
    v_sub_f32 v70, v70, v40
    v_sub_f32 v86, v86, v40
    v_mul_f32 v103, v103, v41
    v_sub_f32 v71, v71, v40
    v_sub_f32 v87, v87, v40
    v_mul_f32 v104, v104, v41
    v_sub_f32 v72, v72, v40
    v_sub_f32 v88, v88, v40
    v_mul_f32 v105, v105, v41
    v_sub_f32 v73, v73, v40
    v_sub_f32 v89, v89, v40
    v_mul_f32 v106, v106, v41
    v_sub_f32 v74, v74, v40
    v_sub_f32 v90, v90, v40
    v_mul_f32 v107, v107, v41
    v_sub_f32 v75, v75, v40
    v_sub_f32 v91, v91, v40
    v_mul_f32 v108, v108, v41
    v_sub_f32 v76, v76, v40
    v_sub_f32 v92, v92, v40
    v_mul_f32 v109, v109, v41
    v_sub_f32 v77, v77, v40
    v_sub_f32 v93, v93, v40
    v_mul_f32 v110, v110, v41
    v_sub_f32 v78, v78, v40
    v_sub_f32 v94, v94, v40
    v_mul_f32 v111, v111, v41
    v_sub_f32 v79, v79, v40
    v_sub_f32 v95, v95, v40
il_attnA_kernel_ok_0_7:
    v_exp_f32 v64, v64
    v_exp_f32 v65, v65
    v_exp_f32 v66, v66
    v_exp_f32 v67, v67
    v_exp_f32 v68, v68
    v_exp_f32 v69, v69
    v_exp_f32 v70, v70
    v_exp_f32 v71, v71
    v_exp_f32 v72, v72
    v_exp_f32 v73, v73
    v_exp_f32 v74, v74
    v_exp_f32 v75, v75
    v_exp_f32 v76, v76
    v_exp_f32 v77, v77
    v_exp_f32 v78, v78
    v_exp_f32 v79, v79
    s_nop 0
    v_cvt_pk_bf16_f32 v112, v64, v65
    v_cvt_pk_bf16_f32 v113, v66, v67
    v_cvt_pk_bf16_f32 v114, v68, v69
    v_cvt_pk_bf16_f32 v115, v70, v71
    v_cvt_pk_bf16_f32 v116, v72, v73
    v_cvt_pk_bf16_f32 v117, v74, v75
    v_cvt_pk_bf16_f32 v118, v76, v77
    v_cvt_pk_bf16_f32 v119, v78, v79
    s_nop 1
    v_mfma_f32_32x32x16_bf16 v[96:111], v[32:35], v[112:115], v[96:111]
    v_mfma_f32_32x32x16_bf16 v[96:111], v[36:39], v[116:119], v[96:111]
    s_waitcnt vmcnt(0)
    s_barrier
    s_add_u32 s3, s48, 1
    s_cmp_ge_u32 s3, 7
    s_cbranch_scc1 il_attnA_kernel_nopf1
    v_readfirstlane_b32 s3, v2
    s_lshl_b32 s3, s3, 11
    s_add_u32 s33, s3, 0
    s_mov_b32 m0, s33
    s_nop 0
    buffer_load_dwordx4 v14, s[12:15], s32 offen offset:0 lds
    s_add_u32 s33, s3, 0
    s_mov_b32 m0, s33
    s_nop 0
    buffer_load_dwordx4 v14, s[12:15], s32 offen offset:1024 lds
    s_add_u32 s33, s3, 16384
    s_mov_b32 m0, s33
    s_nop 0
    buffer_load_dwordx4 v14, s[16:19], s32 offen offset:0 lds
    s_add_u32 s33, s3, 16384
    s_mov_b32 m0, s33
    s_nop 0
    buffer_load_dwordx4 v14, s[16:19], s32 offen offset:1024 lds
    s_add_u32 s32, s32, 16384
il_attnA_kernel_nopf1:
    ds_read_b128 v[24:27], v10 offset:32768
    ds_read_b128 v[28:31], v11 offset:32768
    ds_read_b64_tr_b16 v[32:33], v12 offset:49152
    ds_read_b64_tr_b16 v[34:35], v12 offset:49664
    ds_read_b64_tr_b16 v[36:37], v12 offset:50176
    ds_read_b64_tr_b16 v[38:39], v12 offset:50688
    s_waitcnt lgkmcnt(0)
    v_mfma_f32_32x32x16_bf16 v[64:79], v[24:27], v[16:19], v[80:95]
    v_mfma_f32_32x32x16_bf16 v[64:79], v[28:31], v[20:23], v[64:79]
    s_nop 15
    v_max3_f32 v40, v64, v65, v66
    v_max3_f32 v40, v40, v67, v68
    v_max3_f32 v40, v40, v69, v70
    v_max3_f32 v40, v40, v71, v72
    v_max3_f32 v40, v40, v73, v74
    v_max3_f32 v40, v40, v75, v76
    v_max3_f32 v40, v40, v77, v78
    v_max_f32 v40, v40, v79
    v_cmp_lt_f32 vcc, s60, v40
    s_cbranch_vccz il_attnA_kernel_ok_1_0
    v_mov_b32 v41, v40
    s_nop 1
    v_permlane32_swap_b32 v41, v40
    s_nop 1
    v_max_f32 v40, v40, v41
    v_max_f32 v40, 0, v40
    v_sub_f32 v41, 0, v40
    v_exp_f32 v41, v41
    s_nop 0
    v_mul_f32 v96, v96, v41
    v_sub_f32 v64, v64, v40
    v_sub_f32 v80, v80, v40
    v_mul_f32 v97, v97, v41
    v_sub_f32 v65, v65, v40
    v_sub_f32 v81, v81, v40
    v_mul_f32 v98, v98, v41
    v_sub_f32 v66, v66, v40
    v_sub_f32 v82, v82, v40
    v_mul_f32 v99, v99, v41
    v_sub_f32 v67, v67, v40
    v_sub_f32 v83, v83, v40
    v_mul_f32 v100, v100, v41
    v_sub_f32 v68, v68, v40
    v_sub_f32 v84, v84, v40
    v_mul_f32 v101, v101, v41
    v_sub_f32 v69, v69, v40
    v_sub_f32 v85, v85, v40
    v_mul_f32 v102, v102, v41
    v_sub_f32 v70, v70, v40
    v_sub_f32 v86, v86, v40
    v_mul_f32 v103, v103, v41
    v_sub_f32 v71, v71, v40
    v_sub_f32 v87, v87, v40
    v_mul_f32 v104, v104, v41
    v_sub_f32 v72, v72, v40
    v_sub_f32 v88, v88, v40
    v_mul_f32 v105, v105, v41
    v_sub_f32 v73, v73, v40
    v_sub_f32 v89, v89, v40
    v_mul_f32 v106, v106, v41
    v_sub_f32 v74, v74, v40
    v_sub_f32 v90, v90, v40
    v_mul_f32 v107, v107, v41
    v_sub_f32 v75, v75, v40
    v_sub_f32 v91, v91, v40
    v_mul_f32 v108, v108, v41
    v_sub_f32 v76, v76, v40
    v_sub_f32 v92, v92, v40
    v_mul_f32 v109, v109, v41
    v_sub_f32 v77, v77, v40
    v_sub_f32 v93, v93, v40
    v_mul_f32 v110, v110, v41
    v_sub_f32 v78, v78, v40
    v_sub_f32 v94, v94, v40
    v_mul_f32 v111, v111, v41
    v_sub_f32 v79, v79, v40
    v_sub_f32 v95, v95, v40
il_attnA_kernel_ok_1_0:
    v_exp_f32 v64, v64
    v_exp_f32 v65, v65
    v_exp_f32 v66, v66
    v_exp_f32 v67, v67
    v_exp_f32 v68, v68
    v_exp_f32 v69, v69
    v_exp_f32 v70, v70
    v_exp_f32 v71, v71
    v_exp_f32 v72, v72
    v_exp_f32 v73, v73
    v_exp_f32 v74, v74
    v_exp_f32 v75, v75
    v_exp_f32 v76, v76
    v_exp_f32 v77, v77
    v_exp_f32 v78, v78
    v_exp_f32 v79, v79
    s_nop 0
    v_cvt_pk_bf16_f32 v112, v64, v65
    v_cvt_pk_bf16_f32 v113, v66, v67
    v_cvt_pk_bf16_f32 v114, v68, v69
    v_cvt_pk_bf16_f32 v115, v70, v71
    v_cvt_pk_bf16_f32 v116, v72, v73
    v_cvt_pk_bf16_f32 v117, v74, v75
    v_cvt_pk_bf16_f32 v118, v76, v77
    v_cvt_pk_bf16_f32 v119, v78, v79
    s_nop 1
    v_mfma_f32_32x32x16_bf16 v[96:111], v[32:35], v[112:115], v[96:111]
    v_mfma_f32_32x32x16_bf16 v[96:111], v[36:39], v[116:119], v[96:111]
    ds_read_b128 v[24:27], v10 offset:34816
    ds_read_b128 v[28:31], v11 offset:34816
    ds_read_b64_tr_b16 v[32:33], v12 offset:51200
    ds_read_b64_tr_b16 v[34:35], v12 offset:51712
    ds_read_b64_tr_b16 v[36:37], v12 offset:52224
    ds_read_b64_tr_b16 v[38:39], v12 offset:52736
    s_waitcnt lgkmcnt(0)
    v_mfma_f32_32x32x16_bf16 v[64:79], v[24:27], v[16:19], v[80:95]
    v_mfma_f32_32x32x16_bf16 v[64:79], v[28:31], v[20:23], v[64:79]
    s_nop 15
    v_max3_f32 v40, v64, v65, v66
    v_max3_f32 v40, v40, v67, v68
    v_max3_f32 v40, v40, v69, v70
    v_max3_f32 v40, v40, v71, v72
    v_max3_f32 v40, v40, v73, v74
    v_max3_f32 v40, v40, v75, v76
    v_max3_f32 v40, v40, v77, v78
    v_max_f32 v40, v40, v79
    v_cmp_lt_f32 vcc, s60, v40
    s_cbranch_vccz il_attnA_kernel_ok_1_1
    v_mov_b32 v41, v40
    s_nop 1
    v_permlane32_swap_b32 v41, v40
    s_nop 1
    v_max_f32 v40, v40, v41
    v_max_f32 v40, 0, v40
    v_sub_f32 v41, 0, v40
    v_exp_f32 v41, v41
    s_nop 0
    v_mul_f32 v96, v96, v41
    v_sub_f32 v64, v64, v40
    v_sub_f32 v80, v80, v40
    v_mul_f32 v97, v97, v41
    v_sub_f32 v65, v65, v40
    v_sub_f32 v81, v81, v40
    v_mul_f32 v98, v98, v41
    v_sub_f32 v66, v66, v40
    v_sub_f32 v82, v82, v40
    v_mul_f32 v99, v99, v41
    v_sub_f32 v67, v67, v40
    v_sub_f32 v83, v83, v40
    v_mul_f32 v100, v100, v41
    v_sub_f32 v68, v68, v40
    v_sub_f32 v84, v84, v40
    v_mul_f32 v101, v101, v41
    v_sub_f32 v69, v69, v40
    v_sub_f32 v85, v85, v40
    v_mul_f32 v102, v102, v41
    v_sub_f32 v70, v70, v40
    v_sub_f32 v86, v86, v40
    v_mul_f32 v103, v103, v41
    v_sub_f32 v71, v71, v40
    v_sub_f32 v87, v87, v40
    v_mul_f32 v104, v104, v41
    v_sub_f32 v72, v72, v40
    v_sub_f32 v88, v88, v40
    v_mul_f32 v105, v105, v41
    v_sub_f32 v73, v73, v40
    v_sub_f32 v89, v89, v40
    v_mul_f32 v106, v106, v41
    v_sub_f32 v74, v74, v40
    v_sub_f32 v90, v90, v40
    v_mul_f32 v107, v107, v41
    v_sub_f32 v75, v75, v40
    v_sub_f32 v91, v91, v40
    v_mul_f32 v108, v108, v41
    v_sub_f32 v76, v76, v40
    v_sub_f32 v92, v92, v40
    v_mul_f32 v109, v109, v41
    v_sub_f32 v77, v77, v40
    v_sub_f32 v93, v93, v40
    v_mul_f32 v110, v110, v41
    v_sub_f32 v78, v78, v40
    v_sub_f32 v94, v94, v40
    v_mul_f32 v111, v111, v41
    v_sub_f32 v79, v79, v40
    v_sub_f32 v95, v95, v40
il_attnA_kernel_ok_1_1:
    v_exp_f32 v64, v64
    v_exp_f32 v65, v65
    v_exp_f32 v66, v66
    v_exp_f32 v67, v67
    v_exp_f32 v68, v68
    v_exp_f32 v69, v69
    v_exp_f32 v70, v70
    v_exp_f32 v71, v71
    v_exp_f32 v72, v72
    v_exp_f32 v73, v73
    v_exp_f32 v74, v74
    v_exp_f32 v75, v75
    v_exp_f32 v76, v76
    v_exp_f32 v77, v77
    v_exp_f32 v78, v78
    v_exp_f32 v79, v79
    s_nop 0
    v_cvt_pk_bf16_f32 v112, v64, v65
    v_cvt_pk_bf16_f32 v113, v66, v67
    v_cvt_pk_bf16_f32 v114, v68, v69
    v_cvt_pk_bf16_f32 v115, v70, v71
    v_cvt_pk_bf16_f32 v116, v72, v73
    v_cvt_pk_bf16_f32 v117, v74, v75
    v_cvt_pk_bf16_f32 v118, v76, v77
    v_cvt_pk_bf16_f32 v119, v78, v79
    s_nop 1
    v_mfma_f32_32x32x16_bf16 v[96:111], v[32:35], v[112:115], v[96:111]
    v_mfma_f32_32x32x16_bf16 v[96:111], v[36:39], v[116:119], v[96:111]
    ds_read_b128 v[24:27], v10 offset:36864
    ds_read_b128 v[28:31], v11 offset:36864
    ds_read_b64_tr_b16 v[32:33], v12 offset:53248
    ds_read_b64_tr_b16 v[34:35], v12 offset:53760
    ds_read_b64_tr_b16 v[36:37], v12 offset:54272
    ds_read_b64_tr_b16 v[38:39], v12 offset:54784
    s_waitcnt lgkmcnt(0)
    v_mfma_f32_32x32x16_bf16 v[64:79], v[24:27], v[16:19], v[80:95]
    v_mfma_f32_32x32x16_bf16 v[64:79], v[28:31], v[20:23], v[64:79]
    s_nop 15
    v_max3_f32 v40, v64, v65, v66
    v_max3_f32 v40, v40, v67, v68
    v_max3_f32 v40, v40, v69, v70
    v_max3_f32 v40, v40, v71, v72
    v_max3_f32 v40, v40, v73, v74
    v_max3_f32 v40, v40, v75, v76
    v_max3_f32 v40, v40, v77, v78
    v_max_f32 v40, v40, v79
    v_cmp_lt_f32 vcc, s60, v40
    s_cbranch_vccz il_attnA_kernel_ok_1_2
    v_mov_b32 v41, v40
    s_nop 1
    v_permlane32_swap_b32 v41, v40
    s_nop 1
    v_max_f32 v40, v40, v41
    v_max_f32 v40, 0, v40
    v_sub_f32 v41, 0, v40
    v_exp_f32 v41, v41
    s_nop 0
    v_mul_f32 v96, v96, v41
    v_sub_f32 v64, v64, v40
    v_sub_f32 v80, v80, v40
    v_mul_f32 v97, v97, v41
    v_sub_f32 v65, v65, v40
    v_sub_f32 v81, v81, v40
    v_mul_f32 v98, v98, v41
    v_sub_f32 v66, v66, v40
    v_sub_f32 v82, v82, v40
    v_mul_f32 v99, v99, v41
    v_sub_f32 v67, v67, v40
    v_sub_f32 v83, v83, v40
    v_mul_f32 v100, v100, v41
    v_sub_f32 v68, v68, v40
    v_sub_f32 v84, v84, v40
    v_mul_f32 v101, v101, v41
    v_sub_f32 v69, v69, v40
    v_sub_f32 v85, v85, v40
    v_mul_f32 v102, v102, v41
    v_sub_f32 v70, v70, v40
    v_sub_f32 v86, v86, v40
    v_mul_f32 v103, v103, v41
    v_sub_f32 v71, v71, v40
    v_sub_f32 v87, v87, v40
    v_mul_f32 v104, v104, v41
    v_sub_f32 v72, v72, v40
    v_sub_f32 v88, v88, v40
    v_mul_f32 v105, v105, v41
    v_sub_f32 v73, v73, v40
    v_sub_f32 v89, v89, v40
    v_mul_f32 v106, v106, v41
    v_sub_f32 v74, v74, v40
    v_sub_f32 v90, v90, v40
    v_mul_f32 v107, v107, v41
    v_sub_f32 v75, v75, v40
    v_sub_f32 v91, v91, v40
    v_mul_f32 v108, v108, v41
    v_sub_f32 v76, v76, v40
    v_sub_f32 v92, v92, v40
    v_mul_f32 v109, v109, v41
    v_sub_f32 v77, v77, v40
    v_sub_f32 v93, v93, v40
    v_mul_f32 v110, v110, v41
    v_sub_f32 v78, v78, v40
    v_sub_f32 v94, v94, v40
    v_mul_f32 v111, v111, v41
    v_sub_f32 v79, v79, v40
    v_sub_f32 v95, v95, v40
il_attnA_kernel_ok_1_2:
    v_exp_f32 v64, v64
    v_exp_f32 v65, v65
    v_exp_f32 v66, v66
    v_exp_f32 v67, v67
    v_exp_f32 v68, v68
    v_exp_f32 v69, v69
    v_exp_f32 v70, v70
    v_exp_f32 v71, v71
    v_exp_f32 v72, v72
    v_exp_f32 v73, v73
    v_exp_f32 v74, v74
    v_exp_f32 v75, v75
    v_exp_f32 v76, v76
    v_exp_f32 v77, v77
    v_exp_f32 v78, v78
    v_exp_f32 v79, v79
    s_nop 0
    v_cvt_pk_bf16_f32 v112, v64, v65
    v_cvt_pk_bf16_f32 v113, v66, v67
    v_cvt_pk_bf16_f32 v114, v68, v69
    v_cvt_pk_bf16_f32 v115, v70, v71
    v_cvt_pk_bf16_f32 v116, v72, v73
    v_cvt_pk_bf16_f32 v117, v74, v75
    v_cvt_pk_bf16_f32 v118, v76, v77
    v_cvt_pk_bf16_f32 v119, v78, v79
    s_nop 1
    v_mfma_f32_32x32x16_bf16 v[96:111], v[32:35], v[112:115], v[96:111]
    v_mfma_f32_32x32x16_bf16 v[96:111], v[36:39], v[116:119], v[96:111]
    ds_read_b128 v[24:27], v10 offset:38912
    ds_read_b128 v[28:31], v11 offset:38912
    ds_read_b64_tr_b16 v[32:33], v12 offset:55296
    ds_read_b64_tr_b16 v[34:35], v12 offset:55808
    ds_read_b64_tr_b16 v[36:37], v12 offset:56320
    ds_read_b64_tr_b16 v[38:39], v12 offset:56832
    s_waitcnt lgkmcnt(0)
    v_mfma_f32_32x32x16_bf16 v[64:79], v[24:27], v[16:19], v[80:95]
    v_mfma_f32_32x32x16_bf16 v[64:79], v[28:31], v[20:23], v[64:79]
    s_nop 15
    v_max3_f32 v40, v64, v65, v66
    v_max3_f32 v40, v40, v67, v68
    v_max3_f32 v40, v40, v69, v70
    v_max3_f32 v40, v40, v71, v72
    v_max3_f32 v40, v40, v73, v74
    v_max3_f32 v40, v40, v75, v76
    v_max3_f32 v40, v40, v77, v78
    v_max_f32 v40, v40, v79
    v_cmp_lt_f32 vcc, s60, v40
    s_cbranch_vccz il_attnA_kernel_ok_1_3
    v_mov_b32 v41, v40
    s_nop 1
    v_permlane32_swap_b32 v41, v40
    s_nop 1
    v_max_f32 v40, v40, v41
    v_max_f32 v40, 0, v40
    v_sub_f32 v41, 0, v40
    v_exp_f32 v41, v41
    s_nop 0
    v_mul_f32 v96, v96, v41
    v_sub_f32 v64, v64, v40
    v_sub_f32 v80, v80, v40
    v_mul_f32 v97, v97, v41
    v_sub_f32 v65, v65, v40
    v_sub_f32 v81, v81, v40
    v_mul_f32 v98, v98, v41
    v_sub_f32 v66, v66, v40
    v_sub_f32 v82, v82, v40
    v_mul_f32 v99, v99, v41
    v_sub_f32 v67, v67, v40
    v_sub_f32 v83, v83, v40
    v_mul_f32 v100, v100, v41
    v_sub_f32 v68, v68, v40
    v_sub_f32 v84, v84, v40
    v_mul_f32 v101, v101, v41
    v_sub_f32 v69, v69, v40
    v_sub_f32 v85, v85, v40
    v_mul_f32 v102, v102, v41
    v_sub_f32 v70, v70, v40
    v_sub_f32 v86, v86, v40
    v_mul_f32 v103, v103, v41
    v_sub_f32 v71, v71, v40
    v_sub_f32 v87, v87, v40
    v_mul_f32 v104, v104, v41
    v_sub_f32 v72, v72, v40
    v_sub_f32 v88, v88, v40
    v_mul_f32 v105, v105, v41
    v_sub_f32 v73, v73, v40
    v_sub_f32 v89, v89, v40
    v_mul_f32 v106, v106, v41
    v_sub_f32 v74, v74, v40
    v_sub_f32 v90, v90, v40
    v_mul_f32 v107, v107, v41
    v_sub_f32 v75, v75, v40
    v_sub_f32 v91, v91, v40
    v_mul_f32 v108, v108, v41
    v_sub_f32 v76, v76, v40
    v_sub_f32 v92, v92, v40
    v_mul_f32 v109, v109, v41
    v_sub_f32 v77, v77, v40
    v_sub_f32 v93, v93, v40
    v_mul_f32 v110, v110, v41
    v_sub_f32 v78, v78, v40
    v_sub_f32 v94, v94, v40
    v_mul_f32 v111, v111, v41
    v_sub_f32 v79, v79, v40
    v_sub_f32 v95, v95, v40
il_attnA_kernel_ok_1_3:
    v_exp_f32 v64, v64
    v_exp_f32 v65, v65
    v_exp_f32 v66, v66
    v_exp_f32 v67, v67
    v_exp_f32 v68, v68
    v_exp_f32 v69, v69
    v_exp_f32 v70, v70
    v_exp_f32 v71, v71
    v_exp_f32 v72, v72
    v_exp_f32 v73, v73
    v_exp_f32 v74, v74
    v_exp_f32 v75, v75
    v_exp_f32 v76, v76
    v_exp_f32 v77, v77
    v_exp_f32 v78, v78
    v_exp_f32 v79, v79
    s_nop 0
    v_cvt_pk_bf16_f32 v112, v64, v65
    v_cvt_pk_bf16_f32 v113, v66, v67
    v_cvt_pk_bf16_f32 v114, v68, v69
    v_cvt_pk_bf16_f32 v115, v70, v71
    v_cvt_pk_bf16_f32 v116, v72, v73
    v_cvt_pk_bf16_f32 v117, v74, v75
    v_cvt_pk_bf16_f32 v118, v76, v77
    v_cvt_pk_bf16_f32 v119, v78, v79
    s_nop 1
    v_mfma_f32_32x32x16_bf16 v[96:111], v[32:35], v[112:115], v[96:111]
    v_mfma_f32_32x32x16_bf16 v[96:111], v[36:39], v[116:119], v[96:111]
    ds_read_b128 v[24:27], v10 offset:40960
    ds_read_b128 v[28:31], v11 offset:40960
    ds_read_b64_tr_b16 v[32:33], v12 offset:57344
    ds_read_b64_tr_b16 v[34:35], v12 offset:57856
    ds_read_b64_tr_b16 v[36:37], v12 offset:58368
    ds_read_b64_tr_b16 v[38:39], v12 offset:58880
    s_waitcnt lgkmcnt(0)
    v_mfma_f32_32x32x16_bf16 v[64:79], v[24:27], v[16:19], v[80:95]
    v_mfma_f32_32x32x16_bf16 v[64:79], v[28:31], v[20:23], v[64:79]
    s_nop 15
    v_max3_f32 v40, v64, v65, v66
    v_max3_f32 v40, v40, v67, v68
    v_max3_f32 v40, v40, v69, v70
    v_max3_f32 v40, v40, v71, v72
    v_max3_f32 v40, v40, v73, v74
    v_max3_f32 v40, v40, v75, v76
    v_max3_f32 v40, v40, v77, v78
    v_max_f32 v40, v40, v79
    v_cmp_lt_f32 vcc, s60, v40
    s_cbranch_vccz il_attnA_kernel_ok_1_4
    v_mov_b32 v41, v40
    s_nop 1
    v_permlane32_swap_b32 v41, v40
    s_nop 1
    v_max_f32 v40, v40, v41
    v_max_f32 v40, 0, v40
    v_sub_f32 v41, 0, v40
    v_exp_f32 v41, v41
    s_nop 0
    v_mul_f32 v96, v96, v41
    v_sub_f32 v64, v64, v40
    v_sub_f32 v80, v80, v40
    v_mul_f32 v97, v97, v41
    v_sub_f32 v65, v65, v40
    v_sub_f32 v81, v81, v40
    v_mul_f32 v98, v98, v41
    v_sub_f32 v66, v66, v40
    v_sub_f32 v82, v82, v40
    v_mul_f32 v99, v99, v41
    v_sub_f32 v67, v67, v40
    v_sub_f32 v83, v83, v40
    v_mul_f32 v100, v100, v41
    v_sub_f32 v68, v68, v40
    v_sub_f32 v84, v84, v40
    v_mul_f32 v101, v101, v41
    v_sub_f32 v69, v69, v40
    v_sub_f32 v85, v85, v40
    v_mul_f32 v102, v102, v41
    v_sub_f32 v70, v70, v40
    v_sub_f32 v86, v86, v40
    v_mul_f32 v103, v103, v41
    v_sub_f32 v71, v71, v40
    v_sub_f32 v87, v87, v40
    v_mul_f32 v104, v104, v41
    v_sub_f32 v72, v72, v40
    v_sub_f32 v88, v88, v40
    v_mul_f32 v105, v105, v41
    v_sub_f32 v73, v73, v40
    v_sub_f32 v89, v89, v40
    v_mul_f32 v106, v106, v41
    v_sub_f32 v74, v74, v40
    v_sub_f32 v90, v90, v40
    v_mul_f32 v107, v107, v41
    v_sub_f32 v75, v75, v40
    v_sub_f32 v91, v91, v40
    v_mul_f32 v108, v108, v41
    v_sub_f32 v76, v76, v40
    v_sub_f32 v92, v92, v40
    v_mul_f32 v109, v109, v41
    v_sub_f32 v77, v77, v40
    v_sub_f32 v93, v93, v40
    v_mul_f32 v110, v110, v41
    v_sub_f32 v78, v78, v40
    v_sub_f32 v94, v94, v40
    v_mul_f32 v111, v111, v41
    v_sub_f32 v79, v79, v40
    v_sub_f32 v95, v95, v40
il_attnA_kernel_ok_1_4:
    v_exp_f32 v64, v64
    v_exp_f32 v65, v65
    v_exp_f32 v66, v66
    v_exp_f32 v67, v67
    v_exp_f32 v68, v68
    v_exp_f32 v69, v69
    v_exp_f32 v70, v70
    v_exp_f32 v71, v71
    v_exp_f32 v72, v72
    v_exp_f32 v73, v73
    v_exp_f32 v74, v74
    v_exp_f32 v75, v75
    v_exp_f32 v76, v76
    v_exp_f32 v77, v77
    v_exp_f32 v78, v78
    v_exp_f32 v79, v79
    s_nop 0
    v_cvt_pk_bf16_f32 v112, v64, v65
    v_cvt_pk_bf16_f32 v113, v66, v67
    v_cvt_pk_bf16_f32 v114, v68, v69
    v_cvt_pk_bf16_f32 v115, v70, v71
    v_cvt_pk_bf16_f32 v116, v72, v73
    v_cvt_pk_bf16_f32 v117, v74, v75
    v_cvt_pk_bf16_f32 v118, v76, v77
    v_cvt_pk_bf16_f32 v119, v78, v79
    s_nop 1
    v_mfma_f32_32x32x16_bf16 v[96:111], v[32:35], v[112:115], v[96:111]
    v_mfma_f32_32x32x16_bf16 v[96:111], v[36:39], v[116:119], v[96:111]
    ds_read_b128 v[24:27], v10 offset:43008
    ds_read_b128 v[28:31], v11 offset:43008
    ds_read_b64_tr_b16 v[32:33], v12 offset:59392
    ds_read_b64_tr_b16 v[34:35], v12 offset:59904
    ds_read_b64_tr_b16 v[36:37], v12 offset:60416
    ds_read_b64_tr_b16 v[38:39], v12 offset:60928
    s_waitcnt lgkmcnt(0)
    v_mfma_f32_32x32x16_bf16 v[64:79], v[24:27], v[16:19], v[80:95]
    v_mfma_f32_32x32x16_bf16 v[64:79], v[28:31], v[20:23], v[64:79]
    s_nop 15
    v_max3_f32 v40, v64, v65, v66
    v_max3_f32 v40, v40, v67, v68
    v_max3_f32 v40, v40, v69, v70
    v_max3_f32 v40, v40, v71, v72
    v_max3_f32 v40, v40, v73, v74
    v_max3_f32 v40, v40, v75, v76
    v_max3_f32 v40, v40, v77, v78
    v_max_f32 v40, v40, v79
    v_cmp_lt_f32 vcc, s60, v40
    s_cbranch_vccz il_attnA_kernel_ok_1_5
    v_mov_b32 v41, v40
    s_nop 1
    v_permlane32_swap_b32 v41, v40
    s_nop 1
    v_max_f32 v40, v40, v41
    v_max_f32 v40, 0, v40
    v_sub_f32 v41, 0, v40
    v_exp_f32 v41, v41
    s_nop 0
    v_mul_f32 v96, v96, v41
    v_sub_f32 v64, v64, v40
    v_sub_f32 v80, v80, v40
    v_mul_f32 v97, v97, v41
    v_sub_f32 v65, v65, v40
    v_sub_f32 v81, v81, v40
    v_mul_f32 v98, v98, v41
    v_sub_f32 v66, v66, v40
    v_sub_f32 v82, v82, v40
    v_mul_f32 v99, v99, v41
    v_sub_f32 v67, v67, v40
    v_sub_f32 v83, v83, v40
    v_mul_f32 v100, v100, v41
    v_sub_f32 v68, v68, v40
    v_sub_f32 v84, v84, v40
    v_mul_f32 v101, v101, v41
    v_sub_f32 v69, v69, v40
    v_sub_f32 v85, v85, v40
    v_mul_f32 v102, v102, v41
    v_sub_f32 v70, v70, v40
    v_sub_f32 v86, v86, v40
    v_mul_f32 v103, v103, v41
    v_sub_f32 v71, v71, v40
    v_sub_f32 v87, v87, v40
    v_mul_f32 v104, v104, v41
    v_sub_f32 v72, v72, v40
    v_sub_f32 v88, v88, v40
    v_mul_f32 v105, v105, v41
    v_sub_f32 v73, v73, v40
    v_sub_f32 v89, v89, v40
    v_mul_f32 v106, v106, v41
    v_sub_f32 v74, v74, v40
    v_sub_f32 v90, v90, v40
    v_mul_f32 v107, v107, v41
    v_sub_f32 v75, v75, v40
    v_sub_f32 v91, v91, v40
    v_mul_f32 v108, v108, v41
    v_sub_f32 v76, v76, v40
    v_sub_f32 v92, v92, v40
    v_mul_f32 v109, v109, v41
    v_sub_f32 v77, v77, v40
    v_sub_f32 v93, v93, v40
    v_mul_f32 v110, v110, v41
    v_sub_f32 v78, v78, v40
    v_sub_f32 v94, v94, v40
    v_mul_f32 v111, v111, v41
    v_sub_f32 v79, v79, v40
    v_sub_f32 v95, v95, v40
il_attnA_kernel_ok_1_5:
    v_exp_f32 v64, v64
    v_exp_f32 v65, v65
    v_exp_f32 v66, v66
    v_exp_f32 v67, v67
    v_exp_f32 v68, v68
    v_exp_f32 v69, v69
    v_exp_f32 v70, v70
    v_exp_f32 v71, v71
    v_exp_f32 v72, v72
    v_exp_f32 v73, v73
    v_exp_f32 v74, v74
    v_exp_f32 v75, v75
    v_exp_f32 v76, v76
    v_exp_f32 v77, v77
    v_exp_f32 v78, v78
    v_exp_f32 v79, v79
    s_nop 0
    v_cvt_pk_bf16_f32 v112, v64, v65
    v_cvt_pk_bf16_f32 v113, v66, v67
    v_cvt_pk_bf16_f32 v114, v68, v69
    v_cvt_pk_bf16_f32 v115, v70, v71
    v_cvt_pk_bf16_f32 v116, v72, v73
    v_cvt_pk_bf16_f32 v117, v74, v75
    v_cvt_pk_bf16_f32 v118, v76, v77
    v_cvt_pk_bf16_f32 v119, v78, v79
    s_nop 1
    v_mfma_f32_32x32x16_bf16 v[96:111], v[32:35], v[112:115], v[96:111]
    v_mfma_f32_32x32x16_bf16 v[96:111], v[36:39], v[116:119], v[96:111]
    ds_read_b128 v[24:27], v10 offset:45056
    ds_read_b128 v[28:31], v11 offset:45056
    ds_read_b64_tr_b16 v[32:33], v12 offset:61440
    ds_read_b64_tr_b16 v[34:35], v12 offset:61952
    ds_read_b64_tr_b16 v[36:37], v12 offset:62464
    ds_read_b64_tr_b16 v[38:39], v12 offset:62976
    s_waitcnt lgkmcnt(0)
    v_mfma_f32_32x32x16_bf16 v[64:79], v[24:27], v[16:19], v[80:95]
    v_mfma_f32_32x32x16_bf16 v[64:79], v[28:31], v[20:23], v[64:79]
    s_nop 15
    v_max3_f32 v40, v64, v65, v66
    v_max3_f32 v40, v40, v67, v68
    v_max3_f32 v40, v40, v69, v70
    v_max3_f32 v40, v40, v71, v72
    v_max3_f32 v40, v40, v73, v74
    v_max3_f32 v40, v40, v75, v76
    v_max3_f32 v40, v40, v77, v78
    v_max_f32 v40, v40, v79
    v_cmp_lt_f32 vcc, s60, v40
    s_cbranch_vccz il_attnA_kernel_ok_1_6
    v_mov_b32 v41, v40
    s_nop 1
    v_permlane32_swap_b32 v41, v40
    s_nop 1
    v_max_f32 v40, v40, v41
    v_max_f32 v40, 0, v40
    v_sub_f32 v41, 0, v40
    v_exp_f32 v41, v41
    s_nop 0
    v_mul_f32 v96, v96, v41
    v_sub_f32 v64, v64, v40
    v_sub_f32 v80, v80, v40
    v_mul_f32 v97, v97, v41
    v_sub_f32 v65, v65, v40
    v_sub_f32 v81, v81, v40
    v_mul_f32 v98, v98, v41
    v_sub_f32 v66, v66, v40
    v_sub_f32 v82, v82, v40
    v_mul_f32 v99, v99, v41
    v_sub_f32 v67, v67, v40
    v_sub_f32 v83, v83, v40
    v_mul_f32 v100, v100, v41
    v_sub_f32 v68, v68, v40
    v_sub_f32 v84, v84, v40
    v_mul_f32 v101, v101, v41
    v_sub_f32 v69, v69, v40
    v_sub_f32 v85, v85, v40
    v_mul_f32 v102, v102, v41
    v_sub_f32 v70, v70, v40
    v_sub_f32 v86, v86, v40
    v_mul_f32 v103, v103, v41
    v_sub_f32 v71, v71, v40
    v_sub_f32 v87, v87, v40
    v_mul_f32 v104, v104, v41
    v_sub_f32 v72, v72, v40
    v_sub_f32 v88, v88, v40
    v_mul_f32 v105, v105, v41
    v_sub_f32 v73, v73, v40
    v_sub_f32 v89, v89, v40
    v_mul_f32 v106, v106, v41
    v_sub_f32 v74, v74, v40
    v_sub_f32 v90, v90, v40
    v_mul_f32 v107, v107, v41
    v_sub_f32 v75, v75, v40
    v_sub_f32 v91, v91, v40
    v_mul_f32 v108, v108, v41
    v_sub_f32 v76, v76, v40
    v_sub_f32 v92, v92, v40
    v_mul_f32 v109, v109, v41
    v_sub_f32 v77, v77, v40
    v_sub_f32 v93, v93, v40
    v_mul_f32 v110, v110, v41
    v_sub_f32 v78, v78, v40
    v_sub_f32 v94, v94, v40
    v_mul_f32 v111, v111, v41
    v_sub_f32 v79, v79, v40
    v_sub_f32 v95, v95, v40
il_attnA_kernel_ok_1_6:
    v_exp_f32 v64, v64
    v_exp_f32 v65, v65
    v_exp_f32 v66, v66
    v_exp_f32 v67, v67
    v_exp_f32 v68, v68
    v_exp_f32 v69, v69
    v_exp_f32 v70, v70
    v_exp_f32 v71, v71
    v_exp_f32 v72, v72
    v_exp_f32 v73, v73
    v_exp_f32 v74, v74
    v_exp_f32 v75, v75
    v_exp_f32 v76, v76
    v_exp_f32 v77, v77
    v_exp_f32 v78, v78
    v_exp_f32 v79, v79
    s_nop 0
    v_cvt_pk_bf16_f32 v112, v64, v65
    v_cvt_pk_bf16_f32 v113, v66, v67
    v_cvt_pk_bf16_f32 v114, v68, v69
    v_cvt_pk_bf16_f32 v115, v70, v71
    v_cvt_pk_bf16_f32 v116, v72, v73
    v_cvt_pk_bf16_f32 v117, v74, v75
    v_cvt_pk_bf16_f32 v118, v76, v77
    v_cvt_pk_bf16_f32 v119, v78, v79
    s_nop 1
    v_mfma_f32_32x32x16_bf16 v[96:111], v[32:35], v[112:115], v[96:111]
    v_mfma_f32_32x32x16_bf16 v[96:111], v[36:39], v[116:119], v[96:111]
    ds_read_b128 v[24:27], v10 offset:47104
    ds_read_b128 v[28:31], v11 offset:47104
    ds_read_b64_tr_b16 v[32:33], v12 offset:63488
    ds_read_b64_tr_b16 v[34:35], v12 offset:64000
    ds_read_b64_tr_b16 v[36:37], v12 offset:64512
    ds_read_b64_tr_b16 v[38:39], v12 offset:65024
    s_waitcnt lgkmcnt(0)
    v_mfma_f32_32x32x16_bf16 v[64:79], v[24:27], v[16:19], v[80:95]
    v_mfma_f32_32x32x16_bf16 v[64:79], v[28:31], v[20:23], v[64:79]
    s_nop 15
    v_max3_f32 v40, v64, v65, v66
    v_max3_f32 v40, v40, v67, v68
    v_max3_f32 v40, v40, v69, v70
    v_max3_f32 v40, v40, v71, v72
    v_max3_f32 v40, v40, v73, v74
    v_max3_f32 v40, v40, v75, v76
    v_max3_f32 v40, v40, v77, v78
    v_max_f32 v40, v40, v79
    v_cmp_lt_f32 vcc, s60, v40
    s_cbranch_vccz il_attnA_kernel_ok_1_7
    v_mov_b32 v41, v40
    s_nop 1
    v_permlane32_swap_b32 v41, v40
    s_nop 1
    v_max_f32 v40, v40, v41
    v_max_f32 v40, 0, v40
    v_sub_f32 v41, 0, v40
    v_exp_f32 v41, v41
    s_nop 0
    v_mul_f32 v96, v96, v41
    v_sub_f32 v64, v64, v40
    v_sub_f32 v80, v80, v40
    v_mul_f32 v97, v97, v41
    v_sub_f32 v65, v65, v40
    v_sub_f32 v81, v81, v40
    v_mul_f32 v98, v98, v41
    v_sub_f32 v66, v66, v40
    v_sub_f32 v82, v82, v40
    v_mul_f32 v99, v99, v41
    v_sub_f32 v67, v67, v40
    v_sub_f32 v83, v83, v40
    v_mul_f32 v100, v100, v41
    v_sub_f32 v68, v68, v40
    v_sub_f32 v84, v84, v40
    v_mul_f32 v101, v101, v41
    v_sub_f32 v69, v69, v40
    v_sub_f32 v85, v85, v40
    v_mul_f32 v102, v102, v41
    v_sub_f32 v70, v70, v40
    v_sub_f32 v86, v86, v40
    v_mul_f32 v103, v103, v41
    v_sub_f32 v71, v71, v40
    v_sub_f32 v87, v87, v40
    v_mul_f32 v104, v104, v41
    v_sub_f32 v72, v72, v40
    v_sub_f32 v88, v88, v40
    v_mul_f32 v105, v105, v41
    v_sub_f32 v73, v73, v40
    v_sub_f32 v89, v89, v40
    v_mul_f32 v106, v106, v41
    v_sub_f32 v74, v74, v40
    v_sub_f32 v90, v90, v40
    v_mul_f32 v107, v107, v41
    v_sub_f32 v75, v75, v40
    v_sub_f32 v91, v91, v40
    v_mul_f32 v108, v108, v41
    v_sub_f32 v76, v76, v40
    v_sub_f32 v92, v92, v40
    v_mul_f32 v109, v109, v41
    v_sub_f32 v77, v77, v40
    v_sub_f32 v93, v93, v40
    v_mul_f32 v110, v110, v41
    v_sub_f32 v78, v78, v40
    v_sub_f32 v94, v94, v40
    v_mul_f32 v111, v111, v41
    v_sub_f32 v79, v79, v40
    v_sub_f32 v95, v95, v40
il_attnA_kernel_ok_1_7:
    v_exp_f32 v64, v64
    v_exp_f32 v65, v65
    v_exp_f32 v66, v66
    v_exp_f32 v67, v67
    v_exp_f32 v68, v68
    v_exp_f32 v69, v69
    v_exp_f32 v70, v70
    v_exp_f32 v71, v71
    v_exp_f32 v72, v72
    v_exp_f32 v73, v73
    v_exp_f32 v74, v74
    v_exp_f32 v75, v75
    v_exp_f32 v76, v76
    v_exp_f32 v77, v77
    v_exp_f32 v78, v78
    v_exp_f32 v79, v79
    s_nop 0
    v_cvt_pk_bf16_f32 v112, v64, v65
    v_cvt_pk_bf16_f32 v113, v66, v67
    v_cvt_pk_bf16_f32 v114, v68, v69
    v_cvt_pk_bf16_f32 v115, v70, v71
    v_cvt_pk_bf16_f32 v116, v72, v73
    v_cvt_pk_bf16_f32 v117, v74, v75
    v_cvt_pk_bf16_f32 v118, v76, v77
    v_cvt_pk_bf16_f32 v119, v78, v79
    s_nop 1
    v_mfma_f32_32x32x16_bf16 v[96:111], v[32:35], v[112:115], v[96:111]
    v_mfma_f32_32x32x16_bf16 v[96:111], v[36:39], v[116:119], v[96:111]
    s_add_u32 s48, s48, 2
    s_cmp_lt_u32 s48, 8
    s_cbranch_scc1 il_attnA_kernel_loop
    s_nop 15
    v_lshl_add_u32 v13, v3, 3, v13
    v_mov_b32 v40, v104
    v_mov_b32 v41, v104
    s_nop 1
    v_permlane32_swap_b32 v40, v41
    s_nop 1
    v_rcp_f32 v41, v41
    s_nop 0
    v_mul_f32 v96, v96, v41
    v_mul_f32 v97, v97, v41
    v_mul_f32 v98, v98, v41
    v_mul_f32 v99, v99, v41
    v_mul_f32 v100, v100, v41
    v_mul_f32 v101, v101, v41
    v_mul_f32 v102, v102, v41
    v_mul_f32 v103, v103, v41
    v_mul_f32 v104, v104, v41
    v_mul_f32 v105, v105, v41
    v_mul_f32 v106, v106, v41
    v_mul_f32 v107, v107, v41
    v_cvt_pk_bf16_f32 v42, v96, v97
    v_cvt_pk_bf16_f32 v43, v98, v99
    buffer_store_dwordx2 v[42:43], v13, s[20:23], 0 offen offset:0
    v_cvt_pk_bf16_f32 v42, v100, v101
    v_cvt_pk_bf16_f32 v43, v102, v103
    buffer_store_dwordx2 v[42:43], v13, s[20:23], 0 offen offset:16
    v_cvt_pk_bf16_f32 v42, v104, v105
    v_cvt_pk_bf16_f32 v43, v106, v107
    v_cmp_eq_u32 vcc, 0, v3
    s_and_saveexec_b64 s[50:51], vcc
    buffer_store_dwordx2 v[42:43], v13, s[20:23], 0 offen offset:32
    s_mov_b64 exec, s[50:51]
    s_waitcnt vmcnt(0)
il_attnA_kernel_done:
    s_endpgm
.globl il_opA0_kernel
.p2align 8
.type il_opA0_kernel,@function
il_opA0_kernel:
    s_cmp_ge_u32 s2, 160
    s_cbranch_scc1 il_opA0_kernel_done
    s_load_dwordx2 s[4:5], s[0:1], 80
    s_load_dwordx2 s[6:7], s[0:1], 0
    s_load_dwordx2 s[12:13], s[0:1], 32
    s_and_b32 s34, s2, 15
    s_lshr_b32 s35, s2, 4
    s_mov_b32 s37, s35
    s_mul_i32 s34, s34, 128
    s_mul_i32 s35, s35, 64
    v_and_b32 v1, 63, v0
    v_lshrrev_b32 v2, 6, v0
    v_lshrrev_b32 v3, 5, v1
    s_waitcnt lgkmcnt(0)
    s_add_u32 s8, s4, 10485760
    s_addc_u32 s9, s5, 0
    s_mov_b32 s10, 2621440
    s_mov_b32 s11, 0x00020000
    s_mov_b32 s14, 819200
    s_mov_b32 s15, 0x00020000
    s_add_u32 s20, s4, 0
    s_addc_u32 s21, s5, 0
    s_mov_b32 s22, 2621440
    s_mov_b32 s23, 0x00020000
    s_mov_b32 s24, s6
    s_mov_b32 s25, s7
    s_mov_b32 s26, 2621440
    s_mov_b32 s27, 0x00020000
    s_mov_b32 s36, 0x3f803f80
    v_lshrrev_b32 v17, 3, v1
    v_mul_u32_u24 v18, 32, v2
    v_add_u32 v18, v18, v17
    v_and_b32 v19, 7, v1
    v_lshrrev_b32 v16, 1, v17
    v_xor_b32 v16, v16, v19
    v_lshlrev_b32 v16, 4, v16
    v_add_u32 v4, s34, v18
    v_add_u32 v4, 0, v4
    s_mov_b32 s3, 1280
    v_mul_lo_u32 v4, v4, s3
    v_add_u32 v4, v4, v16
    v_lshrrev_b32 v16, 1, v17
    v_xor_b32 v16, 4, v16
    v_xor_b32 v16, v16, v19
    v_lshlrev_b32 v16, 4, v16
    v_add_u32 v5, s34, v18
    v_add_u32 v5, 8, v5
    s_mov_b32 s3, 1280
    v_mul_lo_u32 v5, v5, s3
    v_add_u32 v5, v5, v16
    v_lshrrev_b32 v16, 1, v17
    v_xor_b32 v16, v16, v19
    v_lshlrev_b32 v16, 4, v16
    v_add_u32 v6, s34, v18
    v_add_u32 v6, 16, v6
    s_mov_b32 s3, 1280
    v_mul_lo_u32 v6, v6, s3
    v_add_u32 v6, v6, v16
    v_lshrrev_b32 v16, 1, v17
    v_xor_b32 v16, 4, v16
    v_xor_b32 v16, v16, v19
    v_lshlrev_b32 v16, 4, v16
    v_add_u32 v7, s34, v18
    v_add_u32 v7, 24, v7
    s_mov_b32 s3, 1280
    v_mul_lo_u32 v7, v7, s3
    v_add_u32 v7, v7, v16
    v_lshrrev_b32 v16, 2, v1
    v_lshl_add_u32 v16, v2, 4, v16
    v_and_b32 v17, 3, v1
    v_lshlrev_b32 v17, 4, v17
    s_mov_b32 s38, 1280
    s_mov_b32 s39, s35
    v_mul_lo_u32 v16, v16, s38
    v_add_u32 v16, v16, v17
    s_lshl_b32 s3, s39, 1
    v_add_u32 v8, s3, v16
    v_add_u32 v9, 64, v8
    v_and_b32 v16, 31, v1
    v_and_b32 v17, 1, v2
    v_mul_u32_u24 v17, 64, v17
    v_add_u32 v17, v17, v16
    v_lshrrev_b32 v16, 1, v16
    v_and_b32 v16, 7, v16
    v_lshlrev_b32 v17, 7, v17
    v_add_u32 v18, 0, v3
    v_xor_b32 v18, v18, v16
    v_lshl_add_u32 v12, v18, 4, v17
    v_add_u32 v18, 2, v3
    v_xor_b32 v18, v18, v16
    v_lshl_add_u32 v13, v18, 4, v17
    v_add_u32 v18, 4, v3
    v_xor_b32 v18, v18, v16
    v_lshl_add_u32 v14, v18, 4, v17
    v_add_u32 v18, 6, v3
    v_xor_b32 v18, v18, v16
    v_lshl_add_u32 v15, v18, 4, v17
    v_lshrrev_b32 v17, 4, v1
    v_and_b32 v17, 1, v17
    v_lshlrev_b32 v17, 5, v17
    v_and_b32 v18, 15, v1
    v_lshrrev_b32 v18, 2, v18
    v_lshl_add_u32 v18, v3, 3, v18
    v_lshl_add_u32 v17, v18, 6, v17
    v_and_b32 v18, 3, v1
    v_lshl_add_u32 v17, v18, 3, v17
    v_lshrrev_b32 v18, 1, v2
    v_mul_u32_u24 v18, 4096, v18
    v_add3_u32 v16, v17, v18, 0
    v_add_u32 v16, 16384, v16
    v_mov_b32 v64, 0
    v_mov_b32 v65, 0
    v_mov_b32 v66, 0
    v_mov_b32 v67, 0
    v_mov_b32 v68, 0
    v_mov_b32 v69, 0
    v_mov_b32 v70, 0
    v_mov_b32 v71, 0
    v_mov_b32 v72, 0
    v_mov_b32 v73, 0
    v_mov_b32 v74, 0
    v_mov_b32 v75, 0
    v_mov_b32 v76, 0
    v_mov_b32 v77, 0
    v_mov_b32 v78, 0
    v_mov_b32 v79, 0
    v_mov_b32 v80, 0
    v_mov_b32 v81, 0
    v_mov_b32 v82, 0
    v_mov_b32 v83, 0
    v_mov_b32 v84, 0
    v_mov_b32 v85, 0
    v_mov_b32 v86, 0
    v_mov_b32 v87, 0
    v_mov_b32 v88, 0
    v_mov_b32 v89, 0
    v_mov_b32 v90, 0
    v_mov_b32 v91, 0
    v_mov_b32 v92, 0
    v_mov_b32 v93, 0
    v_mov_b32 v94, 0
    v_mov_b32 v95, 0
    v_mov_b32 v20, 0
    v_mov_b32 v21, 0
    v_mov_b32 v22, 0
    v_mov_b32 v23, 0
    v_mov_b32 v24, 0
    v_mov_b32 v25, 0
    v_mov_b32 v26, 0
    v_mov_b32 v27, 0
    s_mov_b32 s32, 0
    s_mov_b32 s33, 0
    v_readfirstlane_b32 s3, v2
    s_mul_i32 s3, s3, 4096
    s_add_u32 s3, s3, 0
    s_mov_b32 m0, s3
    s_nop 0
    buffer_load_dwordx4 v4, s[8:11], s32 offen lds
    v_readfirstlane_b32 s3, v2
    s_mul_i32 s3, s3, 4096
    s_add_u32 s3, s3, 1024
    s_mov_b32 m0, s3
    s_nop 0
    buffer_load_dwordx4 v5, s[8:11], s32 offen lds
    v_readfirstlane_b32 s3, v2
    s_mul_i32 s3, s3, 4096
    s_add_u32 s3, s3, 2048
    s_mov_b32 m0, s3
    s_nop 0
    buffer_load_dwordx4 v6, s[8:11], s32 offen lds
    v_readfirstlane_b32 s3, v2
    s_mul_i32 s3, s3, 4096
    s_add_u32 s3, s3, 3072
    s_mov_b32 m0, s3
    s_nop 0
    buffer_load_dwordx4 v7, s[8:11], s32 offen lds
    v_readfirstlane_b32 s3, v2
    s_lshl_b32 s3, s3, 10
    s_add_u32 s3, s3, 16384
    s_mov_b32 m0, s3
    s_nop 0
    buffer_load_dwordx4 v8, s[12:15], s33 offen lds
    v_readfirstlane_b32 s3, v2
    s_lshl_b32 s3, s3, 10
    s_add_u32 s3, s3, 20480
    s_mov_b32 m0, s3
    s_nop 0
    buffer_load_dwordx4 v9, s[12:15], s33 offen lds
    s_add_u32 s32, s32, 128
    s_mul_i32 s3, s38, 64
    s_add_u32 s33, s33, s3
    s_mov_b32 s48, 0
il_opA0_kernel_loop:
    s_waitcnt vmcnt(0)
    s_barrier
    s_add_u32 s3, s48, 0
    s_cmp_ge_u32 s3, 9
    s_cbranch_scc1 il_opA0_kernel_nopf0
    v_readfirstlane_b32 s3, v2
    s_mul_i32 s3, s3, 4096
    s_add_u32 s3, s3, 24576
    s_mov_b32 m0, s3
    s_nop 0
    buffer_load_dwordx4 v4, s[8:11], s32 offen lds
    v_readfirstlane_b32 s3, v2
    s_mul_i32 s3, s3, 4096
    s_add_u32 s3, s3, 25600
    s_mov_b32 m0, s3
    s_nop 0
    buffer_load_dwordx4 v5, s[8:11], s32 offen lds
    v_readfirstlane_b32 s3, v2
    s_mul_i32 s3, s3, 4096
    s_add_u32 s3, s3, 26624
    s_mov_b32 m0, s3
    s_nop 0
    buffer_load_dwordx4 v6, s[8:11], s32 offen lds
    v_readfirstlane_b32 s3, v2
    s_mul_i32 s3, s3, 4096
    s_add_u32 s3, s3, 27648
    s_mov_b32 m0, s3
    s_nop 0
    buffer_load_dwordx4 v7, s[8:11], s32 offen lds
    v_readfirstlane_b32 s3, v2
    s_lshl_b32 s3, s3, 10
    s_add_u32 s3, s3, 40960
    s_mov_b32 m0, s3
    s_nop 0
    buffer_load_dwordx4 v8, s[12:15], s33 offen lds
    v_readfirstlane_b32 s3, v2
    s_lshl_b32 s3, s3, 10
    s_add_u32 s3, s3, 45056
    s_mov_b32 m0, s3
    s_nop 0
    buffer_load_dwordx4 v9, s[12:15], s33 offen lds
    s_add_u32 s32, s32, 128
    s_mul_i32 s3, s38, 64
    s_add_u32 s33, s33, s3
il_opA0_kernel_nopf0:
    ds_read_b128 v[32:35], v12 offset:0
    ds_read_b128 v[36:39], v12 offset:4096
    ds_read_b64_tr_b16 v[40:41], v16 offset:0
    ds_read_b64_tr_b16 v[42:43], v16 offset:256
    s_waitcnt lgkmcnt(0)
    ds_read_b128 v[44:47], v13 offset:0
    ds_read_b128 v[48:51], v13 offset:4096
    ds_read_b64_tr_b16 v[52:53], v16 offset:1024
    ds_read_b64_tr_b16 v[54:55], v16 offset:1280
    v_mfma_f32_32x32x16_bf16 v[64:79], v[40:43], v[32:35], v[64:79]
    v_mfma_f32_32x32x16_bf16 v[80:95], v[40:43], v[36:39], v[80:95]
    s_waitcnt lgkmcnt(0)
    ds_read_b128 v[32:35], v14 offset:0
    ds_read_b128 v[36:39], v14 offset:4096
    ds_read_b64_tr_b16 v[40:41], v16 offset:2048
    ds_read_b64_tr_b16 v[42:43], v16 offset:2304
    v_mfma_f32_32x32x16_bf16 v[64:79], v[52:55], v[44:47], v[64:79]
    v_mfma_f32_32x32x16_bf16 v[80:95], v[52:55], v[48:51], v[80:95]
    s_waitcnt lgkmcnt(0)
    ds_read_b128 v[44:47], v15 offset:0
    ds_read_b128 v[48:51], v15 offset:4096
    ds_read_b64_tr_b16 v[52:53], v16 offset:3072
    ds_read_b64_tr_b16 v[54:55], v16 offset:3328
    v_mfma_f32_32x32x16_bf16 v[64:79], v[40:43], v[32:35], v[64:79]
    v_mfma_f32_32x32x16_bf16 v[80:95], v[40:43], v[36:39], v[80:95]
    s_waitcnt lgkmcnt(0)
    v_mfma_f32_32x32x16_bf16 v[64:79], v[52:55], v[44:47], v[64:79]
    v_mfma_f32_32x32x16_bf16 v[80:95], v[52:55], v[48:51], v[80:95]
    s_waitcnt vmcnt(0)
    s_barrier
    s_add_u32 s3, s48, 1
    s_cmp_ge_u32 s3, 9
    s_cbranch_scc1 il_opA0_kernel_nopf1
    v_readfirstlane_b32 s3, v2
    s_mul_i32 s3, s3, 4096
    s_add_u32 s3, s3, 0
    s_mov_b32 m0, s3
    s_nop 0
    buffer_load_dwordx4 v4, s[8:11], s32 offen lds
    v_readfirstlane_b32 s3, v2
    s_mul_i32 s3, s3, 4096
    s_add_u32 s3, s3, 1024
    s_mov_b32 m0, s3
    s_nop 0
    buffer_load_dwordx4 v5, s[8:11], s32 offen lds
    v_readfirstlane_b32 s3, v2
    s_mul_i32 s3, s3, 4096
    s_add_u32 s3, s3, 2048
    s_mov_b32 m0, s3
    s_nop 0
    buffer_load_dwordx4 v6, s[8:11], s32 offen lds
    v_readfirstlane_b32 s3, v2
    s_mul_i32 s3, s3, 4096
    s_add_u32 s3, s3, 3072
    s_mov_b32 m0, s3
    s_nop 0
    buffer_load_dwordx4 v7, s[8:11], s32 offen lds
    v_readfirstlane_b32 s3, v2
    s_lshl_b32 s3, s3, 10
    s_add_u32 s3, s3, 16384
    s_mov_b32 m0, s3
    s_nop 0
    buffer_load_dwordx4 v8, s[12:15], s33 offen lds
    v_readfirstlane_b32 s3, v2
    s_lshl_b32 s3, s3, 10
    s_add_u32 s3, s3, 20480
    s_mov_b32 m0, s3
    s_nop 0
    buffer_load_dwordx4 v9, s[12:15], s33 offen lds
    s_add_u32 s32, s32, 128
    s_mul_i32 s3, s38, 64
    s_add_u32 s33, s33, s3
il_opA0_kernel_nopf1:
    ds_read_b128 v[32:35], v12 offset:24576
    ds_read_b128 v[36:39], v12 offset:28672
    ds_read_b64_tr_b16 v[40:41], v16 offset:24576
    ds_read_b64_tr_b16 v[42:43], v16 offset:24832
    s_waitcnt lgkmcnt(0)
    ds_read_b128 v[44:47], v13 offset:24576
    ds_read_b128 v[48:51], v13 offset:28672
    ds_read_b64_tr_b16 v[52:53], v16 offset:25600
    ds_read_b64_tr_b16 v[54:55], v16 offset:25856
    v_mfma_f32_32x32x16_bf16 v[64:79], v[40:43], v[32:35], v[64:79]
    v_mfma_f32_32x32x16_bf16 v[80:95], v[40:43], v[36:39], v[80:95]
    s_waitcnt lgkmcnt(0)
    ds_read_b128 v[32:35], v14 offset:24576
    ds_read_b128 v[36:39], v14 offset:28672
    ds_read_b64_tr_b16 v[40:41], v16 offset:26624
    ds_read_b64_tr_b16 v[42:43], v16 offset:26880
    v_mfma_f32_32x32x16_bf16 v[64:79], v[52:55], v[44:47], v[64:79]
    v_mfma_f32_32x32x16_bf16 v[80:95], v[52:55], v[48:51], v[80:95]
    s_waitcnt lgkmcnt(0)
    ds_read_b128 v[44:47], v15 offset:24576
    ds_read_b128 v[48:51], v15 offset:28672
    ds_read_b64_tr_b16 v[52:53], v16 offset:27648
    ds_read_b64_tr_b16 v[54:55], v16 offset:27904
    v_mfma_f32_32x32x16_bf16 v[64:79], v[40:43], v[32:35], v[64:79]
    v_mfma_f32_32x32x16_bf16 v[80:95], v[40:43], v[36:39], v[80:95]
    s_waitcnt lgkmcnt(0)
    v_mfma_f32_32x32x16_bf16 v[64:79], v[52:55], v[44:47], v[64:79]
    v_mfma_f32_32x32x16_bf16 v[80:95], v[52:55], v[48:51], v[80:95]
    s_add_u32 s48, s48, 2
    s_cmp_lt_u32 s48, 10
    s_cbranch_scc1 il_opA0_kernel_loop
    s_nop 15
    s_nop 7
    v_and_b32 v4, 31, v1
    v_and_b32 v5, 1, v2
    v_mul_u32_u24 v5, 64, v5
    v_add3_u32 v4, v4, v5, s34
    v_lshrrev_b32 v5, 1, v2
    v_mul_u32_u24 v5, 32, v5
    v_lshl_add_u32 v5, v3, 2, v5
    v_add_u32 v5, s35, v5
    v_add_u32 v8, 0, v4
    v_add_u32 v9, 0, v5
    v_mul_u32_u24 v10, 1280, v8
    v_lshl_add_u32 v10, v9, 1, v10
    buffer_load_dwordx2 v[12:13], v10, s[24:27], 0 offen
    v_cvt_pk_bf16_f32 v14, v64, v65
    v_cvt_pk_bf16_f32 v15, v66, v67
    s_waitcnt vmcnt(0)
    v_lshlrev_b32 v16, 16, v14
    v_and_b32 v17, 0xffff0000, v14
    v_lshlrev_b32 v18, 16, v12
    v_and_b32 v19, 0xffff0000, v12
    v_add_f32 v16, v16, v18
    v_add_f32 v17, v17, v19
    v_cvt_pk_bf16_f32 v14, v16, v17
    v_lshlrev_b32 v16, 16, v15
    v_and_b32 v17, 0xffff0000, v15
    v_lshlrev_b32 v18, 16, v13
    v_and_b32 v19, 0xffff0000, v13
    v_add_f32 v16, v16, v18
    v_add_f32 v17, v17, v19
    v_cvt_pk_bf16_f32 v15, v16, v17
    buffer_store_dwordx2 v[14:15], v10, s[20:23], 0 offen
    v_add_u32 v9, 8, v5
    v_mul_u32_u24 v10, 1280, v8
    v_lshl_add_u32 v10, v9, 1, v10
    buffer_load_dwordx2 v[12:13], v10, s[24:27], 0 offen
    v_cvt_pk_bf16_f32 v14, v68, v69
    v_cvt_pk_bf16_f32 v15, v70, v71
    s_waitcnt vmcnt(0)
    v_lshlrev_b32 v16, 16, v14
    v_and_b32 v17, 0xffff0000, v14
    v_lshlrev_b32 v18, 16, v12
    v_and_b32 v19, 0xffff0000, v12
    v_add_f32 v16, v16, v18
    v_add_f32 v17, v17, v19
    v_cvt_pk_bf16_f32 v14, v16, v17
    v_lshlrev_b32 v16, 16, v15
    v_and_b32 v17, 0xffff0000, v15
    v_lshlrev_b32 v18, 16, v13
    v_and_b32 v19, 0xffff0000, v13
    v_add_f32 v16, v16, v18
    v_add_f32 v17, v17, v19
    v_cvt_pk_bf16_f32 v15, v16, v17
    buffer_store_dwordx2 v[14:15], v10, s[20:23], 0 offen
    v_add_u32 v9, 16, v5
    v_mul_u32_u24 v10, 1280, v8
    v_lshl_add_u32 v10, v9, 1, v10
    buffer_load_dwordx2 v[12:13], v10, s[24:27], 0 offen
    v_cvt_pk_bf16_f32 v14, v72, v73
    v_cvt_pk_bf16_f32 v15, v74, v75
    s_waitcnt vmcnt(0)
    v_lshlrev_b32 v16, 16, v14
    v_and_b32 v17, 0xffff0000, v14
    v_lshlrev_b32 v18, 16, v12
    v_and_b32 v19, 0xffff0000, v12
    v_add_f32 v16, v16, v18
    v_add_f32 v17, v17, v19
    v_cvt_pk_bf16_f32 v14, v16, v17
    v_lshlrev_b32 v16, 16, v15
    v_and_b32 v17, 0xffff0000, v15
    v_lshlrev_b32 v18, 16, v13
    v_and_b32 v19, 0xffff0000, v13
    v_add_f32 v16, v16, v18
    v_add_f32 v17, v17, v19
    v_cvt_pk_bf16_f32 v15, v16, v17
    buffer_store_dwordx2 v[14:15], v10, s[20:23], 0 offen
    v_add_u32 v9, 24, v5
    v_mul_u32_u24 v10, 1280, v8
    v_lshl_add_u32 v10, v9, 1, v10
    buffer_load_dwordx2 v[12:13], v10, s[24:27], 0 offen
    v_cvt_pk_bf16_f32 v14, v76, v77
    v_cvt_pk_bf16_f32 v15, v78, v79
    s_waitcnt vmcnt(0)
    v_lshlrev_b32 v16, 16, v14
    v_and_b32 v17, 0xffff0000, v14
    v_lshlrev_b32 v18, 16, v12
    v_and_b32 v19, 0xffff0000, v12
    v_add_f32 v16, v16, v18
    v_add_f32 v17, v17, v19
    v_cvt_pk_bf16_f32 v14, v16, v17
    v_lshlrev_b32 v16, 16, v15
    v_and_b32 v17, 0xffff0000, v15
    v_lshlrev_b32 v18, 16, v13
    v_and_b32 v19, 0xffff0000, v13
    v_add_f32 v16, v16, v18
    v_add_f32 v17, v17, v19
    v_cvt_pk_bf16_f32 v15, v16, v17
    buffer_store_dwordx2 v[14:15], v10, s[20:23], 0 offen
    v_add_u32 v8, 32, v4
    v_add_u32 v9, 0, v5
    v_mul_u32_u24 v10, 1280, v8
    v_lshl_add_u32 v10, v9, 1, v10
    buffer_load_dwordx2 v[12:13], v10, s[24:27], 0 offen
    v_cvt_pk_bf16_f32 v14, v80, v81
    v_cvt_pk_bf16_f32 v15, v82, v83
    s_waitcnt vmcnt(0)
    v_lshlrev_b32 v16, 16, v14
    v_and_b32 v17, 0xffff0000, v14
    v_lshlrev_b32 v18, 16, v12
    v_and_b32 v19, 0xffff0000, v12
    v_add_f32 v16, v16, v18
    v_add_f32 v17, v17, v19
    v_cvt_pk_bf16_f32 v14, v16, v17
    v_lshlrev_b32 v16, 16, v15
    v_and_b32 v17, 0xffff0000, v15
    v_lshlrev_b32 v18, 16, v13
    v_and_b32 v19, 0xffff0000, v13
    v_add_f32 v16, v16, v18
    v_add_f32 v17, v17, v19
    v_cvt_pk_bf16_f32 v15, v16, v17
    buffer_store_dwordx2 v[14:15], v10, s[20:23], 0 offen
    v_add_u32 v9, 8, v5
    v_mul_u32_u24 v10, 1280, v8
    v_lshl_add_u32 v10, v9, 1, v10
    buffer_load_dwordx2 v[12:13], v10, s[24:27], 0 offen
    v_cvt_pk_bf16_f32 v14, v84, v85
    v_cvt_pk_bf16_f32 v15, v86, v87
    s_waitcnt vmcnt(0)
    v_lshlrev_b32 v16, 16, v14
    v_and_b32 v17, 0xffff0000, v14
    v_lshlrev_b32 v18, 16, v12
    v_and_b32 v19, 0xffff0000, v12
    v_add_f32 v16, v16, v18
    v_add_f32 v17, v17, v19
    v_cvt_pk_bf16_f32 v14, v16, v17
    v_lshlrev_b32 v16, 16, v15
    v_and_b32 v17, 0xffff0000, v15
    v_lshlrev_b32 v18, 16, v13
    v_and_b32 v19, 0xffff0000, v13
    v_add_f32 v16, v16, v18
    v_add_f32 v17, v17, v19
    v_cvt_pk_bf16_f32 v15, v16, v17
    buffer_store_dwordx2 v[14:15], v10, s[20:23], 0 offen
    v_add_u32 v9, 16, v5
    v_mul_u32_u24 v10, 1280, v8
    v_lshl_add_u32 v10, v9, 1, v10
    buffer_load_dwordx2 v[12:13], v10, s[24:27], 0 offen
    v_cvt_pk_bf16_f32 v14, v88, v89
    v_cvt_pk_bf16_f32 v15, v90, v91
    s_waitcnt vmcnt(0)
    v_lshlrev_b32 v16, 16, v14
    v_and_b32 v17, 0xffff0000, v14
    v_lshlrev_b32 v18, 16, v12
    v_and_b32 v19, 0xffff0000, v12
    v_add_f32 v16, v16, v18
    v_add_f32 v17, v17, v19
    v_cvt_pk_bf16_f32 v14, v16, v17
    v_lshlrev_b32 v16, 16, v15
    v_and_b32 v17, 0xffff0000, v15
    v_lshlrev_b32 v18, 16, v13
    v_and_b32 v19, 0xffff0000, v13
    v_add_f32 v16, v16, v18
    v_add_f32 v17, v17, v19
    v_cvt_pk_bf16_f32 v15, v16, v17
    buffer_store_dwordx2 v[14:15], v10, s[20:23], 0 offen
    v_add_u32 v9, 24, v5
    v_mul_u32_u24 v10, 1280, v8
    v_lshl_add_u32 v10, v9, 1, v10
    buffer_load_dwordx2 v[12:13], v10, s[24:27], 0 offen
    v_cvt_pk_bf16_f32 v14, v92, v93
    v_cvt_pk_bf16_f32 v15, v94, v95
    s_waitcnt vmcnt(0)
    v_lshlrev_b32 v16, 16, v14
    v_and_b32 v17, 0xffff0000, v14
    v_lshlrev_b32 v18, 16, v12
    v_and_b32 v19, 0xffff0000, v12
    v_add_f32 v16, v16, v18
    v_add_f32 v17, v17, v19
    v_cvt_pk_bf16_f32 v14, v16, v17
    v_lshlrev_b32 v16, 16, v15
    v_and_b32 v17, 0xffff0000, v15
    v_lshlrev_b32 v18, 16, v13
    v_and_b32 v19, 0xffff0000, v13
    v_add_f32 v16, v16, v18
    v_add_f32 v17, v17, v19
    v_cvt_pk_bf16_f32 v15, v16, v17
    buffer_store_dwordx2 v[14:15], v10, s[20:23], 0 offen
    s_waitcnt vmcnt(0)
il_opA0_kernel_done:
    s_endpgm
.globl il_qkvB0_kernel
.p2align 8
.type il_qkvB0_kernel,@function
il_qkvB0_kernel:
    s_cmp_ge_u32 s2, 240
    s_cbranch_scc1 il_qkvB0_kernel_done
    s_load_dwordx2 s[4:5], s[0:1], 80
    s_load_dwordx2 s[12:13], s[0:1], 48
    s_and_b32 s34, s2, 15
    s_lshr_b32 s35, s2, 4
    s_mov_b32 s37, s35
    s_mul_i32 s34, s34, 128
    s_mul_i32 s35, s35, 128
    v_and_b32 v1, 63, v0
    v_lshrrev_b32 v2, 6, v0
    v_lshrrev_b32 v3, 5, v1
    s_waitcnt lgkmcnt(0)
    s_add_u32 s8, s4, 0
    s_addc_u32 s9, s5, 0
    s_mov_b32 s10, 2621440
    s_mov_b32 s11, 0x00020000
    s_mov_b32 s14, 2457600
    s_mov_b32 s15, 0x00020000
    s_add_u32 s20, s4, 7864320
    s_addc_u32 s21, s5, 0
    s_mov_b32 s22, 2621440
    s_mov_b32 s23, 0x00020000
    s_add_u32 s24, s4, 13107200
    s_addc_u32 s25, s5, 0
    s_mov_b32 s26, 4194304
    s_mov_b32 s27, 0x00020000
    s_add_u32 s28, s4, 17301504
    s_addc_u32 s29, s5, 0
    s_mov_b32 s30, 4194304
    s_mov_b32 s31, 0x00020000
    s_mov_b32 s36, 0x3f803f80
    v_lshrrev_b32 v17, 3, v1
    v_mul_u32_u24 v18, 32, v2
    v_add_u32 v18, v18, v17
    v_and_b32 v19, 7, v1
    v_lshrrev_b32 v16, 1, v17
    v_xor_b32 v16, v16, v19
    v_lshlrev_b32 v16, 4, v16
    v_add_u32 v4, s34, v18
    v_add_u32 v4, 0, v4
    s_mov_b32 s3, 1280
    v_mul_lo_u32 v4, v4, s3
    v_add_u32 v4, v4, v16
    v_lshrrev_b32 v16, 1, v17
    v_xor_b32 v16, 4, v16
    v_xor_b32 v16, v16, v19
    v_lshlrev_b32 v16, 4, v16
    v_add_u32 v5, s34, v18
    v_add_u32 v5, 8, v5
    s_mov_b32 s3, 1280
    v_mul_lo_u32 v5, v5, s3
    v_add_u32 v5, v5, v16
    v_lshrrev_b32 v16, 1, v17
    v_xor_b32 v16, v16, v19
    v_lshlrev_b32 v16, 4, v16
    v_add_u32 v6, s34, v18
    v_add_u32 v6, 16, v6
    s_mov_b32 s3, 1280
    v_mul_lo_u32 v6, v6, s3
    v_add_u32 v6, v6, v16
    v_lshrrev_b32 v16, 1, v17
    v_xor_b32 v16, 4, v16
    v_xor_b32 v16, v16, v19
    v_lshlrev_b32 v16, 4, v16
    v_add_u32 v7, s34, v18
    v_add_u32 v7, 24, v7
    s_mov_b32 s3, 1280
    v_mul_lo_u32 v7, v7, s3
    v_add_u32 v7, v7, v16
    v_lshrrev_b32 v16, 2, v1
    v_lshl_add_u32 v16, v2, 4, v16
    v_and_b32 v17, 3, v1
    v_lshlrev_b32 v17, 4, v17
    s_mov_b32 s38, 3840
    s_mov_b32 s39, s35
    v_mul_lo_u32 v16, v16, s38
    v_add_u32 v16, v16, v17
    s_lshl_b32 s3, s39, 1
    v_add_u32 v8, s3, v16
    v_add_u32 v9, 64, v8
    v_add_u32 v10, 128, v8
    v_add_u32 v11, 192, v8
    v_and_b32 v16, 31, v1
    v_and_b32 v17, 1, v2
    v_mul_u32_u24 v17, 64, v17
    v_add_u32 v17, v17, v16
    v_lshrrev_b32 v16, 1, v16
    v_and_b32 v16, 7, v16
    v_lshlrev_b32 v17, 7, v17
    v_add_u32 v18, 0, v3
    v_xor_b32 v18, v18, v16
    v_lshl_add_u32 v12, v18, 4, v17
    v_add_u32 v18, 2, v3
    v_xor_b32 v18, v18, v16
    v_lshl_add_u32 v13, v18, 4, v17
    v_add_u32 v18, 4, v3
    v_xor_b32 v18, v18, v16
    v_lshl_add_u32 v14, v18, 4, v17
    v_add_u32 v18, 6, v3
    v_xor_b32 v18, v18, v16
    v_lshl_add_u32 v15, v18, 4, v17
    v_lshrrev_b32 v17, 4, v1
    v_and_b32 v17, 1, v17
    v_lshlrev_b32 v17, 5, v17
    v_and_b32 v18, 15, v1
    v_lshrrev_b32 v18, 2, v18
    v_lshl_add_u32 v18, v3, 3, v18
    v_lshl_add_u32 v17, v18, 6, v17
    v_and_b32 v18, 3, v1
    v_lshl_add_u32 v17, v18, 3, v17
    v_lshrrev_b32 v18, 1, v2
    v_mul_u32_u24 v18, 8192, v18
    v_add3_u32 v16, v17, v18, 0
    v_add_u32 v16, 16384, v16
    v_mov_b32 v64, 0
    v_mov_b32 v65, 0
    v_mov_b32 v66, 0
    v_mov_b32 v67, 0
    v_mov_b32 v68, 0
    v_mov_b32 v69, 0
    v_mov_b32 v70, 0
    v_mov_b32 v71, 0
    v_mov_b32 v72, 0
    v_mov_b32 v73, 0
    v_mov_b32 v74, 0
    v_mov_b32 v75, 0
    v_mov_b32 v76, 0
    v_mov_b32 v77, 0
    v_mov_b32 v78, 0
    v_mov_b32 v79, 0
    v_mov_b32 v80, 0
    v_mov_b32 v81, 0
    v_mov_b32 v82, 0
    v_mov_b32 v83, 0
    v_mov_b32 v84, 0
    v_mov_b32 v85, 0
    v_mov_b32 v86, 0
    v_mov_b32 v87, 0
    v_mov_b32 v88, 0
    v_mov_b32 v89, 0
    v_mov_b32 v90, 0
    v_mov_b32 v91, 0
    v_mov_b32 v92, 0
    v_mov_b32 v93, 0
    v_mov_b32 v94, 0
    v_mov_b32 v95, 0
    v_mov_b32 v96, 0
    v_mov_b32 v97, 0
    v_mov_b32 v98, 0
    v_mov_b32 v99, 0
    v_mov_b32 v100, 0
    v_mov_b32 v101, 0
    v_mov_b32 v102, 0
    v_mov_b32 v103, 0
    v_mov_b32 v104, 0
    v_mov_b32 v105, 0
    v_mov_b32 v106, 0
    v_mov_b32 v107, 0
    v_mov_b32 v108, 0
    v_mov_b32 v109, 0
    v_mov_b32 v110, 0
    v_mov_b32 v111, 0
    v_mov_b32 v112, 0
    v_mov_b32 v113, 0
    v_mov_b32 v114, 0
    v_mov_b32 v115, 0
    v_mov_b32 v116, 0
    v_mov_b32 v117, 0
    v_mov_b32 v118, 0
    v_mov_b32 v119, 0
    v_mov_b32 v120, 0
    v_mov_b32 v121, 0
    v_mov_b32 v122, 0
    v_mov_b32 v123, 0
    v_mov_b32 v124, 0
    v_mov_b32 v125, 0
    v_mov_b32 v126, 0
    v_mov_b32 v127, 0
    v_mov_b32 v20, 0
    v_mov_b32 v21, 0
    v_mov_b32 v22, 0
    v_mov_b32 v23, 0
    v_mov_b32 v24, 0
    v_mov_b32 v25, 0
    v_mov_b32 v26, 0
    v_mov_b32 v27, 0
    s_mov_b32 s32, 0
    s_mov_b32 s33, 0
    v_readfirstlane_b32 s3, v2
    s_mul_i32 s3, s3, 4096
    s_add_u32 s3, s3, 0
    s_mov_b32 m0, s3
    s_nop 0
    buffer_load_dwordx4 v4, s[8:11], s32 offen lds
    v_readfirstlane_b32 s3, v2
    s_mul_i32 s3, s3, 4096
    s_add_u32 s3, s3, 1024
    s_mov_b32 m0, s3
    s_nop 0
    buffer_load_dwordx4 v5, s[8:11], s32 offen lds
    v_readfirstlane_b32 s3, v2
    s_mul_i32 s3, s3, 4096
    s_add_u32 s3, s3, 2048
    s_mov_b32 m0, s3
    s_nop 0
    buffer_load_dwordx4 v6, s[8:11], s32 offen lds
    v_readfirstlane_b32 s3, v2
    s_mul_i32 s3, s3, 4096
    s_add_u32 s3, s3, 3072
    s_mov_b32 m0, s3
    s_nop 0
    buffer_load_dwordx4 v7, s[8:11], s32 offen lds
    v_readfirstlane_b32 s3, v2
    s_lshl_b32 s3, s3, 10
    s_add_u32 s3, s3, 16384
    s_mov_b32 m0, s3
    s_nop 0
    buffer_load_dwordx4 v8, s[12:15], s33 offen lds
    v_readfirstlane_b32 s3, v2
    s_lshl_b32 s3, s3, 10
    s_add_u32 s3, s3, 20480
    s_mov_b32 m0, s3
    s_nop 0
    buffer_load_dwordx4 v9, s[12:15], s33 offen lds
    v_readfirstlane_b32 s3, v2
    s_lshl_b32 s3, s3, 10
    s_add_u32 s3, s3, 24576
    s_mov_b32 m0, s3
    s_nop 0
    buffer_load_dwordx4 v10, s[12:15], s33 offen lds
    v_readfirstlane_b32 s3, v2
    s_lshl_b32 s3, s3, 10
    s_add_u32 s3, s3, 28672
    s_mov_b32 m0, s3
    s_nop 0
    buffer_load_dwordx4 v11, s[12:15], s33 offen lds
    s_add_u32 s32, s32, 128
    s_mul_i32 s3, s38, 64
    s_add_u32 s33, s33, s3
    s_mov_b32 s48, 0
il_qkvB0_kernel_loop:
    s_waitcnt vmcnt(0)
    s_barrier
    s_add_u32 s3, s48, 0
    s_cmp_ge_u32 s3, 9
    s_cbranch_scc1 il_qkvB0_kernel_nopf0
    v_readfirstlane_b32 s3, v2
    s_mul_i32 s3, s3, 4096
    s_add_u32 s3, s3, 32768
    s_mov_b32 m0, s3
    s_nop 0
    buffer_load_dwordx4 v4, s[8:11], s32 offen lds
    v_readfirstlane_b32 s3, v2
    s_mul_i32 s3, s3, 4096
    s_add_u32 s3, s3, 33792
    s_mov_b32 m0, s3
    s_nop 0
    buffer_load_dwordx4 v5, s[8:11], s32 offen lds
    v_readfirstlane_b32 s3, v2
    s_mul_i32 s3, s3, 4096
    s_add_u32 s3, s3, 34816
    s_mov_b32 m0, s3
    s_nop 0
    buffer_load_dwordx4 v6, s[8:11], s32 offen lds
    v_readfirstlane_b32 s3, v2
    s_mul_i32 s3, s3, 4096
    s_add_u32 s3, s3, 35840
    s_mov_b32 m0, s3
    s_nop 0
    buffer_load_dwordx4 v7, s[8:11], s32 offen lds
    v_readfirstlane_b32 s3, v2
    s_lshl_b32 s3, s3, 10
    s_add_u32 s3, s3, 49152
    s_mov_b32 m0, s3
    s_nop 0
    buffer_load_dwordx4 v8, s[12:15], s33 offen lds
    v_readfirstlane_b32 s3, v2
    s_lshl_b32 s3, s3, 10
    s_add_u32 s3, s3, 53248
    s_mov_b32 m0, s3
    s_nop 0
    buffer_load_dwordx4 v9, s[12:15], s33 offen lds
    v_readfirstlane_b32 s3, v2
    s_lshl_b32 s3, s3, 10
    s_add_u32 s3, s3, 57344
    s_mov_b32 m0, s3
    s_nop 0
    buffer_load_dwordx4 v10, s[12:15], s33 offen lds
    v_readfirstlane_b32 s3, v2
    s_lshl_b32 s3, s3, 10
    s_add_u32 s3, s3, 61440
    s_mov_b32 m0, s3
    s_nop 0
    buffer_load_dwordx4 v11, s[12:15], s33 offen lds
    s_add_u32 s32, s32, 128
    s_mul_i32 s3, s38, 64
    s_add_u32 s33, s33, s3
il_qkvB0_kernel_nopf0:
    ds_read_b128 v[32:35], v12 offset:0
    ds_read_b128 v[36:39], v12 offset:4096
    ds_read_b64_tr_b16 v[40:41], v16 offset:0
    ds_read_b64_tr_b16 v[42:43], v16 offset:256
    ds_read_b64_tr_b16 v[44:45], v16 offset:4096
    ds_read_b64_tr_b16 v[46:47], v16 offset:4352
    s_waitcnt lgkmcnt(0)
    ds_read_b128 v[48:51], v13 offset:0
    ds_read_b128 v[52:55], v13 offset:4096
    ds_read_b64_tr_b16 v[56:57], v16 offset:1024
    ds_read_b64_tr_b16 v[58:59], v16 offset:1280
    ds_read_b64_tr_b16 v[60:61], v16 offset:5120
    ds_read_b64_tr_b16 v[62:63], v16 offset:5376
    v_mfma_f32_32x32x16_bf16 v[64:79], v[40:43], v[32:35], v[64:79]
    v_mfma_f32_32x32x16_bf16 v[80:95], v[40:43], v[36:39], v[80:95]
    v_mfma_f32_32x32x16_bf16 v[96:111], v[44:47], v[32:35], v[96:111]
    v_mfma_f32_32x32x16_bf16 v[112:127], v[44:47], v[36:39], v[112:127]
    v_dot2_f32_bf16 v22, v32, v32, v22
    v_dot2_f32_bf16 v20, v32, s36, v20
    v_dot2_f32_bf16 v22, v33, v33, v22
    v_dot2_f32_bf16 v20, v33, s36, v20
    v_dot2_f32_bf16 v22, v34, v34, v22
    v_dot2_f32_bf16 v20, v34, s36, v20
    v_dot2_f32_bf16 v22, v35, v35, v22
    v_dot2_f32_bf16 v20, v35, s36, v20
    v_dot2_f32_bf16 v23, v36, v36, v23
    v_dot2_f32_bf16 v21, v36, s36, v21
    v_dot2_f32_bf16 v23, v37, v37, v23
    v_dot2_f32_bf16 v21, v37, s36, v21
    v_dot2_f32_bf16 v23, v38, v38, v23
    v_dot2_f32_bf16 v21, v38, s36, v21
    v_dot2_f32_bf16 v23, v39, v39, v23
    v_dot2_f32_bf16 v21, v39, s36, v21
    v_dot2_f32_bf16 v24, v40, s36, v24
    v_dot2_f32_bf16 v24, v41, s36, v24
    v_dot2_f32_bf16 v24, v42, s36, v24
    v_dot2_f32_bf16 v24, v43, s36, v24
    v_dot2_f32_bf16 v25, v44, s36, v25
    v_dot2_f32_bf16 v25, v45, s36, v25
    v_dot2_f32_bf16 v25, v46, s36, v25
    v_dot2_f32_bf16 v25, v47, s36, v25
    s_waitcnt lgkmcnt(0)
    ds_read_b128 v[32:35], v14 offset:0
    ds_read_b128 v[36:39], v14 offset:4096
    ds_read_b64_tr_b16 v[40:41], v16 offset:2048
    ds_read_b64_tr_b16 v[42:43], v16 offset:2304
    ds_read_b64_tr_b16 v[44:45], v16 offset:6144
    ds_read_b64_tr_b16 v[46:47], v16 offset:6400
    v_mfma_f32_32x32x16_bf16 v[64:79], v[56:59], v[48:51], v[64:79]
    v_mfma_f32_32x32x16_bf16 v[80:95], v[56:59], v[52:55], v[80:95]
    v_mfma_f32_32x32x16_bf16 v[96:111], v[60:63], v[48:51], v[96:111]
    v_mfma_f32_32x32x16_bf16 v[112:127], v[60:63], v[52:55], v[112:127]
    v_dot2_f32_bf16 v22, v48, v48, v22
    v_dot2_f32_bf16 v20, v48, s36, v20
    v_dot2_f32_bf16 v22, v49, v49, v22
    v_dot2_f32_bf16 v20, v49, s36, v20
    v_dot2_f32_bf16 v22, v50, v50, v22
    v_dot2_f32_bf16 v20, v50, s36, v20
    v_dot2_f32_bf16 v22, v51, v51, v22
    v_dot2_f32_bf16 v20, v51, s36, v20
    v_dot2_f32_bf16 v23, v52, v52, v23
    v_dot2_f32_bf16 v21, v52, s36, v21
    v_dot2_f32_bf16 v23, v53, v53, v23
    v_dot2_f32_bf16 v21, v53, s36, v21
    v_dot2_f32_bf16 v23, v54, v54, v23
    v_dot2_f32_bf16 v21, v54, s36, v21
    v_dot2_f32_bf16 v23, v55, v55, v23
    v_dot2_f32_bf16 v21, v55, s36, v21
    v_dot2_f32_bf16 v24, v56, s36, v24
    v_dot2_f32_bf16 v24, v57, s36, v24
    v_dot2_f32_bf16 v24, v58, s36, v24
    v_dot2_f32_bf16 v24, v59, s36, v24
    v_dot2_f32_bf16 v25, v60, s36, v25
    v_dot2_f32_bf16 v25, v61, s36, v25
    v_dot2_f32_bf16 v25, v62, s36, v25
    v_dot2_f32_bf16 v25, v63, s36, v25
    s_waitcnt lgkmcnt(0)
    ds_read_b128 v[48:51], v15 offset:0
    ds_read_b128 v[52:55], v15 offset:4096
    ds_read_b64_tr_b16 v[56:57], v16 offset:3072
    ds_read_b64_tr_b16 v[58:59], v16 offset:3328
    ds_read_b64_tr_b16 v[60:61], v16 offset:7168
    ds_read_b64_tr_b16 v[62:63], v16 offset:7424
    v_mfma_f32_32x32x16_bf16 v[64:79], v[40:43], v[32:35], v[64:79]
    v_mfma_f32_32x32x16_bf16 v[80:95], v[40:43], v[36:39], v[80:95]
    v_mfma_f32_32x32x16_bf16 v[96:111], v[44:47], v[32:35], v[96:111]
    v_mfma_f32_32x32x16_bf16 v[112:127], v[44:47], v[36:39], v[112:127]
    v_dot2_f32_bf16 v22, v32, v32, v22
    v_dot2_f32_bf16 v20, v32, s36, v20
    v_dot2_f32_bf16 v22, v33, v33, v22
    v_dot2_f32_bf16 v20, v33, s36, v20
    v_dot2_f32_bf16 v22, v34, v34, v22
    v_dot2_f32_bf16 v20, v34, s36, v20
    v_dot2_f32_bf16 v22, v35, v35, v22
    v_dot2_f32_bf16 v20, v35, s36, v20
    v_dot2_f32_bf16 v23, v36, v36, v23
    v_dot2_f32_bf16 v21, v36, s36, v21
    v_dot2_f32_bf16 v23, v37, v37, v23
    v_dot2_f32_bf16 v21, v37, s36, v21
    v_dot2_f32_bf16 v23, v38, v38, v23
    v_dot2_f32_bf16 v21, v38, s36, v21
    v_dot2_f32_bf16 v23, v39, v39, v23
    v_dot2_f32_bf16 v21, v39, s36, v21
    v_dot2_f32_bf16 v24, v40, s36, v24
    v_dot2_f32_bf16 v24, v41, s36, v24
    v_dot2_f32_bf16 v24, v42, s36, v24
    v_dot2_f32_bf16 v24, v43, s36, v24
    v_dot2_f32_bf16 v25, v44, s36, v25
    v_dot2_f32_bf16 v25, v45, s36, v25
    v_dot2_f32_bf16 v25, v46, s36, v25
    v_dot2_f32_bf16 v25, v47, s36, v25
    s_waitcnt lgkmcnt(0)
    v_mfma_f32_32x32x16_bf16 v[64:79], v[56:59], v[48:51], v[64:79]
    v_mfma_f32_32x32x16_bf16 v[80:95], v[56:59], v[52:55], v[80:95]
    v_mfma_f32_32x32x16_bf16 v[96:111], v[60:63], v[48:51], v[96:111]
    v_mfma_f32_32x32x16_bf16 v[112:127], v[60:63], v[52:55], v[112:127]
    v_dot2_f32_bf16 v22, v48, v48, v22
    v_dot2_f32_bf16 v20, v48, s36, v20
    v_dot2_f32_bf16 v22, v49, v49, v22
    v_dot2_f32_bf16 v20, v49, s36, v20
    v_dot2_f32_bf16 v22, v50, v50, v22
    v_dot2_f32_bf16 v20, v50, s36, v20
    v_dot2_f32_bf16 v22, v51, v51, v22
    v_dot2_f32_bf16 v20, v51, s36, v20
    v_dot2_f32_bf16 v23, v52, v52, v23
    v_dot2_f32_bf16 v21, v52, s36, v21
    v_dot2_f32_bf16 v23, v53, v53, v23
    v_dot2_f32_bf16 v21, v53, s36, v21
    v_dot2_f32_bf16 v23, v54, v54, v23
    v_dot2_f32_bf16 v21, v54, s36, v21
    v_dot2_f32_bf16 v23, v55, v55, v23
    v_dot2_f32_bf16 v21, v55, s36, v21
    v_dot2_f32_bf16 v24, v56, s36, v24
    v_dot2_f32_bf16 v24, v57, s36, v24
    v_dot2_f32_bf16 v24, v58, s36, v24
    v_dot2_f32_bf16 v24, v59, s36, v24
    v_dot2_f32_bf16 v25, v60, s36, v25
    v_dot2_f32_bf16 v25, v61, s36, v25
    v_dot2_f32_bf16 v25, v62, s36, v25
    v_dot2_f32_bf16 v25, v63, s36, v25
    s_waitcnt vmcnt(0)
    s_barrier
    s_add_u32 s3, s48, 1
    s_cmp_ge_u32 s3, 9
    s_cbranch_scc1 il_qkvB0_kernel_nopf1
    v_readfirstlane_b32 s3, v2
    s_mul_i32 s3, s3, 4096
    s_add_u32 s3, s3, 0
    s_mov_b32 m0, s3
    s_nop 0
    buffer_load_dwordx4 v4, s[8:11], s32 offen lds
    v_readfirstlane_b32 s3, v2
    s_mul_i32 s3, s3, 4096
    s_add_u32 s3, s3, 1024
    s_mov_b32 m0, s3
    s_nop 0
    buffer_load_dwordx4 v5, s[8:11], s32 offen lds
    v_readfirstlane_b32 s3, v2
    s_mul_i32 s3, s3, 4096
    s_add_u32 s3, s3, 2048
    s_mov_b32 m0, s3
    s_nop 0
    buffer_load_dwordx4 v6, s[8:11], s32 offen lds
    v_readfirstlane_b32 s3, v2
    s_mul_i32 s3, s3, 4096
    s_add_u32 s3, s3, 3072
    s_mov_b32 m0, s3
    s_nop 0
    buffer_load_dwordx4 v7, s[8:11], s32 offen lds
    v_readfirstlane_b32 s3, v2
    s_lshl_b32 s3, s3, 10
    s_add_u32 s3, s3, 16384
    s_mov_b32 m0, s3
    s_nop 0
    buffer_load_dwordx4 v8, s[12:15], s33 offen lds
    v_readfirstlane_b32 s3, v2
    s_lshl_b32 s3, s3, 10
    s_add_u32 s3, s3, 20480
    s_mov_b32 m0, s3
    s_nop 0
    buffer_load_dwordx4 v9, s[12:15], s33 offen lds
    v_readfirstlane_b32 s3, v2
    s_lshl_b32 s3, s3, 10
    s_add_u32 s3, s3, 24576
    s_mov_b32 m0, s3
    s_nop 0
    buffer_load_dwordx4 v10, s[12:15], s33 offen lds
    v_readfirstlane_b32 s3, v2
    s_lshl_b32 s3, s3, 10
    s_add_u32 s3, s3, 28672
    s_mov_b32 m0, s3
    s_nop 0
    buffer_load_dwordx4 v11, s[12:15], s33 offen lds
    s_add_u32 s32, s32, 128
    s_mul_i32 s3, s38, 64
    s_add_u32 s33, s33, s3
il_qkvB0_kernel_nopf1:
    ds_read_b128 v[32:35], v12 offset:32768
    ds_read_b128 v[36:39], v12 offset:36864
    ds_read_b64_tr_b16 v[40:41], v16 offset:32768
    ds_read_b64_tr_b16 v[42:43], v16 offset:33024
    ds_read_b64_tr_b16 v[44:45], v16 offset:36864
    ds_read_b64_tr_b16 v[46:47], v16 offset:37120
    s_waitcnt lgkmcnt(0)
    ds_read_b128 v[48:51], v13 offset:32768
    ds_read_b128 v[52:55], v13 offset:36864
    ds_read_b64_tr_b16 v[56:57], v16 offset:33792
    ds_read_b64_tr_b16 v[58:59], v16 offset:34048
    ds_read_b64_tr_b16 v[60:61], v16 offset:37888
    ds_read_b64_tr_b16 v[62:63], v16 offset:38144
    v_mfma_f32_32x32x16_bf16 v[64:79], v[40:43], v[32:35], v[64:79]
    v_mfma_f32_32x32x16_bf16 v[80:95], v[40:43], v[36:39], v[80:95]
    v_mfma_f32_32x32x16_bf16 v[96:111], v[44:47], v[32:35], v[96:111]
    v_mfma_f32_32x32x16_bf16 v[112:127], v[44:47], v[36:39], v[112:127]
    v_dot2_f32_bf16 v22, v32, v32, v22
    v_dot2_f32_bf16 v20, v32, s36, v20
    v_dot2_f32_bf16 v22, v33, v33, v22
    v_dot2_f32_bf16 v20, v33, s36, v20
    v_dot2_f32_bf16 v22, v34, v34, v22
    v_dot2_f32_bf16 v20, v34, s36, v20
    v_dot2_f32_bf16 v22, v35, v35, v22
    v_dot2_f32_bf16 v20, v35, s36, v20
    v_dot2_f32_bf16 v23, v36, v36, v23
    v_dot2_f32_bf16 v21, v36, s36, v21
    v_dot2_f32_bf16 v23, v37, v37, v23
    v_dot2_f32_bf16 v21, v37, s36, v21
    v_dot2_f32_bf16 v23, v38, v38, v23
    v_dot2_f32_bf16 v21, v38, s36, v21
    v_dot2_f32_bf16 v23, v39, v39, v23
    v_dot2_f32_bf16 v21, v39, s36, v21
    v_dot2_f32_bf16 v24, v40, s36, v24
    v_dot2_f32_bf16 v24, v41, s36, v24
    v_dot2_f32_bf16 v24, v42, s36, v24
    v_dot2_f32_bf16 v24, v43, s36, v24
    v_dot2_f32_bf16 v25, v44, s36, v25
    v_dot2_f32_bf16 v25, v45, s36, v25
    v_dot2_f32_bf16 v25, v46, s36, v25
    v_dot2_f32_bf16 v25, v47, s36, v25
    s_waitcnt lgkmcnt(0)
    ds_read_b128 v[32:35], v14 offset:32768
    ds_read_b128 v[36:39], v14 offset:36864
    ds_read_b64_tr_b16 v[40:41], v16 offset:34816
    ds_read_b64_tr_b16 v[42:43], v16 offset:35072
    ds_read_b64_tr_b16 v[44:45], v16 offset:38912
    ds_read_b64_tr_b16 v[46:47], v16 offset:39168
    v_mfma_f32_32x32x16_bf16 v[64:79], v[56:59], v[48:51], v[64:79]
    v_mfma_f32_32x32x16_bf16 v[80:95], v[56:59], v[52:55], v[80:95]
    v_mfma_f32_32x32x16_bf16 v[96:111], v[60:63], v[48:51], v[96:111]
    v_mfma_f32_32x32x16_bf16 v[112:127], v[60:63], v[52:55], v[112:127]
    v_dot2_f32_bf16 v22, v48, v48, v22
    v_dot2_f32_bf16 v20, v48, s36, v20
    v_dot2_f32_bf16 v22, v49, v49, v22
    v_dot2_f32_bf16 v20, v49, s36, v20
    v_dot2_f32_bf16 v22, v50, v50, v22
    v_dot2_f32_bf16 v20, v50, s36, v20
    v_dot2_f32_bf16 v22, v51, v51, v22
    v_dot2_f32_bf16 v20, v51, s36, v20
    v_dot2_f32_bf16 v23, v52, v52, v23
    v_dot2_f32_bf16 v21, v52, s36, v21
    v_dot2_f32_bf16 v23, v53, v53, v23
    v_dot2_f32_bf16 v21, v53, s36, v21
    v_dot2_f32_bf16 v23, v54, v54, v23
    v_dot2_f32_bf16 v21, v54, s36, v21
    v_dot2_f32_bf16 v23, v55, v55, v23
    v_dot2_f32_bf16 v21, v55, s36, v21
    v_dot2_f32_bf16 v24, v56, s36, v24
    v_dot2_f32_bf16 v24, v57, s36, v24
    v_dot2_f32_bf16 v24, v58, s36, v24
    v_dot2_f32_bf16 v24, v59, s36, v24
    v_dot2_f32_bf16 v25, v60, s36, v25
    v_dot2_f32_bf16 v25, v61, s36, v25
    v_dot2_f32_bf16 v25, v62, s36, v25
    v_dot2_f32_bf16 v25, v63, s36, v25
    s_waitcnt lgkmcnt(0)
    ds_read_b128 v[48:51], v15 offset:32768
    ds_read_b128 v[52:55], v15 offset:36864
    ds_read_b64_tr_b16 v[56:57], v16 offset:35840
    ds_read_b64_tr_b16 v[58:59], v16 offset:36096
    ds_read_b64_tr_b16 v[60:61], v16 offset:39936
    ds_read_b64_tr_b16 v[62:63], v16 offset:40192
    v_mfma_f32_32x32x16_bf16 v[64:79], v[40:43], v[32:35], v[64:79]
    v_mfma_f32_32x32x16_bf16 v[80:95], v[40:43], v[36:39], v[80:95]
    v_mfma_f32_32x32x16_bf16 v[96:111], v[44:47], v[32:35], v[96:111]
    v_mfma_f32_32x32x16_bf16 v[112:127], v[44:47], v[36:39], v[112:127]
    v_dot2_f32_bf16 v22, v32, v32, v22
    v_dot2_f32_bf16 v20, v32, s36, v20
    v_dot2_f32_bf16 v22, v33, v33, v22
    v_dot2_f32_bf16 v20, v33, s36, v20
    v_dot2_f32_bf16 v22, v34, v34, v22
    v_dot2_f32_bf16 v20, v34, s36, v20
    v_dot2_f32_bf16 v22, v35, v35, v22
    v_dot2_f32_bf16 v20, v35, s36, v20
    v_dot2_f32_bf16 v23, v36, v36, v23
    v_dot2_f32_bf16 v21, v36, s36, v21
    v_dot2_f32_bf16 v23, v37, v37, v23
    v_dot2_f32_bf16 v21, v37, s36, v21
    v_dot2_f32_bf16 v23, v38, v38, v23
    v_dot2_f32_bf16 v21, v38, s36, v21
    v_dot2_f32_bf16 v23, v39, v39, v23
    v_dot2_f32_bf16 v21, v39, s36, v21
    v_dot2_f32_bf16 v24, v40, s36, v24
    v_dot2_f32_bf16 v24, v41, s36, v24
    v_dot2_f32_bf16 v24, v42, s36, v24
    v_dot2_f32_bf16 v24, v43, s36, v24
    v_dot2_f32_bf16 v25, v44, s36, v25
    v_dot2_f32_bf16 v25, v45, s36, v25
    v_dot2_f32_bf16 v25, v46, s36, v25
    v_dot2_f32_bf16 v25, v47, s36, v25
    s_waitcnt lgkmcnt(0)
    v_mfma_f32_32x32x16_bf16 v[64:79], v[56:59], v[48:51], v[64:79]
    v_mfma_f32_32x32x16_bf16 v[80:95], v[56:59], v[52:55], v[80:95]
    v_mfma_f32_32x32x16_bf16 v[96:111], v[60:63], v[48:51], v[96:111]
    v_mfma_f32_32x32x16_bf16 v[112:127], v[60:63], v[52:55], v[112:127]
    v_dot2_f32_bf16 v22, v48, v48, v22
    v_dot2_f32_bf16 v20, v48, s36, v20
    v_dot2_f32_bf16 v22, v49, v49, v22
    v_dot2_f32_bf16 v20, v49, s36, v20
    v_dot2_f32_bf16 v22, v50, v50, v22
    v_dot2_f32_bf16 v20, v50, s36, v20
    v_dot2_f32_bf16 v22, v51, v51, v22
    v_dot2_f32_bf16 v20, v51, s36, v20
    v_dot2_f32_bf16 v23, v52, v52, v23
    v_dot2_f32_bf16 v21, v52, s36, v21
    v_dot2_f32_bf16 v23, v53, v53, v23
    v_dot2_f32_bf16 v21, v53, s36, v21
    v_dot2_f32_bf16 v23, v54, v54, v23
    v_dot2_f32_bf16 v21, v54, s36, v21
    v_dot2_f32_bf16 v23, v55, v55, v23
    v_dot2_f32_bf16 v21, v55, s36, v21
    v_dot2_f32_bf16 v24, v56, s36, v24
    v_dot2_f32_bf16 v24, v57, s36, v24
    v_dot2_f32_bf16 v24, v58, s36, v24
    v_dot2_f32_bf16 v24, v59, s36, v24
    v_dot2_f32_bf16 v25, v60, s36, v25
    v_dot2_f32_bf16 v25, v61, s36, v25
    v_dot2_f32_bf16 v25, v62, s36, v25
    v_dot2_f32_bf16 v25, v63, s36, v25
    s_add_u32 s48, s48, 2
    s_cmp_lt_u32 s48, 10
    s_cbranch_scc1 il_qkvB0_kernel_loop
    s_nop 15
    s_nop 7
    v_and_b32 v4, 31, v1
    v_and_b32 v5, 1, v2
    v_mul_u32_u24 v5, 64, v5
    v_add3_u32 v4, v4, v5, s34
    v_lshrrev_b32 v5, 1, v2
    v_mul_u32_u24 v5, 64, v5
    v_lshl_add_u32 v5, v3, 2, v5
    v_add_u32 v5, s35, v5
    v_mov_b32 v6, v20
    s_nop 1
    v_permlane32_swap_b32 v6, v20
    s_nop 1
    v_add_f32 v20, v20, v6
    v_mov_b32 v6, v22
    s_nop 1
    v_permlane32_swap_b32 v6, v22
    s_nop 1
    v_add_f32 v22, v22, v6
    v_mov_b32 v6, v21
    s_nop 1
    v_permlane32_swap_b32 v6, v21
    s_nop 1
    v_add_f32 v21, v21, v6
    v_mov_b32 v6, v23
    s_nop 1
    v_permlane32_swap_b32 v6, v23
    s_nop 1
    v_add_f32 v23, v23, v6
    v_mov_b32 v6, v24
    s_nop 1
    v_permlane32_swap_b32 v6, v24
    s_nop 1
    v_add_f32 v24, v24, v6
    v_mov_b32 v6, v25
    s_nop 1
    v_permlane32_swap_b32 v6, v25
    s_nop 1
    v_add_f32 v25, v25, v6
    s_mov_b32 s3, 0x3acccccd
    v_mul_f32 v20, s3, v20
    v_mul_f32 v22, s3, v22
    v_fma_f32 v22, -v20, v20, v22
    v_max_f32 v22, 0, v22
    v_add_f32 v22, 0x3727c5ac, v22
    v_rsq_f32 v22, v22
    v_mul_f32 v21, s3, v21
    v_mul_f32 v23, s3, v23
    v_fma_f32 v23, -v21, v21, v23
    v_max_f32 v23, 0, v23
    v_add_f32 v23, 0x3727c5ac, v23
    v_rsq_f32 v23, v23
    v_lshlrev_b32 v6, 2, v1
    v_mul_u32_u24 v7, 512, v2
    v_add_u32 v6, v6, v7
    v_add_u32 v6, 65536, v6
    ds_write_b32 v6, v24 offset:0
    ds_write_b32 v6, v25 offset:256
    s_waitcnt lgkmcnt(0)
    v_lshlrev_b32 v6, 4, v3
    v_add3_u32 v6, v6, v7, 0
    v_add_u32 v6, 65536, v6
    ds_read_b128 v[32:35], v6 offset:0
    ds_read_b128 v[36:39], v6 offset:32
    ds_read_b128 v[40:43], v6 offset:64
    ds_read_b128 v[44:47], v6 offset:96
    ds_read_b128 v[48:51], v6 offset:256
    ds_read_b128 v[52:55], v6 offset:288
    ds_read_b128 v[56:59], v6 offset:320
    ds_read_b128 v[60:63], v6 offset:352
    s_waitcnt lgkmcnt(0)
    s_mov_b32 s49, 0x3ea52b5c
    s_mov_b32 s56, 640
    v_add_u32 v8, 0, v4
    v_fma_f32 v64, -v20, v32, v64
    v_mul_f32 v64, v22, v64
    v_fma_f32 v65, -v20, v33, v65
    v_mul_f32 v65, v22, v65
    v_fma_f32 v66, -v20, v34, v66
    v_mul_f32 v66, v22, v66
    v_fma_f32 v67, -v20, v35, v67
    v_mul_f32 v67, v22, v67
    v_fma_f32 v68, -v20, v36, v68
    v_mul_f32 v68, v22, v68
    v_fma_f32 v69, -v20, v37, v69
    v_mul_f32 v69, v22, v69
    v_fma_f32 v70, -v20, v38, v70
    v_mul_f32 v70, v22, v70
    v_fma_f32 v71, -v20, v39, v71
    v_mul_f32 v71, v22, v71
    v_fma_f32 v72, -v20, v40, v72
    v_mul_f32 v72, v22, v72
    v_fma_f32 v73, -v20, v41, v73
    v_mul_f32 v73, v22, v73
    v_fma_f32 v74, -v20, v42, v74
    v_mul_f32 v74, v22, v74
    v_fma_f32 v75, -v20, v43, v75
    v_mul_f32 v75, v22, v75
    v_fma_f32 v76, -v20, v44, v76
    v_mul_f32 v76, v22, v76
    v_fma_f32 v77, -v20, v45, v77
    v_mul_f32 v77, v22, v77
    v_fma_f32 v78, -v20, v46, v78
    v_mul_f32 v78, v22, v78
    v_fma_f32 v79, -v20, v47, v79
    v_mul_f32 v79, v22, v79
    v_add_u32 v9, 0, v5
    v_cmp_gt_u32 vcc, 640, v9
    s_and_saveexec_b64 s[50:51], vcc
    v_mul_f32 v16, s49, v64
    v_mul_f32 v17, s49, v65
    v_mul_f32 v18, s49, v66
    v_mul_f32 v19, s49, v67
    v_cvt_pk_bf16_f32 v14, v16, v17
    v_cvt_pk_bf16_f32 v15, v18, v19
    v_mul_u32_u24 v10, 1280, v8
    v_lshl_add_u32 v10, v9, 1, v10
    buffer_store_dwordx2 v[14:15], v10, s[20:23], 0 offen
    s_mov_b64 exec, s[50:51]
    v_cvt_pk_bf16_f32 v14, v64, v65
    v_cvt_pk_bf16_f32 v15, v66, v67
    v_subrev_u32 v11, 640, v9
    v_cmp_le_u32 vcc, 640, v11
    s_nop 1
    v_cndmask_b32 v16, 0, 1, vcc
    v_mul_u32_u24 v17, 640, v16
    v_sub_u32 v17, v11, v17
    v_lshrrev_b32 v18, 2, v17
    v_mul_u32_u24 v12, 52429, v18
    v_lshrrev_b32 v12, 18, v12
    v_mul_u32_u24 v13, 20, v12
    v_sub_u32 v13, v17, v13
    v_mov_b32 v11, v16
    v_cmp_le_u32 vcc, 640, v9
    v_cmp_gt_u32 s[52:53], 20, v13
    s_nop 1
    s_and_b64 vcc, vcc, s[52:53]
    s_and_saveexec_b64 s[50:51], vcc
    v_lshlrev_b32 v16, 17, v12
    v_lshl_add_u32 v16, v8, 6, v16
    v_lshrrev_b32 v17, 3, v13
    v_lshrrev_b32 v18, 2, v8
    v_and_b32 v18, 3, v18
    v_xor_b32 v17, v17, v18
    v_lshl_add_u32 v17, v17, 4, v16
    v_and_b32 v18, 7, v13
    v_lshl_add_u32 v17, v18, 1, v17
    v_lshl_add_u32 v16, v13, 1, v16
    v_cmp_eq_u32 vcc, 0, v11
    s_and_saveexec_b64 s[52:53], vcc
    buffer_store_dwordx2 v[14:15], v17, s[24:27], 0 offen
    v_cmp_eq_u32 vcc, 16, v13
    s_and_saveexec_b64 s[54:55], vcc
    v_mov_b32 v18, 0
    v_mov_b32 v19, 0
    buffer_store_dwordx2 v[18:19], v17, s[24:27], 0 offen offset:8
    v_lshrrev_b32 v18, 2, v8
    v_and_b32 v18, 3, v18
    v_xor_b32 v18, 3, v18
    v_and_b32 v19, 0xffffffc0, v17
    v_lshl_add_u32 v18, v18, 4, v19
    v_mov_b32 v28, 0
    v_mov_b32 v29, 0
    v_mov_b32 v30, 0
    v_mov_b32 v31, 0
    buffer_store_dwordx4 v[28:31], v18, s[24:27], 0 offen
    s_mov_b64 exec, s[50:51]
    v_cmp_ne_u32 vcc, 0, v11
    v_cmp_le_u32 s[52:53], s56, v9
    s_and_b64 vcc, vcc, s[52:53]
    v_cmp_gt_u32 s[52:53], 20, v13
    s_nop 1
    s_and_b64 vcc, vcc, s[52:53]
    s_and_saveexec_b64 s[52:53], vcc
    buffer_store_dwordx2 v[14:15], v16, s[28:31], 0 offen
    v_cmp_eq_u32 vcc, 16, v13
    s_and_saveexec_b64 s[54:55], vcc
    v_mov_b32 v18, 0x3f80
    v_mov_b32 v19, 0
    buffer_store_dwordx2 v[18:19], v16, s[28:31], 0 offen offset:8
    s_mov_b64 exec, -1
    v_add_u32 v9, 8, v5
    v_cmp_gt_u32 vcc, 640, v9
    s_and_saveexec_b64 s[50:51], vcc
    v_mul_f32 v16, s49, v68
    v_mul_f32 v17, s49, v69
    v_mul_f32 v18, s49, v70
    v_mul_f32 v19, s49, v71
    v_cvt_pk_bf16_f32 v14, v16, v17
    v_cvt_pk_bf16_f32 v15, v18, v19
    v_mul_u32_u24 v10, 1280, v8
    v_lshl_add_u32 v10, v9, 1, v10
    buffer_store_dwordx2 v[14:15], v10, s[20:23], 0 offen
    s_mov_b64 exec, s[50:51]
    v_cvt_pk_bf16_f32 v14, v68, v69
    v_cvt_pk_bf16_f32 v15, v70, v71
    v_subrev_u32 v11, 640, v9
    v_cmp_le_u32 vcc, 640, v11
    s_nop 1
    v_cndmask_b32 v16, 0, 1, vcc
    v_mul_u32_u24 v17, 640, v16
    v_sub_u32 v17, v11, v17
    v_lshrrev_b32 v18, 2, v17
    v_mul_u32_u24 v12, 52429, v18
    v_lshrrev_b32 v12, 18, v12
    v_mul_u32_u24 v13, 20, v12
    v_sub_u32 v13, v17, v13
    v_mov_b32 v11, v16
    v_cmp_le_u32 vcc, 640, v9
    v_cmp_gt_u32 s[52:53], 20, v13
    s_nop 1
    s_and_b64 vcc, vcc, s[52:53]
    s_and_saveexec_b64 s[50:51], vcc
    v_lshlrev_b32 v16, 17, v12
    v_lshl_add_u32 v16, v8, 6, v16
    v_lshrrev_b32 v17, 3, v13
    v_lshrrev_b32 v18, 2, v8
    v_and_b32 v18, 3, v18
    v_xor_b32 v17, v17, v18
    v_lshl_add_u32 v17, v17, 4, v16
    v_and_b32 v18, 7, v13
    v_lshl_add_u32 v17, v18, 1, v17
    v_lshl_add_u32 v16, v13, 1, v16
    v_cmp_eq_u32 vcc, 0, v11
    s_and_saveexec_b64 s[52:53], vcc
    buffer_store_dwordx2 v[14:15], v17, s[24:27], 0 offen
    v_cmp_eq_u32 vcc, 16, v13
    s_and_saveexec_b64 s[54:55], vcc
    v_mov_b32 v18, 0
    v_mov_b32 v19, 0
    buffer_store_dwordx2 v[18:19], v17, s[24:27], 0 offen offset:8
    v_lshrrev_b32 v18, 2, v8
    v_and_b32 v18, 3, v18
    v_xor_b32 v18, 3, v18
    v_and_b32 v19, 0xffffffc0, v17
    v_lshl_add_u32 v18, v18, 4, v19
    v_mov_b32 v28, 0
    v_mov_b32 v29, 0
    v_mov_b32 v30, 0
    v_mov_b32 v31, 0
    buffer_store_dwordx4 v[28:31], v18, s[24:27], 0 offen
    s_mov_b64 exec, s[50:51]
    v_cmp_ne_u32 vcc, 0, v11
    v_cmp_le_u32 s[52:53], s56, v9
    s_and_b64 vcc, vcc, s[52:53]
    v_cmp_gt_u32 s[52:53], 20, v13
    s_nop 1
    s_and_b64 vcc, vcc, s[52:53]
    s_and_saveexec_b64 s[52:53], vcc
    buffer_store_dwordx2 v[14:15], v16, s[28:31], 0 offen
    v_cmp_eq_u32 vcc, 16, v13
    s_and_saveexec_b64 s[54:55], vcc
    v_mov_b32 v18, 0x3f80
    v_mov_b32 v19, 0
    buffer_store_dwordx2 v[18:19], v16, s[28:31], 0 offen offset:8
    s_mov_b64 exec, -1
    v_add_u32 v9, 16, v5
    v_cmp_gt_u32 vcc, 640, v9
    s_and_saveexec_b64 s[50:51], vcc
    v_mul_f32 v16, s49, v72
    v_mul_f32 v17, s49, v73
    v_mul_f32 v18, s49, v74
    v_mul_f32 v19, s49, v75
    v_cvt_pk_bf16_f32 v14, v16, v17
    v_cvt_pk_bf16_f32 v15, v18, v19
    v_mul_u32_u24 v10, 1280, v8
    v_lshl_add_u32 v10, v9, 1, v10
    buffer_store_dwordx2 v[14:15], v10, s[20:23], 0 offen
    s_mov_b64 exec, s[50:51]
    v_cvt_pk_bf16_f32 v14, v72, v73
    v_cvt_pk_bf16_f32 v15, v74, v75
    v_subrev_u32 v11, 640, v9
    v_cmp_le_u32 vcc, 640, v11
    s_nop 1
    v_cndmask_b32 v16, 0, 1, vcc
    v_mul_u32_u24 v17, 640, v16
    v_sub_u32 v17, v11, v17
    v_lshrrev_b32 v18, 2, v17
    v_mul_u32_u24 v12, 52429, v18
    v_lshrrev_b32 v12, 18, v12
    v_mul_u32_u24 v13, 20, v12
    v_sub_u32 v13, v17, v13
    v_mov_b32 v11, v16
    v_cmp_le_u32 vcc, 640, v9
    v_cmp_gt_u32 s[52:53], 20, v13
    s_nop 1
    s_and_b64 vcc, vcc, s[52:53]
    s_and_saveexec_b64 s[50:51], vcc
    v_lshlrev_b32 v16, 17, v12
    v_lshl_add_u32 v16, v8, 6, v16
    v_lshrrev_b32 v17, 3, v13
    v_lshrrev_b32 v18, 2, v8
    v_and_b32 v18, 3, v18
    v_xor_b32 v17, v17, v18
    v_lshl_add_u32 v17, v17, 4, v16
    v_and_b32 v18, 7, v13
    v_lshl_add_u32 v17, v18, 1, v17
    v_lshl_add_u32 v16, v13, 1, v16
    v_cmp_eq_u32 vcc, 0, v11
    s_and_saveexec_b64 s[52:53], vcc
    buffer_store_dwordx2 v[14:15], v17, s[24:27], 0 offen
    v_cmp_eq_u32 vcc, 16, v13
    s_and_saveexec_b64 s[54:55], vcc
    v_mov_b32 v18, 0
    v_mov_b32 v19, 0
    buffer_store_dwordx2 v[18:19], v17, s[24:27], 0 offen offset:8
    v_lshrrev_b32 v18, 2, v8
    v_and_b32 v18, 3, v18
    v_xor_b32 v18, 3, v18
    v_and_b32 v19, 0xffffffc0, v17
    v_lshl_add_u32 v18, v18, 4, v19
    v_mov_b32 v28, 0
    v_mov_b32 v29, 0
    v_mov_b32 v30, 0
    v_mov_b32 v31, 0
    buffer_store_dwordx4 v[28:31], v18, s[24:27], 0 offen
    s_mov_b64 exec, s[50:51]
    v_cmp_ne_u32 vcc, 0, v11
    v_cmp_le_u32 s[52:53], s56, v9
    s_and_b64 vcc, vcc, s[52:53]
    v_cmp_gt_u32 s[52:53], 20, v13
    s_nop 1
    s_and_b64 vcc, vcc, s[52:53]
    s_and_saveexec_b64 s[52:53], vcc
    buffer_store_dwordx2 v[14:15], v16, s[28:31], 0 offen
    v_cmp_eq_u32 vcc, 16, v13
    s_and_saveexec_b64 s[54:55], vcc
    v_mov_b32 v18, 0x3f80
    v_mov_b32 v19, 0
    buffer_store_dwordx2 v[18:19], v16, s[28:31], 0 offen offset:8
    s_mov_b64 exec, -1
    v_add_u32 v9, 24, v5
    v_cmp_gt_u32 vcc, 640, v9
    s_and_saveexec_b64 s[50:51], vcc
    v_mul_f32 v16, s49, v76
    v_mul_f32 v17, s49, v77
    v_mul_f32 v18, s49, v78
    v_mul_f32 v19, s49, v79
    v_cvt_pk_bf16_f32 v14, v16, v17
    v_cvt_pk_bf16_f32 v15, v18, v19
    v_mul_u32_u24 v10, 1280, v8
    v_lshl_add_u32 v10, v9, 1, v10
    buffer_store_dwordx2 v[14:15], v10, s[20:23], 0 offen
    s_mov_b64 exec, s[50:51]
    v_cvt_pk_bf16_f32 v14, v76, v77
    v_cvt_pk_bf16_f32 v15, v78, v79
    v_subrev_u32 v11, 640, v9
    v_cmp_le_u32 vcc, 640, v11
    s_nop 1
    v_cndmask_b32 v16, 0, 1, vcc
    v_mul_u32_u24 v17, 640, v16
    v_sub_u32 v17, v11, v17
    v_lshrrev_b32 v18, 2, v17
    v_mul_u32_u24 v12, 52429, v18
    v_lshrrev_b32 v12, 18, v12
    v_mul_u32_u24 v13, 20, v12
    v_sub_u32 v13, v17, v13
    v_mov_b32 v11, v16
    v_cmp_le_u32 vcc, 640, v9
    v_cmp_gt_u32 s[52:53], 20, v13
    s_nop 1
    s_and_b64 vcc, vcc, s[52:53]
    s_and_saveexec_b64 s[50:51], vcc
    v_lshlrev_b32 v16, 17, v12
    v_lshl_add_u32 v16, v8, 6, v16
    v_lshrrev_b32 v17, 3, v13
    v_lshrrev_b32 v18, 2, v8
    v_and_b32 v18, 3, v18
    v_xor_b32 v17, v17, v18
    v_lshl_add_u32 v17, v17, 4, v16
    v_and_b32 v18, 7, v13
    v_lshl_add_u32 v17, v18, 1, v17
    v_lshl_add_u32 v16, v13, 1, v16
    v_cmp_eq_u32 vcc, 0, v11
    s_and_saveexec_b64 s[52:53], vcc
    buffer_store_dwordx2 v[14:15], v17, s[24:27], 0 offen
    v_cmp_eq_u32 vcc, 16, v13
    s_and_saveexec_b64 s[54:55], vcc
    v_mov_b32 v18, 0
    v_mov_b32 v19, 0
    buffer_store_dwordx2 v[18:19], v17, s[24:27], 0 offen offset:8
    v_lshrrev_b32 v18, 2, v8
    v_and_b32 v18, 3, v18
    v_xor_b32 v18, 3, v18
    v_and_b32 v19, 0xffffffc0, v17
    v_lshl_add_u32 v18, v18, 4, v19
    v_mov_b32 v28, 0
    v_mov_b32 v29, 0
    v_mov_b32 v30, 0
    v_mov_b32 v31, 0
    buffer_store_dwordx4 v[28:31], v18, s[24:27], 0 offen
    s_mov_b64 exec, s[50:51]
    v_cmp_ne_u32 vcc, 0, v11
    v_cmp_le_u32 s[52:53], s56, v9
    s_and_b64 vcc, vcc, s[52:53]
    v_cmp_gt_u32 s[52:53], 20, v13
    s_nop 1
    s_and_b64 vcc, vcc, s[52:53]
    s_and_saveexec_b64 s[52:53], vcc
    buffer_store_dwordx2 v[14:15], v16, s[28:31], 0 offen
    v_cmp_eq_u32 vcc, 16, v13
    s_and_saveexec_b64 s[54:55], vcc
    v_mov_b32 v18, 0x3f80
    v_mov_b32 v19, 0
    buffer_store_dwordx2 v[18:19], v16, s[28:31], 0 offen offset:8
    s_mov_b64 exec, -1
    v_add_u32 v8, 32, v4
    v_fma_f32 v80, -v21, v32, v80
    v_mul_f32 v80, v23, v80
    v_fma_f32 v81, -v21, v33, v81
    v_mul_f32 v81, v23, v81
    v_fma_f32 v82, -v21, v34, v82
    v_mul_f32 v82, v23, v82
    v_fma_f32 v83, -v21, v35, v83
    v_mul_f32 v83, v23, v83
    v_fma_f32 v84, -v21, v36, v84
    v_mul_f32 v84, v23, v84
    v_fma_f32 v85, -v21, v37, v85
    v_mul_f32 v85, v23, v85
    v_fma_f32 v86, -v21, v38, v86
    v_mul_f32 v86, v23, v86
    v_fma_f32 v87, -v21, v39, v87
    v_mul_f32 v87, v23, v87
    v_fma_f32 v88, -v21, v40, v88
    v_mul_f32 v88, v23, v88
    v_fma_f32 v89, -v21, v41, v89
    v_mul_f32 v89, v23, v89
    v_fma_f32 v90, -v21, v42, v90
    v_mul_f32 v90, v23, v90
    v_fma_f32 v91, -v21, v43, v91
    v_mul_f32 v91, v23, v91
    v_fma_f32 v92, -v21, v44, v92
    v_mul_f32 v92, v23, v92
    v_fma_f32 v93, -v21, v45, v93
    v_mul_f32 v93, v23, v93
    v_fma_f32 v94, -v21, v46, v94
    v_mul_f32 v94, v23, v94
    v_fma_f32 v95, -v21, v47, v95
    v_mul_f32 v95, v23, v95
    v_add_u32 v9, 0, v5
    v_cmp_gt_u32 vcc, 640, v9
    s_and_saveexec_b64 s[50:51], vcc
    v_mul_f32 v16, s49, v80
    v_mul_f32 v17, s49, v81
    v_mul_f32 v18, s49, v82
    v_mul_f32 v19, s49, v83
    v_cvt_pk_bf16_f32 v14, v16, v17
    v_cvt_pk_bf16_f32 v15, v18, v19
    v_mul_u32_u24 v10, 1280, v8
    v_lshl_add_u32 v10, v9, 1, v10
    buffer_store_dwordx2 v[14:15], v10, s[20:23], 0 offen
    s_mov_b64 exec, s[50:51]
    v_cvt_pk_bf16_f32 v14, v80, v81
    v_cvt_pk_bf16_f32 v15, v82, v83
    v_subrev_u32 v11, 640, v9
    v_cmp_le_u32 vcc, 640, v11
    s_nop 1
    v_cndmask_b32 v16, 0, 1, vcc
    v_mul_u32_u24 v17, 640, v16
    v_sub_u32 v17, v11, v17
    v_lshrrev_b32 v18, 2, v17
    v_mul_u32_u24 v12, 52429, v18
    v_lshrrev_b32 v12, 18, v12
    v_mul_u32_u24 v13, 20, v12
    v_sub_u32 v13, v17, v13
    v_mov_b32 v11, v16
    v_cmp_le_u32 vcc, 640, v9
    v_cmp_gt_u32 s[52:53], 20, v13
    s_nop 1
    s_and_b64 vcc, vcc, s[52:53]
    s_and_saveexec_b64 s[50:51], vcc
    v_lshlrev_b32 v16, 17, v12
    v_lshl_add_u32 v16, v8, 6, v16
    v_lshrrev_b32 v17, 3, v13
    v_lshrrev_b32 v18, 2, v8
    v_and_b32 v18, 3, v18
    v_xor_b32 v17, v17, v18
    v_lshl_add_u32 v17, v17, 4, v16
    v_and_b32 v18, 7, v13
    v_lshl_add_u32 v17, v18, 1, v17
    v_lshl_add_u32 v16, v13, 1, v16
    v_cmp_eq_u32 vcc, 0, v11
    s_and_saveexec_b64 s[52:53], vcc
    buffer_store_dwordx2 v[14:15], v17, s[24:27], 0 offen
    v_cmp_eq_u32 vcc, 16, v13
    s_and_saveexec_b64 s[54:55], vcc
    v_mov_b32 v18, 0
    v_mov_b32 v19, 0
    buffer_store_dwordx2 v[18:19], v17, s[24:27], 0 offen offset:8
    v_lshrrev_b32 v18, 2, v8
    v_and_b32 v18, 3, v18
    v_xor_b32 v18, 3, v18
    v_and_b32 v19, 0xffffffc0, v17
    v_lshl_add_u32 v18, v18, 4, v19
    v_mov_b32 v28, 0
    v_mov_b32 v29, 0
    v_mov_b32 v30, 0
    v_mov_b32 v31, 0
    buffer_store_dwordx4 v[28:31], v18, s[24:27], 0 offen
    s_mov_b64 exec, s[50:51]
    v_cmp_ne_u32 vcc, 0, v11
    v_cmp_le_u32 s[52:53], s56, v9
    s_and_b64 vcc, vcc, s[52:53]
    v_cmp_gt_u32 s[52:53], 20, v13
    s_nop 1
    s_and_b64 vcc, vcc, s[52:53]
    s_and_saveexec_b64 s[52:53], vcc
    buffer_store_dwordx2 v[14:15], v16, s[28:31], 0 offen
    v_cmp_eq_u32 vcc, 16, v13
    s_and_saveexec_b64 s[54:55], vcc
    v_mov_b32 v18, 0x3f80
    v_mov_b32 v19, 0
    buffer_store_dwordx2 v[18:19], v16, s[28:31], 0 offen offset:8
    s_mov_b64 exec, -1
    v_add_u32 v9, 8, v5
    v_cmp_gt_u32 vcc, 640, v9
    s_and_saveexec_b64 s[50:51], vcc
    v_mul_f32 v16, s49, v84
    v_mul_f32 v17, s49, v85
    v_mul_f32 v18, s49, v86
    v_mul_f32 v19, s49, v87
    v_cvt_pk_bf16_f32 v14, v16, v17
    v_cvt_pk_bf16_f32 v15, v18, v19
    v_mul_u32_u24 v10, 1280, v8
    v_lshl_add_u32 v10, v9, 1, v10
    buffer_store_dwordx2 v[14:15], v10, s[20:23], 0 offen
    s_mov_b64 exec, s[50:51]
    v_cvt_pk_bf16_f32 v14, v84, v85
    v_cvt_pk_bf16_f32 v15, v86, v87
    v_subrev_u32 v11, 640, v9
    v_cmp_le_u32 vcc, 640, v11
    s_nop 1
    v_cndmask_b32 v16, 0, 1, vcc
    v_mul_u32_u24 v17, 640, v16
    v_sub_u32 v17, v11, v17
    v_lshrrev_b32 v18, 2, v17
    v_mul_u32_u24 v12, 52429, v18
    v_lshrrev_b32 v12, 18, v12
    v_mul_u32_u24 v13, 20, v12
    v_sub_u32 v13, v17, v13
    v_mov_b32 v11, v16
    v_cmp_le_u32 vcc, 640, v9
    v_cmp_gt_u32 s[52:53], 20, v13
    s_nop 1
    s_and_b64 vcc, vcc, s[52:53]
    s_and_saveexec_b64 s[50:51], vcc
    v_lshlrev_b32 v16, 17, v12
    v_lshl_add_u32 v16, v8, 6, v16
    v_lshrrev_b32 v17, 3, v13
    v_lshrrev_b32 v18, 2, v8
    v_and_b32 v18, 3, v18
    v_xor_b32 v17, v17, v18
    v_lshl_add_u32 v17, v17, 4, v16
    v_and_b32 v18, 7, v13
    v_lshl_add_u32 v17, v18, 1, v17
    v_lshl_add_u32 v16, v13, 1, v16
    v_cmp_eq_u32 vcc, 0, v11
    s_and_saveexec_b64 s[52:53], vcc
    buffer_store_dwordx2 v[14:15], v17, s[24:27], 0 offen
    v_cmp_eq_u32 vcc, 16, v13
    s_and_saveexec_b64 s[54:55], vcc
    v_mov_b32 v18, 0
    v_mov_b32 v19, 0
    buffer_store_dwordx2 v[18:19], v17, s[24:27], 0 offen offset:8
    v_lshrrev_b32 v18, 2, v8
    v_and_b32 v18, 3, v18
    v_xor_b32 v18, 3, v18
    v_and_b32 v19, 0xffffffc0, v17
    v_lshl_add_u32 v18, v18, 4, v19
    v_mov_b32 v28, 0
    v_mov_b32 v29, 0
    v_mov_b32 v30, 0
    v_mov_b32 v31, 0
    buffer_store_dwordx4 v[28:31], v18, s[24:27], 0 offen
    s_mov_b64 exec, s[50:51]
    v_cmp_ne_u32 vcc, 0, v11
    v_cmp_le_u32 s[52:53], s56, v9
    s_and_b64 vcc, vcc, s[52:53]
    v_cmp_gt_u32 s[52:53], 20, v13
    s_nop 1
    s_and_b64 vcc, vcc, s[52:53]
    s_and_saveexec_b64 s[52:53], vcc
    buffer_store_dwordx2 v[14:15], v16, s[28:31], 0 offen
    v_cmp_eq_u32 vcc, 16, v13
    s_and_saveexec_b64 s[54:55], vcc
    v_mov_b32 v18, 0x3f80
    v_mov_b32 v19, 0
    buffer_store_dwordx2 v[18:19], v16, s[28:31], 0 offen offset:8
    s_mov_b64 exec, -1
    v_add_u32 v9, 16, v5
    v_cmp_gt_u32 vcc, 640, v9
    s_and_saveexec_b64 s[50:51], vcc
    v_mul_f32 v16, s49, v88
    v_mul_f32 v17, s49, v89
    v_mul_f32 v18, s49, v90
    v_mul_f32 v19, s49, v91
    v_cvt_pk_bf16_f32 v14, v16, v17
    v_cvt_pk_bf16_f32 v15, v18, v19
    v_mul_u32_u24 v10, 1280, v8
    v_lshl_add_u32 v10, v9, 1, v10
    buffer_store_dwordx2 v[14:15], v10, s[20:23], 0 offen
    s_mov_b64 exec, s[50:51]
    v_cvt_pk_bf16_f32 v14, v88, v89
    v_cvt_pk_bf16_f32 v15, v90, v91
    v_subrev_u32 v11, 640, v9
    v_cmp_le_u32 vcc, 640, v11
    s_nop 1
    v_cndmask_b32 v16, 0, 1, vcc
    v_mul_u32_u24 v17, 640, v16
    v_sub_u32 v17, v11, v17
    v_lshrrev_b32 v18, 2, v17
    v_mul_u32_u24 v12, 52429, v18
    v_lshrrev_b32 v12, 18, v12
    v_mul_u32_u24 v13, 20, v12
    v_sub_u32 v13, v17, v13
    v_mov_b32 v11, v16
    v_cmp_le_u32 vcc, 640, v9
    v_cmp_gt_u32 s[52:53], 20, v13
    s_nop 1
    s_and_b64 vcc, vcc, s[52:53]
    s_and_saveexec_b64 s[50:51], vcc
    v_lshlrev_b32 v16, 17, v12
    v_lshl_add_u32 v16, v8, 6, v16
    v_lshrrev_b32 v17, 3, v13
    v_lshrrev_b32 v18, 2, v8
    v_and_b32 v18, 3, v18
    v_xor_b32 v17, v17, v18
    v_lshl_add_u32 v17, v17, 4, v16
    v_and_b32 v18, 7, v13
    v_lshl_add_u32 v17, v18, 1, v17
    v_lshl_add_u32 v16, v13, 1, v16
    v_cmp_eq_u32 vcc, 0, v11
    s_and_saveexec_b64 s[52:53], vcc
    buffer_store_dwordx2 v[14:15], v17, s[24:27], 0 offen
    v_cmp_eq_u32 vcc, 16, v13
    s_and_saveexec_b64 s[54:55], vcc
    v_mov_b32 v18, 0
    v_mov_b32 v19, 0
    buffer_store_dwordx2 v[18:19], v17, s[24:27], 0 offen offset:8
    v_lshrrev_b32 v18, 2, v8
    v_and_b32 v18, 3, v18
    v_xor_b32 v18, 3, v18
    v_and_b32 v19, 0xffffffc0, v17
    v_lshl_add_u32 v18, v18, 4, v19
    v_mov_b32 v28, 0
    v_mov_b32 v29, 0
    v_mov_b32 v30, 0
    v_mov_b32 v31, 0
    buffer_store_dwordx4 v[28:31], v18, s[24:27], 0 offen
    s_mov_b64 exec, s[50:51]
    v_cmp_ne_u32 vcc, 0, v11
    v_cmp_le_u32 s[52:53], s56, v9
    s_and_b64 vcc, vcc, s[52:53]
    v_cmp_gt_u32 s[52:53], 20, v13
    s_nop 1
    s_and_b64 vcc, vcc, s[52:53]
    s_and_saveexec_b64 s[52:53], vcc
    buffer_store_dwordx2 v[14:15], v16, s[28:31], 0 offen
    v_cmp_eq_u32 vcc, 16, v13
    s_and_saveexec_b64 s[54:55], vcc
    v_mov_b32 v18, 0x3f80
    v_mov_b32 v19, 0
    buffer_store_dwordx2 v[18:19], v16, s[28:31], 0 offen offset:8
    s_mov_b64 exec, -1
    v_add_u32 v9, 24, v5
    v_cmp_gt_u32 vcc, 640, v9
    s_and_saveexec_b64 s[50:51], vcc
    v_mul_f32 v16, s49, v92
    v_mul_f32 v17, s49, v93
    v_mul_f32 v18, s49, v94
    v_mul_f32 v19, s49, v95
    v_cvt_pk_bf16_f32 v14, v16, v17
    v_cvt_pk_bf16_f32 v15, v18, v19
    v_mul_u32_u24 v10, 1280, v8
    v_lshl_add_u32 v10, v9, 1, v10
    buffer_store_dwordx2 v[14:15], v10, s[20:23], 0 offen
    s_mov_b64 exec, s[50:51]
    v_cvt_pk_bf16_f32 v14, v92, v93
    v_cvt_pk_bf16_f32 v15, v94, v95
    v_subrev_u32 v11, 640, v9
    v_cmp_le_u32 vcc, 640, v11
    s_nop 1
    v_cndmask_b32 v16, 0, 1, vcc
    v_mul_u32_u24 v17, 640, v16
    v_sub_u32 v17, v11, v17
    v_lshrrev_b32 v18, 2, v17
    v_mul_u32_u24 v12, 52429, v18
    v_lshrrev_b32 v12, 18, v12
    v_mul_u32_u24 v13, 20, v12
    v_sub_u32 v13, v17, v13
    v_mov_b32 v11, v16
    v_cmp_le_u32 vcc, 640, v9
    v_cmp_gt_u32 s[52:53], 20, v13
    s_nop 1
    s_and_b64 vcc, vcc, s[52:53]
    s_and_saveexec_b64 s[50:51], vcc
    v_lshlrev_b32 v16, 17, v12
    v_lshl_add_u32 v16, v8, 6, v16
    v_lshrrev_b32 v17, 3, v13
    v_lshrrev_b32 v18, 2, v8
    v_and_b32 v18, 3, v18
    v_xor_b32 v17, v17, v18
    v_lshl_add_u32 v17, v17, 4, v16
    v_and_b32 v18, 7, v13
    v_lshl_add_u32 v17, v18, 1, v17
    v_lshl_add_u32 v16, v13, 1, v16
    v_cmp_eq_u32 vcc, 0, v11
    s_and_saveexec_b64 s[52:53], vcc
    buffer_store_dwordx2 v[14:15], v17, s[24:27], 0 offen
    v_cmp_eq_u32 vcc, 16, v13
    s_and_saveexec_b64 s[54:55], vcc
    v_mov_b32 v18, 0
    v_mov_b32 v19, 0
    buffer_store_dwordx2 v[18:19], v17, s[24:27], 0 offen offset:8
    v_lshrrev_b32 v18, 2, v8
    v_and_b32 v18, 3, v18
    v_xor_b32 v18, 3, v18
    v_and_b32 v19, 0xffffffc0, v17
    v_lshl_add_u32 v18, v18, 4, v19
    v_mov_b32 v28, 0
    v_mov_b32 v29, 0
    v_mov_b32 v30, 0
    v_mov_b32 v31, 0
    buffer_store_dwordx4 v[28:31], v18, s[24:27], 0 offen
    s_mov_b64 exec, s[50:51]
    v_cmp_ne_u32 vcc, 0, v11
    v_cmp_le_u32 s[52:53], s56, v9
    s_and_b64 vcc, vcc, s[52:53]
    v_cmp_gt_u32 s[52:53], 20, v13
    s_nop 1
    s_and_b64 vcc, vcc, s[52:53]
    s_and_saveexec_b64 s[52:53], vcc
    buffer_store_dwordx2 v[14:15], v16, s[28:31], 0 offen
    v_cmp_eq_u32 vcc, 16, v13
    s_and_saveexec_b64 s[54:55], vcc
    v_mov_b32 v18, 0x3f80
    v_mov_b32 v19, 0
    buffer_store_dwordx2 v[18:19], v16, s[28:31], 0 offen offset:8
    s_mov_b64 exec, -1
    v_add_u32 v8, 0, v4
    v_fma_f32 v96, -v20, v48, v96
    v_mul_f32 v96, v22, v96
    v_fma_f32 v97, -v20, v49, v97
    v_mul_f32 v97, v22, v97
    v_fma_f32 v98, -v20, v50, v98
    v_mul_f32 v98, v22, v98
    v_fma_f32 v99, -v20, v51, v99
    v_mul_f32 v99, v22, v99
    v_fma_f32 v100, -v20, v52, v100
    v_mul_f32 v100, v22, v100
    v_fma_f32 v101, -v20, v53, v101
    v_mul_f32 v101, v22, v101
    v_fma_f32 v102, -v20, v54, v102
    v_mul_f32 v102, v22, v102
    v_fma_f32 v103, -v20, v55, v103
    v_mul_f32 v103, v22, v103
    v_fma_f32 v104, -v20, v56, v104
    v_mul_f32 v104, v22, v104
    v_fma_f32 v105, -v20, v57, v105
    v_mul_f32 v105, v22, v105
    v_fma_f32 v106, -v20, v58, v106
    v_mul_f32 v106, v22, v106
    v_fma_f32 v107, -v20, v59, v107
    v_mul_f32 v107, v22, v107
    v_fma_f32 v108, -v20, v60, v108
    v_mul_f32 v108, v22, v108
    v_fma_f32 v109, -v20, v61, v109
    v_mul_f32 v109, v22, v109
    v_fma_f32 v110, -v20, v62, v110
    v_mul_f32 v110, v22, v110
    v_fma_f32 v111, -v20, v63, v111
    v_mul_f32 v111, v22, v111
    v_add_u32 v9, 32, v5
    v_cmp_gt_u32 vcc, 640, v9
    s_and_saveexec_b64 s[50:51], vcc
    v_mul_f32 v16, s49, v96
    v_mul_f32 v17, s49, v97
    v_mul_f32 v18, s49, v98
    v_mul_f32 v19, s49, v99
    v_cvt_pk_bf16_f32 v14, v16, v17
    v_cvt_pk_bf16_f32 v15, v18, v19
    v_mul_u32_u24 v10, 1280, v8
    v_lshl_add_u32 v10, v9, 1, v10
    buffer_store_dwordx2 v[14:15], v10, s[20:23], 0 offen
    s_mov_b64 exec, s[50:51]
    v_cvt_pk_bf16_f32 v14, v96, v97
    v_cvt_pk_bf16_f32 v15, v98, v99
    v_subrev_u32 v11, 640, v9
    v_cmp_le_u32 vcc, 640, v11
    s_nop 1
    v_cndmask_b32 v16, 0, 1, vcc
    v_mul_u32_u24 v17, 640, v16
    v_sub_u32 v17, v11, v17
    v_lshrrev_b32 v18, 2, v17
    v_mul_u32_u24 v12, 52429, v18
    v_lshrrev_b32 v12, 18, v12
    v_mul_u32_u24 v13, 20, v12
    v_sub_u32 v13, v17, v13
    v_mov_b32 v11, v16
    v_cmp_le_u32 vcc, 640, v9
    v_cmp_gt_u32 s[52:53], 20, v13
    s_nop 1
    s_and_b64 vcc, vcc, s[52:53]
    s_and_saveexec_b64 s[50:51], vcc
    v_lshlrev_b32 v16, 17, v12
    v_lshl_add_u32 v16, v8, 6, v16
    v_lshrrev_b32 v17, 3, v13
    v_lshrrev_b32 v18, 2, v8
    v_and_b32 v18, 3, v18
    v_xor_b32 v17, v17, v18
    v_lshl_add_u32 v17, v17, 4, v16
    v_and_b32 v18, 7, v13
    v_lshl_add_u32 v17, v18, 1, v17
    v_lshl_add_u32 v16, v13, 1, v16
    v_cmp_eq_u32 vcc, 0, v11
    s_and_saveexec_b64 s[52:53], vcc
    buffer_store_dwordx2 v[14:15], v17, s[24:27], 0 offen
    v_cmp_eq_u32 vcc, 16, v13
    s_and_saveexec_b64 s[54:55], vcc
    v_mov_b32 v18, 0
    v_mov_b32 v19, 0
    buffer_store_dwordx2 v[18:19], v17, s[24:27], 0 offen offset:8
    v_lshrrev_b32 v18, 2, v8
    v_and_b32 v18, 3, v18
    v_xor_b32 v18, 3, v18
    v_and_b32 v19, 0xffffffc0, v17
    v_lshl_add_u32 v18, v18, 4, v19
    v_mov_b32 v28, 0
    v_mov_b32 v29, 0
    v_mov_b32 v30, 0
    v_mov_b32 v31, 0
    buffer_store_dwordx4 v[28:31], v18, s[24:27], 0 offen
    s_mov_b64 exec, s[50:51]
    v_cmp_ne_u32 vcc, 0, v11
    v_cmp_le_u32 s[52:53], s56, v9
    s_and_b64 vcc, vcc, s[52:53]
    v_cmp_gt_u32 s[52:53], 20, v13
    s_nop 1
    s_and_b64 vcc, vcc, s[52:53]
    s_and_saveexec_b64 s[52:53], vcc
    buffer_store_dwordx2 v[14:15], v16, s[28:31], 0 offen
    v_cmp_eq_u32 vcc, 16, v13
    s_and_saveexec_b64 s[54:55], vcc
    v_mov_b32 v18, 0x3f80
    v_mov_b32 v19, 0
    buffer_store_dwordx2 v[18:19], v16, s[28:31], 0 offen offset:8
    s_mov_b64 exec, -1
    v_add_u32 v9, 40, v5
    v_cmp_gt_u32 vcc, 640, v9
    s_and_saveexec_b64 s[50:51], vcc
    v_mul_f32 v16, s49, v100
    v_mul_f32 v17, s49, v101
    v_mul_f32 v18, s49, v102
    v_mul_f32 v19, s49, v103
    v_cvt_pk_bf16_f32 v14, v16, v17
    v_cvt_pk_bf16_f32 v15, v18, v19
    v_mul_u32_u24 v10, 1280, v8
    v_lshl_add_u32 v10, v9, 1, v10
    buffer_store_dwordx2 v[14:15], v10, s[20:23], 0 offen
    s_mov_b64 exec, s[50:51]
    v_cvt_pk_bf16_f32 v14, v100, v101
    v_cvt_pk_bf16_f32 v15, v102, v103
    v_subrev_u32 v11, 640, v9
    v_cmp_le_u32 vcc, 640, v11
    s_nop 1
    v_cndmask_b32 v16, 0, 1, vcc
    v_mul_u32_u24 v17, 640, v16
    v_sub_u32 v17, v11, v17
    v_lshrrev_b32 v18, 2, v17
    v_mul_u32_u24 v12, 52429, v18
    v_lshrrev_b32 v12, 18, v12
    v_mul_u32_u24 v13, 20, v12
    v_sub_u32 v13, v17, v13
    v_mov_b32 v11, v16
    v_cmp_le_u32 vcc, 640, v9
    v_cmp_gt_u32 s[52:53], 20, v13
    s_nop 1
    s_and_b64 vcc, vcc, s[52:53]
    s_and_saveexec_b64 s[50:51], vcc
    v_lshlrev_b32 v16, 17, v12
    v_lshl_add_u32 v16, v8, 6, v16
    v_lshrrev_b32 v17, 3, v13
    v_lshrrev_b32 v18, 2, v8
    v_and_b32 v18, 3, v18
    v_xor_b32 v17, v17, v18
    v_lshl_add_u32 v17, v17, 4, v16
    v_and_b32 v18, 7, v13
    v_lshl_add_u32 v17, v18, 1, v17
    v_lshl_add_u32 v16, v13, 1, v16
    v_cmp_eq_u32 vcc, 0, v11
    s_and_saveexec_b64 s[52:53], vcc
    buffer_store_dwordx2 v[14:15], v17, s[24:27], 0 offen
    v_cmp_eq_u32 vcc, 16, v13
    s_and_saveexec_b64 s[54:55], vcc
    v_mov_b32 v18, 0
    v_mov_b32 v19, 0
    buffer_store_dwordx2 v[18:19], v17, s[24:27], 0 offen offset:8
    v_lshrrev_b32 v18, 2, v8
    v_and_b32 v18, 3, v18
    v_xor_b32 v18, 3, v18
    v_and_b32 v19, 0xffffffc0, v17
    v_lshl_add_u32 v18, v18, 4, v19
    v_mov_b32 v28, 0
    v_mov_b32 v29, 0
    v_mov_b32 v30, 0
    v_mov_b32 v31, 0
    buffer_store_dwordx4 v[28:31], v18, s[24:27], 0 offen
    s_mov_b64 exec, s[50:51]
    v_cmp_ne_u32 vcc, 0, v11
    v_cmp_le_u32 s[52:53], s56, v9
    s_and_b64 vcc, vcc, s[52:53]
    v_cmp_gt_u32 s[52:53], 20, v13
    s_nop 1
    s_and_b64 vcc, vcc, s[52:53]
    s_and_saveexec_b64 s[52:53], vcc
    buffer_store_dwordx2 v[14:15], v16, s[28:31], 0 offen
    v_cmp_eq_u32 vcc, 16, v13
    s_and_saveexec_b64 s[54:55], vcc
    v_mov_b32 v18, 0x3f80
    v_mov_b32 v19, 0
    buffer_store_dwordx2 v[18:19], v16, s[28:31], 0 offen offset:8
    s_mov_b64 exec, -1
    v_add_u32 v9, 48, v5
    v_cmp_gt_u32 vcc, 640, v9
    s_and_saveexec_b64 s[50:51], vcc
    v_mul_f32 v16, s49, v104
    v_mul_f32 v17, s49, v105
    v_mul_f32 v18, s49, v106
    v_mul_f32 v19, s49, v107
    v_cvt_pk_bf16_f32 v14, v16, v17
    v_cvt_pk_bf16_f32 v15, v18, v19
    v_mul_u32_u24 v10, 1280, v8
    v_lshl_add_u32 v10, v9, 1, v10
    buffer_store_dwordx2 v[14:15], v10, s[20:23], 0 offen
    s_mov_b64 exec, s[50:51]
    v_cvt_pk_bf16_f32 v14, v104, v105
    v_cvt_pk_bf16_f32 v15, v106, v107
    v_subrev_u32 v11, 640, v9
    v_cmp_le_u32 vcc, 640, v11
    s_nop 1
    v_cndmask_b32 v16, 0, 1, vcc
    v_mul_u32_u24 v17, 640, v16
    v_sub_u32 v17, v11, v17
    v_lshrrev_b32 v18, 2, v17
    v_mul_u32_u24 v12, 52429, v18
    v_lshrrev_b32 v12, 18, v12
    v_mul_u32_u24 v13, 20, v12
    v_sub_u32 v13, v17, v13
    v_mov_b32 v11, v16
    v_cmp_le_u32 vcc, 640, v9
    v_cmp_gt_u32 s[52:53], 20, v13
    s_nop 1
    s_and_b64 vcc, vcc, s[52:53]
    s_and_saveexec_b64 s[50:51], vcc
    v_lshlrev_b32 v16, 17, v12
    v_lshl_add_u32 v16, v8, 6, v16
    v_lshrrev_b32 v17, 3, v13
    v_lshrrev_b32 v18, 2, v8
    v_and_b32 v18, 3, v18
    v_xor_b32 v17, v17, v18
    v_lshl_add_u32 v17, v17, 4, v16
    v_and_b32 v18, 7, v13
    v_lshl_add_u32 v17, v18, 1, v17
    v_lshl_add_u32 v16, v13, 1, v16
    v_cmp_eq_u32 vcc, 0, v11
    s_and_saveexec_b64 s[52:53], vcc
    buffer_store_dwordx2 v[14:15], v17, s[24:27], 0 offen
    v_cmp_eq_u32 vcc, 16, v13
    s_and_saveexec_b64 s[54:55], vcc
    v_mov_b32 v18, 0
    v_mov_b32 v19, 0
    buffer_store_dwordx2 v[18:19], v17, s[24:27], 0 offen offset:8
    v_lshrrev_b32 v18, 2, v8
    v_and_b32 v18, 3, v18
    v_xor_b32 v18, 3, v18
    v_and_b32 v19, 0xffffffc0, v17
    v_lshl_add_u32 v18, v18, 4, v19
    v_mov_b32 v28, 0
    v_mov_b32 v29, 0
    v_mov_b32 v30, 0
    v_mov_b32 v31, 0
    buffer_store_dwordx4 v[28:31], v18, s[24:27], 0 offen
    s_mov_b64 exec, s[50:51]
    v_cmp_ne_u32 vcc, 0, v11
    v_cmp_le_u32 s[52:53], s56, v9
    s_and_b64 vcc, vcc, s[52:53]
    v_cmp_gt_u32 s[52:53], 20, v13
    s_nop 1
    s_and_b64 vcc, vcc, s[52:53]
    s_and_saveexec_b64 s[52:53], vcc
    buffer_store_dwordx2 v[14:15], v16, s[28:31], 0 offen
    v_cmp_eq_u32 vcc, 16, v13
    s_and_saveexec_b64 s[54:55], vcc
    v_mov_b32 v18, 0x3f80
    v_mov_b32 v19, 0
    buffer_store_dwordx2 v[18:19], v16, s[28:31], 0 offen offset:8
    s_mov_b64 exec, -1
    v_add_u32 v9, 56, v5
    v_cmp_gt_u32 vcc, 640, v9
    s_and_saveexec_b64 s[50:51], vcc
    v_mul_f32 v16, s49, v108
    v_mul_f32 v17, s49, v109
    v_mul_f32 v18, s49, v110
    v_mul_f32 v19, s49, v111
    v_cvt_pk_bf16_f32 v14, v16, v17
    v_cvt_pk_bf16_f32 v15, v18, v19
    v_mul_u32_u24 v10, 1280, v8
    v_lshl_add_u32 v10, v9, 1, v10
    buffer_store_dwordx2 v[14:15], v10, s[20:23], 0 offen
    s_mov_b64 exec, s[50:51]
    v_cvt_pk_bf16_f32 v14, v108, v109
    v_cvt_pk_bf16_f32 v15, v110, v111
    v_subrev_u32 v11, 640, v9
    v_cmp_le_u32 vcc, 640, v11
    s_nop 1
    v_cndmask_b32 v16, 0, 1, vcc
    v_mul_u32_u24 v17, 640, v16
    v_sub_u32 v17, v11, v17
    v_lshrrev_b32 v18, 2, v17
    v_mul_u32_u24 v12, 52429, v18
    v_lshrrev_b32 v12, 18, v12
    v_mul_u32_u24 v13, 20, v12
    v_sub_u32 v13, v17, v13
    v_mov_b32 v11, v16
    v_cmp_le_u32 vcc, 640, v9
    v_cmp_gt_u32 s[52:53], 20, v13
    s_nop 1
    s_and_b64 vcc, vcc, s[52:53]
    s_and_saveexec_b64 s[50:51], vcc
    v_lshlrev_b32 v16, 17, v12
    v_lshl_add_u32 v16, v8, 6, v16
    v_lshrrev_b32 v17, 3, v13
    v_lshrrev_b32 v18, 2, v8
    v_and_b32 v18, 3, v18
    v_xor_b32 v17, v17, v18
    v_lshl_add_u32 v17, v17, 4, v16
    v_and_b32 v18, 7, v13
    v_lshl_add_u32 v17, v18, 1, v17
    v_lshl_add_u32 v16, v13, 1, v16
    v_cmp_eq_u32 vcc, 0, v11
    s_and_saveexec_b64 s[52:53], vcc
    buffer_store_dwordx2 v[14:15], v17, s[24:27], 0 offen
    v_cmp_eq_u32 vcc, 16, v13
    s_and_saveexec_b64 s[54:55], vcc
    v_mov_b32 v18, 0
    v_mov_b32 v19, 0
    buffer_store_dwordx2 v[18:19], v17, s[24:27], 0 offen offset:8
    v_lshrrev_b32 v18, 2, v8
    v_and_b32 v18, 3, v18
    v_xor_b32 v18, 3, v18
    v_and_b32 v19, 0xffffffc0, v17
    v_lshl_add_u32 v18, v18, 4, v19
    v_mov_b32 v28, 0
    v_mov_b32 v29, 0
    v_mov_b32 v30, 0
    v_mov_b32 v31, 0
    buffer_store_dwordx4 v[28:31], v18, s[24:27], 0 offen
    s_mov_b64 exec, s[50:51]
    v_cmp_ne_u32 vcc, 0, v11
    v_cmp_le_u32 s[52:53], s56, v9
    s_and_b64 vcc, vcc, s[52:53]
    v_cmp_gt_u32 s[52:53], 20, v13
    s_nop 1
    s_and_b64 vcc, vcc, s[52:53]
    s_and_saveexec_b64 s[52:53], vcc
    buffer_store_dwordx2 v[14:15], v16, s[28:31], 0 offen
    v_cmp_eq_u32 vcc, 16, v13
    s_and_saveexec_b64 s[54:55], vcc
    v_mov_b32 v18, 0x3f80
    v_mov_b32 v19, 0
    buffer_store_dwordx2 v[18:19], v16, s[28:31], 0 offen offset:8
    s_mov_b64 exec, -1
    v_add_u32 v8, 32, v4
    v_fma_f32 v112, -v21, v48, v112
    v_mul_f32 v112, v23, v112
    v_fma_f32 v113, -v21, v49, v113
    v_mul_f32 v113, v23, v113
    v_fma_f32 v114, -v21, v50, v114
    v_mul_f32 v114, v23, v114
    v_fma_f32 v115, -v21, v51, v115
    v_mul_f32 v115, v23, v115
    v_fma_f32 v116, -v21, v52, v116
    v_mul_f32 v116, v23, v116
    v_fma_f32 v117, -v21, v53, v117
    v_mul_f32 v117, v23, v117
    v_fma_f32 v118, -v21, v54, v118
    v_mul_f32 v118, v23, v118
    v_fma_f32 v119, -v21, v55, v119
    v_mul_f32 v119, v23, v119
    v_fma_f32 v120, -v21, v56, v120
    v_mul_f32 v120, v23, v120
    v_fma_f32 v121, -v21, v57, v121
    v_mul_f32 v121, v23, v121
    v_fma_f32 v122, -v21, v58, v122
    v_mul_f32 v122, v23, v122
    v_fma_f32 v123, -v21, v59, v123
    v_mul_f32 v123, v23, v123
    v_fma_f32 v124, -v21, v60, v124
    v_mul_f32 v124, v23, v124
    v_fma_f32 v125, -v21, v61, v125
    v_mul_f32 v125, v23, v125
    v_fma_f32 v126, -v21, v62, v126
    v_mul_f32 v126, v23, v126
    v_fma_f32 v127, -v21, v63, v127
    v_mul_f32 v127, v23, v127
    v_add_u32 v9, 32, v5
    v_cmp_gt_u32 vcc, 640, v9
    s_and_saveexec_b64 s[50:51], vcc
    v_mul_f32 v16, s49, v112
    v_mul_f32 v17, s49, v113
    v_mul_f32 v18, s49, v114
    v_mul_f32 v19, s49, v115
    v_cvt_pk_bf16_f32 v14, v16, v17
    v_cvt_pk_bf16_f32 v15, v18, v19
    v_mul_u32_u24 v10, 1280, v8
    v_lshl_add_u32 v10, v9, 1, v10
    buffer_store_dwordx2 v[14:15], v10, s[20:23], 0 offen
    s_mov_b64 exec, s[50:51]
    v_cvt_pk_bf16_f32 v14, v112, v113
    v_cvt_pk_bf16_f32 v15, v114, v115
    v_subrev_u32 v11, 640, v9
    v_cmp_le_u32 vcc, 640, v11
    s_nop 1
    v_cndmask_b32 v16, 0, 1, vcc
    v_mul_u32_u24 v17, 640, v16
    v_sub_u32 v17, v11, v17
    v_lshrrev_b32 v18, 2, v17
    v_mul_u32_u24 v12, 52429, v18
    v_lshrrev_b32 v12, 18, v12
    v_mul_u32_u24 v13, 20, v12
    v_sub_u32 v13, v17, v13
    v_mov_b32 v11, v16
    v_cmp_le_u32 vcc, 640, v9
    v_cmp_gt_u32 s[52:53], 20, v13
    s_nop 1
    s_and_b64 vcc, vcc, s[52:53]
    s_and_saveexec_b64 s[50:51], vcc
    v_lshlrev_b32 v16, 17, v12
    v_lshl_add_u32 v16, v8, 6, v16
    v_lshrrev_b32 v17, 3, v13
    v_lshrrev_b32 v18, 2, v8
    v_and_b32 v18, 3, v18
    v_xor_b32 v17, v17, v18
    v_lshl_add_u32 v17, v17, 4, v16
    v_and_b32 v18, 7, v13
    v_lshl_add_u32 v17, v18, 1, v17
    v_lshl_add_u32 v16, v13, 1, v16
    v_cmp_eq_u32 vcc, 0, v11
    s_and_saveexec_b64 s[52:53], vcc
    buffer_store_dwordx2 v[14:15], v17, s[24:27], 0 offen
    v_cmp_eq_u32 vcc, 16, v13
    s_and_saveexec_b64 s[54:55], vcc
    v_mov_b32 v18, 0
    v_mov_b32 v19, 0
    buffer_store_dwordx2 v[18:19], v17, s[24:27], 0 offen offset:8
    v_lshrrev_b32 v18, 2, v8
    v_and_b32 v18, 3, v18
    v_xor_b32 v18, 3, v18
    v_and_b32 v19, 0xffffffc0, v17
    v_lshl_add_u32 v18, v18, 4, v19
    v_mov_b32 v28, 0
    v_mov_b32 v29, 0
    v_mov_b32 v30, 0
    v_mov_b32 v31, 0
    buffer_store_dwordx4 v[28:31], v18, s[24:27], 0 offen
    s_mov_b64 exec, s[50:51]
    v_cmp_ne_u32 vcc, 0, v11
    v_cmp_le_u32 s[52:53], s56, v9
    s_and_b64 vcc, vcc, s[52:53]
    v_cmp_gt_u32 s[52:53], 20, v13
    s_nop 1
    s_and_b64 vcc, vcc, s[52:53]
    s_and_saveexec_b64 s[52:53], vcc
    buffer_store_dwordx2 v[14:15], v16, s[28:31], 0 offen
    v_cmp_eq_u32 vcc, 16, v13
    s_and_saveexec_b64 s[54:55], vcc
    v_mov_b32 v18, 0x3f80
    v_mov_b32 v19, 0
    buffer_store_dwordx2 v[18:19], v16, s[28:31], 0 offen offset:8
    s_mov_b64 exec, -1
    v_add_u32 v9, 40, v5
    v_cmp_gt_u32 vcc, 640, v9
    s_and_saveexec_b64 s[50:51], vcc
    v_mul_f32 v16, s49, v116
    v_mul_f32 v17, s49, v117
    v_mul_f32 v18, s49, v118
    v_mul_f32 v19, s49, v119
    v_cvt_pk_bf16_f32 v14, v16, v17
    v_cvt_pk_bf16_f32 v15, v18, v19
    v_mul_u32_u24 v10, 1280, v8
    v_lshl_add_u32 v10, v9, 1, v10
    buffer_store_dwordx2 v[14:15], v10, s[20:23], 0 offen
    s_mov_b64 exec, s[50:51]
    v_cvt_pk_bf16_f32 v14, v116, v117
    v_cvt_pk_bf16_f32 v15, v118, v119
    v_subrev_u32 v11, 640, v9
    v_cmp_le_u32 vcc, 640, v11
    s_nop 1
    v_cndmask_b32 v16, 0, 1, vcc
    v_mul_u32_u24 v17, 640, v16
    v_sub_u32 v17, v11, v17
    v_lshrrev_b32 v18, 2, v17
    v_mul_u32_u24 v12, 52429, v18
    v_lshrrev_b32 v12, 18, v12
    v_mul_u32_u24 v13, 20, v12
    v_sub_u32 v13, v17, v13
    v_mov_b32 v11, v16
    v_cmp_le_u32 vcc, 640, v9
    v_cmp_gt_u32 s[52:53], 20, v13
    s_nop 1
    s_and_b64 vcc, vcc, s[52:53]
    s_and_saveexec_b64 s[50:51], vcc
    v_lshlrev_b32 v16, 17, v12
    v_lshl_add_u32 v16, v8, 6, v16
    v_lshrrev_b32 v17, 3, v13
    v_lshrrev_b32 v18, 2, v8
    v_and_b32 v18, 3, v18
    v_xor_b32 v17, v17, v18
    v_lshl_add_u32 v17, v17, 4, v16
    v_and_b32 v18, 7, v13
    v_lshl_add_u32 v17, v18, 1, v17
    v_lshl_add_u32 v16, v13, 1, v16
    v_cmp_eq_u32 vcc, 0, v11
    s_and_saveexec_b64 s[52:53], vcc
    buffer_store_dwordx2 v[14:15], v17, s[24:27], 0 offen
    v_cmp_eq_u32 vcc, 16, v13
    s_and_saveexec_b64 s[54:55], vcc
    v_mov_b32 v18, 0
    v_mov_b32 v19, 0
    buffer_store_dwordx2 v[18:19], v17, s[24:27], 0 offen offset:8
    v_lshrrev_b32 v18, 2, v8
    v_and_b32 v18, 3, v18
    v_xor_b32 v18, 3, v18
    v_and_b32 v19, 0xffffffc0, v17
    v_lshl_add_u32 v18, v18, 4, v19
    v_mov_b32 v28, 0
    v_mov_b32 v29, 0
    v_mov_b32 v30, 0
    v_mov_b32 v31, 0
    buffer_store_dwordx4 v[28:31], v18, s[24:27], 0 offen
    s_mov_b64 exec, s[50:51]
    v_cmp_ne_u32 vcc, 0, v11
    v_cmp_le_u32 s[52:53], s56, v9
    s_and_b64 vcc, vcc, s[52:53]
    v_cmp_gt_u32 s[52:53], 20, v13
    s_nop 1
    s_and_b64 vcc, vcc, s[52:53]
    s_and_saveexec_b64 s[52:53], vcc
    buffer_store_dwordx2 v[14:15], v16, s[28:31], 0 offen
    v_cmp_eq_u32 vcc, 16, v13
    s_and_saveexec_b64 s[54:55], vcc
    v_mov_b32 v18, 0x3f80
    v_mov_b32 v19, 0
    buffer_store_dwordx2 v[18:19], v16, s[28:31], 0 offen offset:8
    s_mov_b64 exec, -1
    v_add_u32 v9, 48, v5
    v_cmp_gt_u32 vcc, 640, v9
    s_and_saveexec_b64 s[50:51], vcc
    v_mul_f32 v16, s49, v120
    v_mul_f32 v17, s49, v121
    v_mul_f32 v18, s49, v122
    v_mul_f32 v19, s49, v123
    v_cvt_pk_bf16_f32 v14, v16, v17
    v_cvt_pk_bf16_f32 v15, v18, v19
    v_mul_u32_u24 v10, 1280, v8
    v_lshl_add_u32 v10, v9, 1, v10
    buffer_store_dwordx2 v[14:15], v10, s[20:23], 0 offen
    s_mov_b64 exec, s[50:51]
    v_cvt_pk_bf16_f32 v14, v120, v121
    v_cvt_pk_bf16_f32 v15, v122, v123
    v_subrev_u32 v11, 640, v9
    v_cmp_le_u32 vcc, 640, v11
    s_nop 1
    v_cndmask_b32 v16, 0, 1, vcc
    v_mul_u32_u24 v17, 640, v16
    v_sub_u32 v17, v11, v17
    v_lshrrev_b32 v18, 2, v17
    v_mul_u32_u24 v12, 52429, v18
    v_lshrrev_b32 v12, 18, v12
    v_mul_u32_u24 v13, 20, v12
    v_sub_u32 v13, v17, v13
    v_mov_b32 v11, v16
    v_cmp_le_u32 vcc, 640, v9
    v_cmp_gt_u32 s[52:53], 20, v13
    s_nop 1
    s_and_b64 vcc, vcc, s[52:53]
    s_and_saveexec_b64 s[50:51], vcc
    v_lshlrev_b32 v16, 17, v12
    v_lshl_add_u32 v16, v8, 6, v16
    v_lshrrev_b32 v17, 3, v13
    v_lshrrev_b32 v18, 2, v8
    v_and_b32 v18, 3, v18
    v_xor_b32 v17, v17, v18
    v_lshl_add_u32 v17, v17, 4, v16
    v_and_b32 v18, 7, v13
    v_lshl_add_u32 v17, v18, 1, v17
    v_lshl_add_u32 v16, v13, 1, v16
    v_cmp_eq_u32 vcc, 0, v11
    s_and_saveexec_b64 s[52:53], vcc
    buffer_store_dwordx2 v[14:15], v17, s[24:27], 0 offen
    v_cmp_eq_u32 vcc, 16, v13
    s_and_saveexec_b64 s[54:55], vcc
    v_mov_b32 v18, 0
    v_mov_b32 v19, 0
    buffer_store_dwordx2 v[18:19], v17, s[24:27], 0 offen offset:8
    v_lshrrev_b32 v18, 2, v8
    v_and_b32 v18, 3, v18
    v_xor_b32 v18, 3, v18
    v_and_b32 v19, 0xffffffc0, v17
    v_lshl_add_u32 v18, v18, 4, v19
    v_mov_b32 v28, 0
    v_mov_b32 v29, 0
    v_mov_b32 v30, 0
    v_mov_b32 v31, 0
    buffer_store_dwordx4 v[28:31], v18, s[24:27], 0 offen
    s_mov_b64 exec, s[50:51]
    v_cmp_ne_u32 vcc, 0, v11
    v_cmp_le_u32 s[52:53], s56, v9
    s_and_b64 vcc, vcc, s[52:53]
    v_cmp_gt_u32 s[52:53], 20, v13
    s_nop 1
    s_and_b64 vcc, vcc, s[52:53]
    s_and_saveexec_b64 s[52:53], vcc
    buffer_store_dwordx2 v[14:15], v16, s[28:31], 0 offen
    v_cmp_eq_u32 vcc, 16, v13
    s_and_saveexec_b64 s[54:55], vcc
    v_mov_b32 v18, 0x3f80
    v_mov_b32 v19, 0
    buffer_store_dwordx2 v[18:19], v16, s[28:31], 0 offen offset:8
    s_mov_b64 exec, -1
    v_add_u32 v9, 56, v5
    v_cmp_gt_u32 vcc, 640, v9
    s_and_saveexec_b64 s[50:51], vcc
    v_mul_f32 v16, s49, v124
    v_mul_f32 v17, s49, v125
    v_mul_f32 v18, s49, v126
    v_mul_f32 v19, s49, v127
    v_cvt_pk_bf16_f32 v14, v16, v17
    v_cvt_pk_bf16_f32 v15, v18, v19
    v_mul_u32_u24 v10, 1280, v8
    v_lshl_add_u32 v10, v9, 1, v10
    buffer_store_dwordx2 v[14:15], v10, s[20:23], 0 offen
    s_mov_b64 exec, s[50:51]
    v_cvt_pk_bf16_f32 v14, v124, v125
    v_cvt_pk_bf16_f32 v15, v126, v127
    v_subrev_u32 v11, 640, v9
    v_cmp_le_u32 vcc, 640, v11
    s_nop 1
    v_cndmask_b32 v16, 0, 1, vcc
    v_mul_u32_u24 v17, 640, v16
    v_sub_u32 v17, v11, v17
    v_lshrrev_b32 v18, 2, v17
    v_mul_u32_u24 v12, 52429, v18
    v_lshrrev_b32 v12, 18, v12
    v_mul_u32_u24 v13, 20, v12
    v_sub_u32 v13, v17, v13
    v_mov_b32 v11, v16
    v_cmp_le_u32 vcc, 640, v9
    v_cmp_gt_u32 s[52:53], 20, v13
    s_nop 1
    s_and_b64 vcc, vcc, s[52:53]
    s_and_saveexec_b64 s[50:51], vcc
    v_lshlrev_b32 v16, 17, v12
    v_lshl_add_u32 v16, v8, 6, v16
    v_lshrrev_b32 v17, 3, v13
    v_lshrrev_b32 v18, 2, v8
    v_and_b32 v18, 3, v18
    v_xor_b32 v17, v17, v18
    v_lshl_add_u32 v17, v17, 4, v16
    v_and_b32 v18, 7, v13
    v_lshl_add_u32 v17, v18, 1, v17
    v_lshl_add_u32 v16, v13, 1, v16
    v_cmp_eq_u32 vcc, 0, v11
    s_and_saveexec_b64 s[52:53], vcc
    buffer_store_dwordx2 v[14:15], v17, s[24:27], 0 offen
    v_cmp_eq_u32 vcc, 16, v13
    s_and_saveexec_b64 s[54:55], vcc
    v_mov_b32 v18, 0
    v_mov_b32 v19, 0
    buffer_store_dwordx2 v[18:19], v17, s[24:27], 0 offen offset:8
    v_lshrrev_b32 v18, 2, v8
    v_and_b32 v18, 3, v18
    v_xor_b32 v18, 3, v18
    v_and_b32 v19, 0xffffffc0, v17
    v_lshl_add_u32 v18, v18, 4, v19
    v_mov_b32 v28, 0
    v_mov_b32 v29, 0
    v_mov_b32 v30, 0
    v_mov_b32 v31, 0
    buffer_store_dwordx4 v[28:31], v18, s[24:27], 0 offen
    s_mov_b64 exec, s[50:51]
    v_cmp_ne_u32 vcc, 0, v11
    v_cmp_le_u32 s[52:53], s56, v9
    s_and_b64 vcc, vcc, s[52:53]
    v_cmp_gt_u32 s[52:53], 20, v13
    s_nop 1
    s_and_b64 vcc, vcc, s[52:53]
    s_and_saveexec_b64 s[52:53], vcc
    buffer_store_dwordx2 v[14:15], v16, s[28:31], 0 offen
    v_cmp_eq_u32 vcc, 16, v13
    s_and_saveexec_b64 s[54:55], vcc
    v_mov_b32 v18, 0x3f80
    v_mov_b32 v19, 0
    buffer_store_dwordx2 v[18:19], v16, s[28:31], 0 offen offset:8
    s_mov_b64 exec, -1
    s_waitcnt vmcnt(0)
il_qkvB0_kernel_done:
    s_endpgm
.globl il_attnB_kernel
.p2align 8
.type il_attnB_kernel,@function
il_attnB_kernel:
    s_cmp_ge_u32 s2, 512
    s_cbranch_scc1 il_attnB_kernel_done
    s_load_dwordx2 s[4:5], s[0:1], 80
    v_and_b32 v1, 63, v0
    v_lshrrev_b32 v2, 6, v0
    v_lshrrev_b32 v3, 5, v1
    s_waitcnt lgkmcnt(0)
    s_add_u32 s8, s4, 7864320
    s_addc_u32 s9, s5, 0
    s_mov_b32 s10, 2621440
    s_mov_b32 s11, 0x00020000
    s_add_u32 s12, s4, 13107200
    s_addc_u32 s13, s5, 0
    s_mov_b32 s14, 4194304
    s_mov_b32 s15, 0x00020000
    s_add_u32 s16, s4, 17301504
    s_addc_u32 s17, s5, 0
    s_mov_b32 s18, 4194304
    s_mov_b32 s19, 0x00020000
    s_add_u32 s20, s4, 10485760
    s_addc_u32 s21, s5, 0
    s_mov_b32 s22, 2621440
    s_mov_b32 s23, 0x00020000
    s_mov_b32 s60, 0x41000000
    v_and_b32 v4, 31, v1
    v_lshrrev_b32 v5, 2, v4
    v_and_b32 v5, 3, v5
    v_xor_b32 v6, v3, v5
    v_lshlrev_b32 v4, 6, v4
    v_lshl_add_u32 v10, v6, 4, v4
    v_add_u32 v6, 2, v3
    v_xor_b32 v6, v6, v5
    v_lshl_add_u32 v11, v6, 4, v4
    v_and_b32 v4, 15, v1
    v_lshrrev_b32 v4, 2, v4
    v_lshl_add_u32 v4, v3, 2, v4
    v_lshlrev_b32 v4, 6, v4
    v_lshrrev_b32 v5, 4, v1
    v_and_b32 v5, 1, v5
    v_lshl_add_u32 v4, v5, 5, v4
    v_and_b32 v5, 3, v1
    v_lshl_add_u32 v12, v5, 3, v4
    s_and_b32 s34, s2, 31
    s_lshr_b32 s35, s2, 5
    s_lshl_b32 s35, s35, 7
    v_and_b32 v5, 31, v1
    v_lshl_add_u32 v4, v2, 5, v5
    v_add_u32 v4, s35, v4
    v_mul_u32_u24 v4, 1280, v4
    s_mul_i32 s3, s34, 40
    v_add_u32 v13, s3, v4
    v_lshl_add_u32 v4, v3, 4, v13
    buffer_load_dwordx4 v[16:19], v4, s[8:11], 0 offen
    v_lshlrev_b32 v5, 4, v3
    v_sub_u32 v5, v4, v5
    buffer_load_dwordx2 v[20:21], v5, s[8:11], 0 offen offset:32
    v_mov_b32 v22, 0
    v_mov_b32 v23, 0
    s_waitcnt vmcnt(0)
    v_cmp_eq_u32 vcc, 0, v3
    s_nop 1
    v_cndmask_b32 v20, 0, v20, vcc
    v_cndmask_b32 v21, 0, v21, vcc
    v_mov_b32 v96, 0
    v_mov_b32 v80, 0
    v_mov_b32 v97, 0
    v_mov_b32 v81, 0
    v_mov_b32 v98, 0
    v_mov_b32 v82, 0
    v_mov_b32 v99, 0
    v_mov_b32 v83, 0
    v_mov_b32 v100, 0
    v_mov_b32 v84, 0
    v_mov_b32 v101, 0
    v_mov_b32 v85, 0
    v_mov_b32 v102, 0
    v_mov_b32 v86, 0
    v_mov_b32 v103, 0
    v_mov_b32 v87, 0
    v_mov_b32 v104, 0
    v_mov_b32 v88, 0
    v_mov_b32 v105, 0
    v_mov_b32 v89, 0
    v_mov_b32 v106, 0
    v_mov_b32 v90, 0
    v_mov_b32 v107, 0
    v_mov_b32 v91, 0
    v_mov_b32 v108, 0
    v_mov_b32 v92, 0
    v_mov_b32 v109, 0
    v_mov_b32 v93, 0
    v_mov_b32 v110, 0
    v_mov_b32 v94, 0
    v_mov_b32 v111, 0
    v_mov_b32 v95, 0
    v_lshlrev_b32 v14, 4, v1
    v_lshl_add_u32 v14, v2, 10, v14
    s_lshl_b32 s3, s34, 17
    s_lshl_b32 s33, s35, 6
    s_add_u32 s3, s3, s33
    s_sub_u32 s38, 256, s35
    s_max_i32 s38, s38, 0
    s_lshl_b32 s38, s38, 6
    s_add_u32 s3, s3, s38
    s_sub_u32 s3, s3, 16384
    v_add_u32 v14, s3, v14
    v_readfirstlane_b32 s3, v2
    s_lshl_b32 s3, s3, 10
    s_add_u32 s3, s3, s38
    s_add_u32 s33, s3, 0
    s_mov_b32 m0, s33
    s_mov_b32 s37, 0
    buffer_load_dwordx4 v14, s[12:15], s37 offen lds
    s_add_u32 s33, s3, 4096
    s_mov_b32 m0, s33
    s_mov_b32 s37, 4096
    buffer_load_dwordx4 v14, s[12:15], s37 offen lds
    s_add_u32 s33, s3, 8192
    s_mov_b32 m0, s33
    s_mov_b32 s37, 8192
    buffer_load_dwordx4 v14, s[12:15], s37 offen lds
    s_add_u32 s33, s3, 12288
    s_mov_b32 m0, s33
    s_mov_b32 s37, 12288
    buffer_load_dwordx4 v14, s[12:15], s37 offen lds
    s_add_u32 s33, s3, 16384
    s_mov_b32 m0, s33
    s_mov_b32 s37, 16384
    buffer_load_dwordx4 v14, s[12:15], s37 offen lds
    s_add_u32 s33, s3, 20480
    s_mov_b32 m0, s33
    s_mov_b32 s37, 20480
    buffer_load_dwordx4 v14, s[12:15], s37 offen lds
    s_add_u32 s33, s3, 32768
    s_mov_b32 m0, s33
    s_mov_b32 s37, 0
    buffer_load_dwordx4 v14, s[16:19], s37 offen lds
    s_add_u32 s33, s3, 36864
    s_mov_b32 m0, s33
    s_mov_b32 s37, 4096
    buffer_load_dwordx4 v14, s[16:19], s37 offen lds
    s_add_u32 s33, s3, 40960
    s_mov_b32 m0, s33
    s_mov_b32 s37, 8192
    buffer_load_dwordx4 v14, s[16:19], s37 offen lds
    s_add_u32 s33, s3, 45056
    s_mov_b32 m0, s33
    s_mov_b32 s37, 12288
    buffer_load_dwordx4 v14, s[16:19], s37 offen lds
    s_add_u32 s33, s3, 49152
    s_mov_b32 m0, s33
    s_mov_b32 s37, 16384
    buffer_load_dwordx4 v14, s[16:19], s37 offen lds
    s_add_u32 s33, s3, 53248
    s_mov_b32 m0, s33
    s_mov_b32 s37, 20480
    buffer_load_dwordx4 v14, s[16:19], s37 offen lds
    s_waitcnt vmcnt(0)
    s_barrier
    v_lshlrev_b32 v5, 11, v2
    v_add_u32 v10, v10, v5
    v_add_u32 v11, v11, v5
    v_add_u32 v12, v12, v5
    v_readfirstlane_b32 s36, v2
    s_lshl_b32 s36, s36, 5
    s_add_u32 s36, s36, s35
    ds_read_b128 v[24:27], v10 offset:16384
    ds_read_b128 v[28:31], v11 offset:16384
    ds_read_b64_tr_b16 v[32:33], v12 offset:49152
    ds_read_b64_tr_b16 v[34:35], v12 offset:49664
    ds_read_b64_tr_b16 v[36:37], v12 offset:50176
    ds_read_b64_tr_b16 v[38:39], v12 offset:50688
    s_waitcnt lgkmcnt(0)
    v_mfma_f32_32x32x16_bf16 v[64:79], v[24:27], v[16:19], v[80:95]
    v_mfma_f32_32x32x16_bf16 v[64:79], v[28:31], v[20:23], v[64:79]
    s_nop 15
    v_and_b32 v4, 31, v1
    v_lshlrev_b32 v5, 2, v3
    v_sub_u32 v4, v4, v5
    v_mov_b32 v6, 0xff7fffff
    v_cmp_gt_i32 vcc, 0, v4
    v_cndmask_b32 v64, v64, v6, vcc
    v_cmp_gt_i32 vcc, 1, v4
    v_cndmask_b32 v65, v65, v6, vcc
    v_cmp_gt_i32 vcc, 2, v4
    v_cndmask_b32 v66, v66, v6, vcc
    v_cmp_gt_i32 vcc, 3, v4
    v_cndmask_b32 v67, v67, v6, vcc
    v_cmp_gt_i32 vcc, 8, v4
    v_cndmask_b32 v68, v68, v6, vcc
    v_cmp_gt_i32 vcc, 9, v4
    v_cndmask_b32 v69, v69, v6, vcc
    v_cmp_gt_i32 vcc, 10, v4
    v_cndmask_b32 v70, v70, v6, vcc
    v_cmp_gt_i32 vcc, 11, v4
    v_cndmask_b32 v71, v71, v6, vcc
    v_cmp_gt_i32 vcc, 16, v4
    v_cndmask_b32 v72, v72, v6, vcc
    v_cmp_gt_i32 vcc, 17, v4
    v_cndmask_b32 v73, v73, v6, vcc
    v_cmp_gt_i32 vcc, 18, v4
    v_cndmask_b32 v74, v74, v6, vcc
    v_cmp_gt_i32 vcc, 19, v4
    v_cndmask_b32 v75, v75, v6, vcc
    v_cmp_gt_i32 vcc, 24, v4
    v_cndmask_b32 v76, v76, v6, vcc
    v_cmp_gt_i32 vcc, 25, v4
    v_cndmask_b32 v77, v77, v6, vcc
    v_cmp_gt_i32 vcc, 26, v4
    v_cndmask_b32 v78, v78, v6, vcc
    v_cmp_gt_i32 vcc, 27, v4
    v_cndmask_b32 v79, v79, v6, vcc
    v_max3_f32 v40, v64, v65, v66
    v_max3_f32 v40, v40, v67, v68
    v_max3_f32 v40, v40, v69, v70
    v_max3_f32 v40, v40, v71, v72
    v_max3_f32 v40, v40, v73, v74
    v_max3_f32 v40, v40, v75, v76
    v_max3_f32 v40, v40, v77, v78
    v_max_f32 v40, v40, v79
    v_mov_b32 v41, v40
    s_nop 1
    v_permlane32_swap_b32 v41, v40
    s_nop 1
    v_max_f32 v40, v40, v41
    v_sub_f32 v64, v64, v40
    v_sub_f32 v80, 0, v40
    v_sub_f32 v65, v65, v40
    v_sub_f32 v81, 0, v40
    v_sub_f32 v66, v66, v40
    v_sub_f32 v82, 0, v40
    v_sub_f32 v67, v67, v40
    v_sub_f32 v83, 0, v40
    v_sub_f32 v68, v68, v40
    v_sub_f32 v84, 0, v40
    v_sub_f32 v69, v69, v40
    v_sub_f32 v85, 0, v40
    v_sub_f32 v70, v70, v40
    v_sub_f32 v86, 0, v40
    v_sub_f32 v71, v71, v40
    v_sub_f32 v87, 0, v40
    v_sub_f32 v72, v72, v40
    v_sub_f32 v88, 0, v40
    v_sub_f32 v73, v73, v40
    v_sub_f32 v89, 0, v40
    v_sub_f32 v74, v74, v40
    v_sub_f32 v90, 0, v40
    v_sub_f32 v75, v75, v40
    v_sub_f32 v91, 0, v40
    v_sub_f32 v76, v76, v40
    v_sub_f32 v92, 0, v40
    v_sub_f32 v77, v77, v40
    v_sub_f32 v93, 0, v40
    v_sub_f32 v78, v78, v40
    v_sub_f32 v94, 0, v40
    v_sub_f32 v79, v79, v40
    v_sub_f32 v95, 0, v40
    v_max3_f32 v40, v64, v65, v66
    v_max3_f32 v40, v40, v67, v68
    v_max3_f32 v40, v40, v69, v70
    v_max3_f32 v40, v40, v71, v72
    v_max3_f32 v40, v40, v73, v74
    v_max3_f32 v40, v40, v75, v76
    v_max3_f32 v40, v40, v77, v78
    v_max_f32 v40, v40, v79
    v_cmp_lt_f32 vcc, s60, v40
    s_cbranch_vccz il_attnB_kernel_ok_8
    v_mov_b32 v41, v40
    s_nop 1
    v_permlane32_swap_b32 v41, v40
    s_nop 1
    v_max_f32 v40, v40, v41
    v_max_f32 v40, 0, v40
    v_sub_f32 v41, 0, v40
    v_exp_f32 v41, v41
    s_nop 0
    v_mul_f32 v96, v96, v41
    v_sub_f32 v64, v64, v40
    v_sub_f32 v80, v80, v40
    v_mul_f32 v97, v97, v41
    v_sub_f32 v65, v65, v40
    v_sub_f32 v81, v81, v40
    v_mul_f32 v98, v98, v41
    v_sub_f32 v66, v66, v40
    v_sub_f32 v82, v82, v40
    v_mul_f32 v99, v99, v41
    v_sub_f32 v67, v67, v40
    v_sub_f32 v83, v83, v40
    v_mul_f32 v100, v100, v41
    v_sub_f32 v68, v68, v40
    v_sub_f32 v84, v84, v40
    v_mul_f32 v101, v101, v41
    v_sub_f32 v69, v69, v40
    v_sub_f32 v85, v85, v40
    v_mul_f32 v102, v102, v41
    v_sub_f32 v70, v70, v40
    v_sub_f32 v86, v86, v40
    v_mul_f32 v103, v103, v41
    v_sub_f32 v71, v71, v40
    v_sub_f32 v87, v87, v40
    v_mul_f32 v104, v104, v41
    v_sub_f32 v72, v72, v40
    v_sub_f32 v88, v88, v40
    v_mul_f32 v105, v105, v41
    v_sub_f32 v73, v73, v40
    v_sub_f32 v89, v89, v40
    v_mul_f32 v106, v106, v41
    v_sub_f32 v74, v74, v40
    v_sub_f32 v90, v90, v40
    v_mul_f32 v107, v107, v41
    v_sub_f32 v75, v75, v40
    v_sub_f32 v91, v91, v40
    v_mul_f32 v108, v108, v41
    v_sub_f32 v76, v76, v40
    v_sub_f32 v92, v92, v40
    v_mul_f32 v109, v109, v41
    v_sub_f32 v77, v77, v40
    v_sub_f32 v93, v93, v40
    v_mul_f32 v110, v110, v41
    v_sub_f32 v78, v78, v40
    v_sub_f32 v94, v94, v40
    v_mul_f32 v111, v111, v41
    v_sub_f32 v79, v79, v40
    v_sub_f32 v95, v95, v40
il_attnB_kernel_ok_8:
    v_exp_f32 v64, v64
    v_exp_f32 v65, v65
    v_exp_f32 v66, v66
    v_exp_f32 v67, v67
    v_exp_f32 v68, v68
    v_exp_f32 v69, v69
    v_exp_f32 v70, v70
    v_exp_f32 v71, v71
    v_exp_f32 v72, v72
    v_exp_f32 v73, v73
    v_exp_f32 v74, v74
    v_exp_f32 v75, v75
    v_exp_f32 v76, v76
    v_exp_f32 v77, v77
    v_exp_f32 v78, v78
    v_exp_f32 v79, v79
    s_nop 0
    v_cvt_pk_bf16_f32 v112, v64, v65
    v_cvt_pk_bf16_f32 v113, v66, v67
    v_cvt_pk_bf16_f32 v114, v68, v69
    v_cvt_pk_bf16_f32 v115, v70, v71
    v_cvt_pk_bf16_f32 v116, v72, v73
    v_cvt_pk_bf16_f32 v117, v74, v75
    v_cvt_pk_bf16_f32 v118, v76, v77
    v_cvt_pk_bf16_f32 v119, v78, v79
    s_nop 1
    v_mfma_f32_32x32x16_bf16 v[96:111], v[32:35], v[112:115], v[96:111]
    v_mfma_f32_32x32x16_bf16 v[96:111], v[36:39], v[116:119], v[96:111]
    s_cmp_lt_u32 s36, 256
    s_cbranch_scc1 il_attnB_kernel_skip0
    ds_read_b128 v[24:27], v10 offset:0
    ds_read_b128 v[28:31], v11 offset:0
    ds_read_b64_tr_b16 v[32:33], v12 offset:32768
    ds_read_b64_tr_b16 v[34:35], v12 offset:33280
    ds_read_b64_tr_b16 v[36:37], v12 offset:33792
    ds_read_b64_tr_b16 v[38:39], v12 offset:34304
    s_waitcnt lgkmcnt(0)
    v_mfma_f32_32x32x16_bf16 v[64:79], v[24:27], v[16:19], v[80:95]
    v_mfma_f32_32x32x16_bf16 v[64:79], v[28:31], v[20:23], v[64:79]
    s_nop 15
    v_and_b32 v4, 31, v1
    v_lshlrev_b32 v5, 2, v3
    v_sub_u32 v4, v4, v5
    v_mov_b32 v6, 0xff7fffff
    v_cmp_le_i32 vcc, 0, v4
    v_cndmask_b32 v64, v64, v6, vcc
    v_cmp_le_i32 vcc, 1, v4
    v_cndmask_b32 v65, v65, v6, vcc
    v_cmp_le_i32 vcc, 2, v4
    v_cndmask_b32 v66, v66, v6, vcc
    v_cmp_le_i32 vcc, 3, v4
    v_cndmask_b32 v67, v67, v6, vcc
    v_cmp_le_i32 vcc, 8, v4
    v_cndmask_b32 v68, v68, v6, vcc
    v_cmp_le_i32 vcc, 9, v4
    v_cndmask_b32 v69, v69, v6, vcc
    v_cmp_le_i32 vcc, 10, v4
    v_cndmask_b32 v70, v70, v6, vcc
    v_cmp_le_i32 vcc, 11, v4
    v_cndmask_b32 v71, v71, v6, vcc
    v_cmp_le_i32 vcc, 16, v4
    v_cndmask_b32 v72, v72, v6, vcc
    v_cmp_le_i32 vcc, 17, v4
    v_cndmask_b32 v73, v73, v6, vcc
    v_cmp_le_i32 vcc, 18, v4
    v_cndmask_b32 v74, v74, v6, vcc
    v_cmp_le_i32 vcc, 19, v4
    v_cndmask_b32 v75, v75, v6, vcc
    v_cmp_le_i32 vcc, 24, v4
    v_cndmask_b32 v76, v76, v6, vcc
    v_cmp_le_i32 vcc, 25, v4
    v_cndmask_b32 v77, v77, v6, vcc
    v_cmp_le_i32 vcc, 26, v4
    v_cndmask_b32 v78, v78, v6, vcc
    v_cmp_le_i32 vcc, 27, v4
    v_cndmask_b32 v79, v79, v6, vcc
    v_max3_f32 v40, v64, v65, v66
    v_max3_f32 v40, v40, v67, v68
    v_max3_f32 v40, v40, v69, v70
    v_max3_f32 v40, v40, v71, v72
    v_max3_f32 v40, v40, v73, v74
    v_max3_f32 v40, v40, v75, v76
    v_max3_f32 v40, v40, v77, v78
    v_max_f32 v40, v40, v79
    v_cmp_lt_f32 vcc, s60, v40
    s_cbranch_vccz il_attnB_kernel_ok_0
    v_mov_b32 v41, v40
    s_nop 1
    v_permlane32_swap_b32 v41, v40
    s_nop 1
    v_max_f32 v40, v40, v41
    v_max_f32 v40, 0, v40
    v_sub_f32 v41, 0, v40
    v_exp_f32 v41, v41
    s_nop 0
    v_mul_f32 v96, v96, v41
    v_sub_f32 v64, v64, v40
    v_sub_f32 v80, v80, v40
    v_mul_f32 v97, v97, v41
    v_sub_f32 v65, v65, v40
    v_sub_f32 v81, v81, v40
    v_mul_f32 v98, v98, v41
    v_sub_f32 v66, v66, v40
    v_sub_f32 v82, v82, v40
    v_mul_f32 v99, v99, v41
    v_sub_f32 v67, v67, v40
    v_sub_f32 v83, v83, v40
    v_mul_f32 v100, v100, v41
    v_sub_f32 v68, v68, v40
    v_sub_f32 v84, v84, v40
    v_mul_f32 v101, v101, v41
    v_sub_f32 v69, v69, v40
    v_sub_f32 v85, v85, v40
    v_mul_f32 v102, v102, v41
    v_sub_f32 v70, v70, v40
    v_sub_f32 v86, v86, v40
    v_mul_f32 v103, v103, v41
    v_sub_f32 v71, v71, v40
    v_sub_f32 v87, v87, v40
    v_mul_f32 v104, v104, v41
    v_sub_f32 v72, v72, v40
    v_sub_f32 v88, v88, v40
    v_mul_f32 v105, v105, v41
    v_sub_f32 v73, v73, v40
    v_sub_f32 v89, v89, v40
    v_mul_f32 v106, v106, v41
    v_sub_f32 v74, v74, v40
    v_sub_f32 v90, v90, v40
    v_mul_f32 v107, v107, v41
    v_sub_f32 v75, v75, v40
    v_sub_f32 v91, v91, v40
    v_mul_f32 v108, v108, v41
    v_sub_f32 v76, v76, v40
    v_sub_f32 v92, v92, v40
    v_mul_f32 v109, v109, v41
    v_sub_f32 v77, v77, v40
    v_sub_f32 v93, v93, v40
    v_mul_f32 v110, v110, v41
    v_sub_f32 v78, v78, v40
    v_sub_f32 v94, v94, v40
    v_mul_f32 v111, v111, v41
    v_sub_f32 v79, v79, v40
    v_sub_f32 v95, v95, v40
il_attnB_kernel_ok_0:
    v_exp_f32 v64, v64
    v_exp_f32 v65, v65
    v_exp_f32 v66, v66
    v_exp_f32 v67, v67
    v_exp_f32 v68, v68
    v_exp_f32 v69, v69
    v_exp_f32 v70, v70
    v_exp_f32 v71, v71
    v_exp_f32 v72, v72
    v_exp_f32 v73, v73
    v_exp_f32 v74, v74
    v_exp_f32 v75, v75
    v_exp_f32 v76, v76
    v_exp_f32 v77, v77
    v_exp_f32 v78, v78
    v_exp_f32 v79, v79
    s_nop 0
    v_cvt_pk_bf16_f32 v112, v64, v65
    v_cvt_pk_bf16_f32 v113, v66, v67
    v_cvt_pk_bf16_f32 v114, v68, v69
    v_cvt_pk_bf16_f32 v115, v70, v71
    v_cvt_pk_bf16_f32 v116, v72, v73
    v_cvt_pk_bf16_f32 v117, v74, v75
    v_cvt_pk_bf16_f32 v118, v76, v77
    v_cvt_pk_bf16_f32 v119, v78, v79
    s_nop 1
    v_mfma_f32_32x32x16_bf16 v[96:111], v[32:35], v[112:115], v[96:111]
    v_mfma_f32_32x32x16_bf16 v[96:111], v[36:39], v[116:119], v[96:111]
il_attnB_kernel_skip0:
    s_cmp_lt_u32 s36, 224
    s_cbranch_scc1 il_attnB_kernel_skip1
    ds_read_b128 v[24:27], v10 offset:2048
    ds_read_b128 v[28:31], v11 offset:2048
    ds_read_b64_tr_b16 v[32:33], v12 offset:34816
    ds_read_b64_tr_b16 v[34:35], v12 offset:35328
    ds_read_b64_tr_b16 v[36:37], v12 offset:35840
    ds_read_b64_tr_b16 v[38:39], v12 offset:36352
    s_waitcnt lgkmcnt(0)
    v_mfma_f32_32x32x16_bf16 v[64:79], v[24:27], v[16:19], v[80:95]
    v_mfma_f32_32x32x16_bf16 v[64:79], v[28:31], v[20:23], v[64:79]
    s_nop 15
    v_max3_f32 v40, v64, v65, v66
    v_max3_f32 v40, v40, v67, v68
    v_max3_f32 v40, v40, v69, v70
    v_max3_f32 v40, v40, v71, v72
    v_max3_f32 v40, v40, v73, v74
    v_max3_f32 v40, v40, v75, v76
    v_max3_f32 v40, v40, v77, v78
    v_max_f32 v40, v40, v79
    v_cmp_lt_f32 vcc, s60, v40
    s_cbranch_vccz il_attnB_kernel_ok_1
    v_mov_b32 v41, v40
    s_nop 1
    v_permlane32_swap_b32 v41, v40
    s_nop 1
    v_max_f32 v40, v40, v41
    v_max_f32 v40, 0, v40
    v_sub_f32 v41, 0, v40
    v_exp_f32 v41, v41
    s_nop 0
    v_mul_f32 v96, v96, v41
    v_sub_f32 v64, v64, v40
    v_sub_f32 v80, v80, v40
    v_mul_f32 v97, v97, v41
    v_sub_f32 v65, v65, v40
    v_sub_f32 v81, v81, v40
    v_mul_f32 v98, v98, v41
    v_sub_f32 v66, v66, v40
    v_sub_f32 v82, v82, v40
    v_mul_f32 v99, v99, v41
    v_sub_f32 v67, v67, v40
    v_sub_f32 v83, v83, v40
    v_mul_f32 v100, v100, v41
    v_sub_f32 v68, v68, v40
    v_sub_f32 v84, v84, v40
    v_mul_f32 v101, v101, v41
    v_sub_f32 v69, v69, v40
    v_sub_f32 v85, v85, v40
    v_mul_f32 v102, v102, v41
    v_sub_f32 v70, v70, v40
    v_sub_f32 v86, v86, v40
    v_mul_f32 v103, v103, v41
    v_sub_f32 v71, v71, v40
    v_sub_f32 v87, v87, v40
    v_mul_f32 v104, v104, v41
    v_sub_f32 v72, v72, v40
    v_sub_f32 v88, v88, v40
    v_mul_f32 v105, v105, v41
    v_sub_f32 v73, v73, v40
    v_sub_f32 v89, v89, v40
    v_mul_f32 v106, v106, v41
    v_sub_f32 v74, v74, v40
    v_sub_f32 v90, v90, v40
    v_mul_f32 v107, v107, v41
    v_sub_f32 v75, v75, v40
    v_sub_f32 v91, v91, v40
    v_mul_f32 v108, v108, v41
    v_sub_f32 v76, v76, v40
    v_sub_f32 v92, v92, v40
    v_mul_f32 v109, v109, v41
    v_sub_f32 v77, v77, v40
    v_sub_f32 v93, v93, v40
    v_mul_f32 v110, v110, v41
    v_sub_f32 v78, v78, v40
    v_sub_f32 v94, v94, v40
    v_mul_f32 v111, v111, v41
    v_sub_f32 v79, v79, v40
    v_sub_f32 v95, v95, v40
il_attnB_kernel_ok_1:
    v_exp_f32 v64, v64
    v_exp_f32 v65, v65
    v_exp_f32 v66, v66
    v_exp_f32 v67, v67
    v_exp_f32 v68, v68
    v_exp_f32 v69, v69
    v_exp_f32 v70, v70
    v_exp_f32 v71, v71
    v_exp_f32 v72, v72
    v_exp_f32 v73, v73
    v_exp_f32 v74, v74
    v_exp_f32 v75, v75
    v_exp_f32 v76, v76
    v_exp_f32 v77, v77
    v_exp_f32 v78, v78
    v_exp_f32 v79, v79
    s_nop 0
    v_cvt_pk_bf16_f32 v112, v64, v65
    v_cvt_pk_bf16_f32 v113, v66, v67
    v_cvt_pk_bf16_f32 v114, v68, v69
    v_cvt_pk_bf16_f32 v115, v70, v71
    v_cvt_pk_bf16_f32 v116, v72, v73
    v_cvt_pk_bf16_f32 v117, v74, v75
    v_cvt_pk_bf16_f32 v118, v76, v77
    v_cvt_pk_bf16_f32 v119, v78, v79
    s_nop 1
    v_mfma_f32_32x32x16_bf16 v[96:111], v[32:35], v[112:115], v[96:111]
    v_mfma_f32_32x32x16_bf16 v[96:111], v[36:39], v[116:119], v[96:111]
il_attnB_kernel_skip1:
    s_cmp_lt_u32 s36, 192
    s_cbranch_scc1 il_attnB_kernel_skip2
    ds_read_b128 v[24:27], v10 offset:4096
    ds_read_b128 v[28:31], v11 offset:4096
    ds_read_b64_tr_b16 v[32:33], v12 offset:36864
    ds_read_b64_tr_b16 v[34:35], v12 offset:37376
    ds_read_b64_tr_b16 v[36:37], v12 offset:37888
    ds_read_b64_tr_b16 v[38:39], v12 offset:38400
    s_waitcnt lgkmcnt(0)
    v_mfma_f32_32x32x16_bf16 v[64:79], v[24:27], v[16:19], v[80:95]
    v_mfma_f32_32x32x16_bf16 v[64:79], v[28:31], v[20:23], v[64:79]
    s_nop 15
    v_max3_f32 v40, v64, v65, v66
    v_max3_f32 v40, v40, v67, v68
    v_max3_f32 v40, v40, v69, v70
    v_max3_f32 v40, v40, v71, v72
    v_max3_f32 v40, v40, v73, v74
    v_max3_f32 v40, v40, v75, v76
    v_max3_f32 v40, v40, v77, v78
    v_max_f32 v40, v40, v79
    v_cmp_lt_f32 vcc, s60, v40
    s_cbranch_vccz il_attnB_kernel_ok_2
    v_mov_b32 v41, v40
    s_nop 1
    v_permlane32_swap_b32 v41, v40
    s_nop 1
    v_max_f32 v40, v40, v41
    v_max_f32 v40, 0, v40
    v_sub_f32 v41, 0, v40
    v_exp_f32 v41, v41
    s_nop 0
    v_mul_f32 v96, v96, v41
    v_sub_f32 v64, v64, v40
    v_sub_f32 v80, v80, v40
    v_mul_f32 v97, v97, v41
    v_sub_f32 v65, v65, v40
    v_sub_f32 v81, v81, v40
    v_mul_f32 v98, v98, v41
    v_sub_f32 v66, v66, v40
    v_sub_f32 v82, v82, v40
    v_mul_f32 v99, v99, v41
    v_sub_f32 v67, v67, v40
    v_sub_f32 v83, v83, v40
    v_mul_f32 v100, v100, v41
    v_sub_f32 v68, v68, v40
    v_sub_f32 v84, v84, v40
    v_mul_f32 v101, v101, v41
    v_sub_f32 v69, v69, v40
    v_sub_f32 v85, v85, v40
    v_mul_f32 v102, v102, v41
    v_sub_f32 v70, v70, v40
    v_sub_f32 v86, v86, v40
    v_mul_f32 v103, v103, v41
    v_sub_f32 v71, v71, v40
    v_sub_f32 v87, v87, v40
    v_mul_f32 v104, v104, v41
    v_sub_f32 v72, v72, v40
    v_sub_f32 v88, v88, v40
    v_mul_f32 v105, v105, v41
    v_sub_f32 v73, v73, v40
    v_sub_f32 v89, v89, v40
    v_mul_f32 v106, v106, v41
    v_sub_f32 v74, v74, v40
    v_sub_f32 v90, v90, v40
    v_mul_f32 v107, v107, v41
    v_sub_f32 v75, v75, v40
    v_sub_f32 v91, v91, v40
    v_mul_f32 v108, v108, v41
    v_sub_f32 v76, v76, v40
    v_sub_f32 v92, v92, v40
    v_mul_f32 v109, v109, v41
    v_sub_f32 v77, v77, v40
    v_sub_f32 v93, v93, v40
    v_mul_f32 v110, v110, v41
    v_sub_f32 v78, v78, v40
    v_sub_f32 v94, v94, v40
    v_mul_f32 v111, v111, v41
    v_sub_f32 v79, v79, v40
    v_sub_f32 v95, v95, v40
il_attnB_kernel_ok_2:
    v_exp_f32 v64, v64
    v_exp_f32 v65, v65
    v_exp_f32 v66, v66
    v_exp_f32 v67, v67
    v_exp_f32 v68, v68
    v_exp_f32 v69, v69
    v_exp_f32 v70, v70
    v_exp_f32 v71, v71
    v_exp_f32 v72, v72
    v_exp_f32 v73, v73
    v_exp_f32 v74, v74
    v_exp_f32 v75, v75
    v_exp_f32 v76, v76
    v_exp_f32 v77, v77
    v_exp_f32 v78, v78
    v_exp_f32 v79, v79
    s_nop 0
    v_cvt_pk_bf16_f32 v112, v64, v65
    v_cvt_pk_bf16_f32 v113, v66, v67
    v_cvt_pk_bf16_f32 v114, v68, v69
    v_cvt_pk_bf16_f32 v115, v70, v71
    v_cvt_pk_bf16_f32 v116, v72, v73
    v_cvt_pk_bf16_f32 v117, v74, v75
    v_cvt_pk_bf16_f32 v118, v76, v77
    v_cvt_pk_bf16_f32 v119, v78, v79
    s_nop 1
    v_mfma_f32_32x32x16_bf16 v[96:111], v[32:35], v[112:115], v[96:111]
    v_mfma_f32_32x32x16_bf16 v[96:111], v[36:39], v[116:119], v[96:111]
il_attnB_kernel_skip2:
    s_cmp_lt_u32 s36, 160
    s_cbranch_scc1 il_attnB_kernel_skip3
    ds_read_b128 v[24:27], v10 offset:6144
    ds_read_b128 v[28:31], v11 offset:6144
    ds_read_b64_tr_b16 v[32:33], v12 offset:38912
    ds_read_b64_tr_b16 v[34:35], v12 offset:39424
    ds_read_b64_tr_b16 v[36:37], v12 offset:39936
    ds_read_b64_tr_b16 v[38:39], v12 offset:40448
    s_waitcnt lgkmcnt(0)
    v_mfma_f32_32x32x16_bf16 v[64:79], v[24:27], v[16:19], v[80:95]
    v_mfma_f32_32x32x16_bf16 v[64:79], v[28:31], v[20:23], v[64:79]
    s_nop 15
    v_max3_f32 v40, v64, v65, v66
    v_max3_f32 v40, v40, v67, v68
    v_max3_f32 v40, v40, v69, v70
    v_max3_f32 v40, v40, v71, v72
    v_max3_f32 v40, v40, v73, v74
    v_max3_f32 v40, v40, v75, v76
    v_max3_f32 v40, v40, v77, v78
    v_max_f32 v40, v40, v79
    v_cmp_lt_f32 vcc, s60, v40
    s_cbranch_vccz il_attnB_kernel_ok_3
    v_mov_b32 v41, v40
    s_nop 1
    v_permlane32_swap_b32 v41, v40
    s_nop 1
    v_max_f32 v40, v40, v41
    v_max_f32 v40, 0, v40
    v_sub_f32 v41, 0, v40
    v_exp_f32 v41, v41
    s_nop 0
    v_mul_f32 v96, v96, v41
    v_sub_f32 v64, v64, v40
    v_sub_f32 v80, v80, v40
    v_mul_f32 v97, v97, v41
    v_sub_f32 v65, v65, v40
    v_sub_f32 v81, v81, v40
    v_mul_f32 v98, v98, v41
    v_sub_f32 v66, v66, v40
    v_sub_f32 v82, v82, v40
    v_mul_f32 v99, v99, v41
    v_sub_f32 v67, v67, v40
    v_sub_f32 v83, v83, v40
    v_mul_f32 v100, v100, v41
    v_sub_f32 v68, v68, v40
    v_sub_f32 v84, v84, v40
    v_mul_f32 v101, v101, v41
    v_sub_f32 v69, v69, v40
    v_sub_f32 v85, v85, v40
    v_mul_f32 v102, v102, v41
    v_sub_f32 v70, v70, v40
    v_sub_f32 v86, v86, v40
    v_mul_f32 v103, v103, v41
    v_sub_f32 v71, v71, v40
    v_sub_f32 v87, v87, v40
    v_mul_f32 v104, v104, v41
    v_sub_f32 v72, v72, v40
    v_sub_f32 v88, v88, v40
    v_mul_f32 v105, v105, v41
    v_sub_f32 v73, v73, v40
    v_sub_f32 v89, v89, v40
    v_mul_f32 v106, v106, v41
    v_sub_f32 v74, v74, v40
    v_sub_f32 v90, v90, v40
    v_mul_f32 v107, v107, v41
    v_sub_f32 v75, v75, v40
    v_sub_f32 v91, v91, v40
    v_mul_f32 v108, v108, v41
    v_sub_f32 v76, v76, v40
    v_sub_f32 v92, v92, v40
    v_mul_f32 v109, v109, v41
    v_sub_f32 v77, v77, v40
    v_sub_f32 v93, v93, v40
    v_mul_f32 v110, v110, v41
    v_sub_f32 v78, v78, v40
    v_sub_f32 v94, v94, v40
    v_mul_f32 v111, v111, v41
    v_sub_f32 v79, v79, v40
    v_sub_f32 v95, v95, v40
il_attnB_kernel_ok_3:
    v_exp_f32 v64, v64
    v_exp_f32 v65, v65
    v_exp_f32 v66, v66
    v_exp_f32 v67, v67
    v_exp_f32 v68, v68
    v_exp_f32 v69, v69
    v_exp_f32 v70, v70
    v_exp_f32 v71, v71
    v_exp_f32 v72, v72
    v_exp_f32 v73, v73
    v_exp_f32 v74, v74
    v_exp_f32 v75, v75
    v_exp_f32 v76, v76
    v_exp_f32 v77, v77
    v_exp_f32 v78, v78
    v_exp_f32 v79, v79
    s_nop 0
    v_cvt_pk_bf16_f32 v112, v64, v65
    v_cvt_pk_bf16_f32 v113, v66, v67
    v_cvt_pk_bf16_f32 v114, v68, v69
    v_cvt_pk_bf16_f32 v115, v70, v71
    v_cvt_pk_bf16_f32 v116, v72, v73
    v_cvt_pk_bf16_f32 v117, v74, v75
    v_cvt_pk_bf16_f32 v118, v76, v77
    v_cvt_pk_bf16_f32 v119, v78, v79
    s_nop 1
    v_mfma_f32_32x32x16_bf16 v[96:111], v[32:35], v[112:115], v[96:111]
    v_mfma_f32_32x32x16_bf16 v[96:111], v[36:39], v[116:119], v[96:111]
il_attnB_kernel_skip3:
    s_cmp_lt_u32 s36, 128
    s_cbranch_scc1 il_attnB_kernel_skip4
    ds_read_b128 v[24:27], v10 offset:8192
    ds_read_b128 v[28:31], v11 offset:8192
    ds_read_b64_tr_b16 v[32:33], v12 offset:40960
    ds_read_b64_tr_b16 v[34:35], v12 offset:41472
    ds_read_b64_tr_b16 v[36:37], v12 offset:41984
    ds_read_b64_tr_b16 v[38:39], v12 offset:42496
    s_waitcnt lgkmcnt(0)
    v_mfma_f32_32x32x16_bf16 v[64:79], v[24:27], v[16:19], v[80:95]
    v_mfma_f32_32x32x16_bf16 v[64:79], v[28:31], v[20:23], v[64:79]
    s_nop 15
    v_max3_f32 v40, v64, v65, v66
    v_max3_f32 v40, v40, v67, v68
    v_max3_f32 v40, v40, v69, v70
    v_max3_f32 v40, v40, v71, v72
    v_max3_f32 v40, v40, v73, v74
    v_max3_f32 v40, v40, v75, v76
    v_max3_f32 v40, v40, v77, v78
    v_max_f32 v40, v40, v79
    v_cmp_lt_f32 vcc, s60, v40
    s_cbranch_vccz il_attnB_kernel_ok_4
    v_mov_b32 v41, v40
    s_nop 1
    v_permlane32_swap_b32 v41, v40
    s_nop 1
    v_max_f32 v40, v40, v41
    v_max_f32 v40, 0, v40
    v_sub_f32 v41, 0, v40
    v_exp_f32 v41, v41
    s_nop 0
    v_mul_f32 v96, v96, v41
    v_sub_f32 v64, v64, v40
    v_sub_f32 v80, v80, v40
    v_mul_f32 v97, v97, v41
    v_sub_f32 v65, v65, v40
    v_sub_f32 v81, v81, v40
    v_mul_f32 v98, v98, v41
    v_sub_f32 v66, v66, v40
    v_sub_f32 v82, v82, v40
    v_mul_f32 v99, v99, v41
    v_sub_f32 v67, v67, v40
    v_sub_f32 v83, v83, v40
    v_mul_f32 v100, v100, v41
    v_sub_f32 v68, v68, v40
    v_sub_f32 v84, v84, v40
    v_mul_f32 v101, v101, v41
    v_sub_f32 v69, v69, v40
    v_sub_f32 v85, v85, v40
    v_mul_f32 v102, v102, v41
    v_sub_f32 v70, v70, v40
    v_sub_f32 v86, v86, v40
    v_mul_f32 v103, v103, v41
    v_sub_f32 v71, v71, v40
    v_sub_f32 v87, v87, v40
    v_mul_f32 v104, v104, v41
    v_sub_f32 v72, v72, v40
    v_sub_f32 v88, v88, v40
    v_mul_f32 v105, v105, v41
    v_sub_f32 v73, v73, v40
    v_sub_f32 v89, v89, v40
    v_mul_f32 v106, v106, v41
    v_sub_f32 v74, v74, v40
    v_sub_f32 v90, v90, v40
    v_mul_f32 v107, v107, v41
    v_sub_f32 v75, v75, v40
    v_sub_f32 v91, v91, v40
    v_mul_f32 v108, v108, v41
    v_sub_f32 v76, v76, v40
    v_sub_f32 v92, v92, v40
    v_mul_f32 v109, v109, v41
    v_sub_f32 v77, v77, v40
    v_sub_f32 v93, v93, v40
    v_mul_f32 v110, v110, v41
    v_sub_f32 v78, v78, v40
    v_sub_f32 v94, v94, v40
    v_mul_f32 v111, v111, v41
    v_sub_f32 v79, v79, v40
    v_sub_f32 v95, v95, v40
il_attnB_kernel_ok_4:
    v_exp_f32 v64, v64
    v_exp_f32 v65, v65
    v_exp_f32 v66, v66
    v_exp_f32 v67, v67
    v_exp_f32 v68, v68
    v_exp_f32 v69, v69
    v_exp_f32 v70, v70
    v_exp_f32 v71, v71
    v_exp_f32 v72, v72
    v_exp_f32 v73, v73
    v_exp_f32 v74, v74
    v_exp_f32 v75, v75
    v_exp_f32 v76, v76
    v_exp_f32 v77, v77
    v_exp_f32 v78, v78
    v_exp_f32 v79, v79
    s_nop 0
    v_cvt_pk_bf16_f32 v112, v64, v65
    v_cvt_pk_bf16_f32 v113, v66, v67
    v_cvt_pk_bf16_f32 v114, v68, v69
    v_cvt_pk_bf16_f32 v115, v70, v71
    v_cvt_pk_bf16_f32 v116, v72, v73
    v_cvt_pk_bf16_f32 v117, v74, v75
    v_cvt_pk_bf16_f32 v118, v76, v77
    v_cvt_pk_bf16_f32 v119, v78, v79
    s_nop 1
    v_mfma_f32_32x32x16_bf16 v[96:111], v[32:35], v[112:115], v[96:111]
    v_mfma_f32_32x32x16_bf16 v[96:111], v[36:39], v[116:119], v[96:111]
il_attnB_kernel_skip4:
    s_cmp_lt_u32 s36, 96
    s_cbranch_scc1 il_attnB_kernel_skip5
    ds_read_b128 v[24:27], v10 offset:10240
    ds_read_b128 v[28:31], v11 offset:10240
    ds_read_b64_tr_b16 v[32:33], v12 offset:43008
    ds_read_b64_tr_b16 v[34:35], v12 offset:43520
    ds_read_b64_tr_b16 v[36:37], v12 offset:44032
    ds_read_b64_tr_b16 v[38:39], v12 offset:44544
    s_waitcnt lgkmcnt(0)
    v_mfma_f32_32x32x16_bf16 v[64:79], v[24:27], v[16:19], v[80:95]
    v_mfma_f32_32x32x16_bf16 v[64:79], v[28:31], v[20:23], v[64:79]
    s_nop 15
    v_max3_f32 v40, v64, v65, v66
    v_max3_f32 v40, v40, v67, v68
    v_max3_f32 v40, v40, v69, v70
    v_max3_f32 v40, v40, v71, v72
    v_max3_f32 v40, v40, v73, v74
    v_max3_f32 v40, v40, v75, v76
    v_max3_f32 v40, v40, v77, v78
    v_max_f32 v40, v40, v79
    v_cmp_lt_f32 vcc, s60, v40
    s_cbranch_vccz il_attnB_kernel_ok_5
    v_mov_b32 v41, v40
    s_nop 1
    v_permlane32_swap_b32 v41, v40
    s_nop 1
    v_max_f32 v40, v40, v41
    v_max_f32 v40, 0, v40
    v_sub_f32 v41, 0, v40
    v_exp_f32 v41, v41
    s_nop 0
    v_mul_f32 v96, v96, v41
    v_sub_f32 v64, v64, v40
    v_sub_f32 v80, v80, v40
    v_mul_f32 v97, v97, v41
    v_sub_f32 v65, v65, v40
    v_sub_f32 v81, v81, v40
    v_mul_f32 v98, v98, v41
    v_sub_f32 v66, v66, v40
    v_sub_f32 v82, v82, v40
    v_mul_f32 v99, v99, v41
    v_sub_f32 v67, v67, v40
    v_sub_f32 v83, v83, v40
    v_mul_f32 v100, v100, v41
    v_sub_f32 v68, v68, v40
    v_sub_f32 v84, v84, v40
    v_mul_f32 v101, v101, v41
    v_sub_f32 v69, v69, v40
    v_sub_f32 v85, v85, v40
    v_mul_f32 v102, v102, v41
    v_sub_f32 v70, v70, v40
    v_sub_f32 v86, v86, v40
    v_mul_f32 v103, v103, v41
    v_sub_f32 v71, v71, v40
    v_sub_f32 v87, v87, v40
    v_mul_f32 v104, v104, v41
    v_sub_f32 v72, v72, v40
    v_sub_f32 v88, v88, v40
    v_mul_f32 v105, v105, v41
    v_sub_f32 v73, v73, v40
    v_sub_f32 v89, v89, v40
    v_mul_f32 v106, v106, v41
    v_sub_f32 v74, v74, v40
    v_sub_f32 v90, v90, v40
    v_mul_f32 v107, v107, v41
    v_sub_f32 v75, v75, v40
    v_sub_f32 v91, v91, v40
    v_mul_f32 v108, v108, v41
    v_sub_f32 v76, v76, v40
    v_sub_f32 v92, v92, v40
    v_mul_f32 v109, v109, v41
    v_sub_f32 v77, v77, v40
    v_sub_f32 v93, v93, v40
    v_mul_f32 v110, v110, v41
    v_sub_f32 v78, v78, v40
    v_sub_f32 v94, v94, v40
    v_mul_f32 v111, v111, v41
    v_sub_f32 v79, v79, v40
    v_sub_f32 v95, v95, v40
il_attnB_kernel_ok_5:
    v_exp_f32 v64, v64
    v_exp_f32 v65, v65
    v_exp_f32 v66, v66
    v_exp_f32 v67, v67
    v_exp_f32 v68, v68
    v_exp_f32 v69, v69
    v_exp_f32 v70, v70
    v_exp_f32 v71, v71
    v_exp_f32 v72, v72
    v_exp_f32 v73, v73
    v_exp_f32 v74, v74
    v_exp_f32 v75, v75
    v_exp_f32 v76, v76
    v_exp_f32 v77, v77
    v_exp_f32 v78, v78
    v_exp_f32 v79, v79
    s_nop 0
    v_cvt_pk_bf16_f32 v112, v64, v65
    v_cvt_pk_bf16_f32 v113, v66, v67
    v_cvt_pk_bf16_f32 v114, v68, v69
    v_cvt_pk_bf16_f32 v115, v70, v71
    v_cvt_pk_bf16_f32 v116, v72, v73
    v_cvt_pk_bf16_f32 v117, v74, v75
    v_cvt_pk_bf16_f32 v118, v76, v77
    v_cvt_pk_bf16_f32 v119, v78, v79
    s_nop 1
    v_mfma_f32_32x32x16_bf16 v[96:111], v[32:35], v[112:115], v[96:111]
    v_mfma_f32_32x32x16_bf16 v[96:111], v[36:39], v[116:119], v[96:111]
il_attnB_kernel_skip5:
    s_cmp_lt_u32 s36, 64
    s_cbranch_scc1 il_attnB_kernel_skip6
    ds_read_b128 v[24:27], v10 offset:12288
    ds_read_b128 v[28:31], v11 offset:12288
    ds_read_b64_tr_b16 v[32:33], v12 offset:45056
    ds_read_b64_tr_b16 v[34:35], v12 offset:45568
    ds_read_b64_tr_b16 v[36:37], v12 offset:46080
    ds_read_b64_tr_b16 v[38:39], v12 offset:46592
    s_waitcnt lgkmcnt(0)
    v_mfma_f32_32x32x16_bf16 v[64:79], v[24:27], v[16:19], v[80:95]
    v_mfma_f32_32x32x16_bf16 v[64:79], v[28:31], v[20:23], v[64:79]
    s_nop 15
    v_max3_f32 v40, v64, v65, v66
    v_max3_f32 v40, v40, v67, v68
    v_max3_f32 v40, v40, v69, v70
    v_max3_f32 v40, v40, v71, v72
    v_max3_f32 v40, v40, v73, v74
    v_max3_f32 v40, v40, v75, v76
    v_max3_f32 v40, v40, v77, v78
    v_max_f32 v40, v40, v79
    v_cmp_lt_f32 vcc, s60, v40
    s_cbranch_vccz il_attnB_kernel_ok_6
    v_mov_b32 v41, v40
    s_nop 1
    v_permlane32_swap_b32 v41, v40
    s_nop 1
    v_max_f32 v40, v40, v41
    v_max_f32 v40, 0, v40
    v_sub_f32 v41, 0, v40
    v_exp_f32 v41, v41
    s_nop 0
    v_mul_f32 v96, v96, v41
    v_sub_f32 v64, v64, v40
    v_sub_f32 v80, v80, v40
    v_mul_f32 v97, v97, v41
    v_sub_f32 v65, v65, v40
    v_sub_f32 v81, v81, v40
    v_mul_f32 v98, v98, v41
    v_sub_f32 v66, v66, v40
    v_sub_f32 v82, v82, v40
    v_mul_f32 v99, v99, v41
    v_sub_f32 v67, v67, v40
    v_sub_f32 v83, v83, v40
    v_mul_f32 v100, v100, v41
    v_sub_f32 v68, v68, v40
    v_sub_f32 v84, v84, v40
    v_mul_f32 v101, v101, v41
    v_sub_f32 v69, v69, v40
    v_sub_f32 v85, v85, v40
    v_mul_f32 v102, v102, v41
    v_sub_f32 v70, v70, v40
    v_sub_f32 v86, v86, v40
    v_mul_f32 v103, v103, v41
    v_sub_f32 v71, v71, v40
    v_sub_f32 v87, v87, v40
    v_mul_f32 v104, v104, v41
    v_sub_f32 v72, v72, v40
    v_sub_f32 v88, v88, v40
    v_mul_f32 v105, v105, v41
    v_sub_f32 v73, v73, v40
    v_sub_f32 v89, v89, v40
    v_mul_f32 v106, v106, v41
    v_sub_f32 v74, v74, v40
    v_sub_f32 v90, v90, v40
    v_mul_f32 v107, v107, v41
    v_sub_f32 v75, v75, v40
    v_sub_f32 v91, v91, v40
    v_mul_f32 v108, v108, v41
    v_sub_f32 v76, v76, v40
    v_sub_f32 v92, v92, v40
    v_mul_f32 v109, v109, v41
    v_sub_f32 v77, v77, v40
    v_sub_f32 v93, v93, v40
    v_mul_f32 v110, v110, v41
    v_sub_f32 v78, v78, v40
    v_sub_f32 v94, v94, v40
    v_mul_f32 v111, v111, v41
    v_sub_f32 v79, v79, v40
    v_sub_f32 v95, v95, v40
il_attnB_kernel_ok_6:
    v_exp_f32 v64, v64
    v_exp_f32 v65, v65
    v_exp_f32 v66, v66
    v_exp_f32 v67, v67
    v_exp_f32 v68, v68
    v_exp_f32 v69, v69
    v_exp_f32 v70, v70
    v_exp_f32 v71, v71
    v_exp_f32 v72, v72
    v_exp_f32 v73, v73
    v_exp_f32 v74, v74
    v_exp_f32 v75, v75
    v_exp_f32 v76, v76
    v_exp_f32 v77, v77
    v_exp_f32 v78, v78
    v_exp_f32 v79, v79
    s_nop 0
    v_cvt_pk_bf16_f32 v112, v64, v65
    v_cvt_pk_bf16_f32 v113, v66, v67
    v_cvt_pk_bf16_f32 v114, v68, v69
    v_cvt_pk_bf16_f32 v115, v70, v71
    v_cvt_pk_bf16_f32 v116, v72, v73
    v_cvt_pk_bf16_f32 v117, v74, v75
    v_cvt_pk_bf16_f32 v118, v76, v77
    v_cvt_pk_bf16_f32 v119, v78, v79
    s_nop 1
    v_mfma_f32_32x32x16_bf16 v[96:111], v[32:35], v[112:115], v[96:111]
    v_mfma_f32_32x32x16_bf16 v[96:111], v[36:39], v[116:119], v[96:111]
il_attnB_kernel_skip6:
    s_cmp_lt_u32 s36, 32
    s_cbranch_scc1 il_attnB_kernel_skip7
    ds_read_b128 v[24:27], v10 offset:14336
    ds_read_b128 v[28:31], v11 offset:14336
    ds_read_b64_tr_b16 v[32:33], v12 offset:47104
    ds_read_b64_tr_b16 v[34:35], v12 offset:47616
    ds_read_b64_tr_b16 v[36:37], v12 offset:48128
    ds_read_b64_tr_b16 v[38:39], v12 offset:48640
    s_waitcnt lgkmcnt(0)
    v_mfma_f32_32x32x16_bf16 v[64:79], v[24:27], v[16:19], v[80:95]
    v_mfma_f32_32x32x16_bf16 v[64:79], v[28:31], v[20:23], v[64:79]
    s_nop 15
    v_max3_f32 v40, v64, v65, v66
    v_max3_f32 v40, v40, v67, v68
    v_max3_f32 v40, v40, v69, v70
    v_max3_f32 v40, v40, v71, v72
    v_max3_f32 v40, v40, v73, v74
    v_max3_f32 v40, v40, v75, v76
    v_max3_f32 v40, v40, v77, v78
    v_max_f32 v40, v40, v79
    v_cmp_lt_f32 vcc, s60, v40
    s_cbranch_vccz il_attnB_kernel_ok_7
    v_mov_b32 v41, v40
    s_nop 1
    v_permlane32_swap_b32 v41, v40
    s_nop 1
    v_max_f32 v40, v40, v41
    v_max_f32 v40, 0, v40
    v_sub_f32 v41, 0, v40
    v_exp_f32 v41, v41
    s_nop 0
    v_mul_f32 v96, v96, v41
    v_sub_f32 v64, v64, v40
    v_sub_f32 v80, v80, v40
    v_mul_f32 v97, v97, v41
    v_sub_f32 v65, v65, v40
    v_sub_f32 v81, v81, v40
    v_mul_f32 v98, v98, v41
    v_sub_f32 v66, v66, v40
    v_sub_f32 v82, v82, v40
    v_mul_f32 v99, v99, v41
    v_sub_f32 v67, v67, v40
    v_sub_f32 v83, v83, v40
    v_mul_f32 v100, v100, v41
    v_sub_f32 v68, v68, v40
    v_sub_f32 v84, v84, v40
    v_mul_f32 v101, v101, v41
    v_sub_f32 v69, v69, v40
    v_sub_f32 v85, v85, v40
    v_mul_f32 v102, v102, v41
    v_sub_f32 v70, v70, v40
    v_sub_f32 v86, v86, v40
    v_mul_f32 v103, v103, v41
    v_sub_f32 v71, v71, v40
    v_sub_f32 v87, v87, v40
    v_mul_f32 v104, v104, v41
    v_sub_f32 v72, v72, v40
    v_sub_f32 v88, v88, v40
    v_mul_f32 v105, v105, v41
    v_sub_f32 v73, v73, v40
    v_sub_f32 v89, v89, v40
    v_mul_f32 v106, v106, v41
    v_sub_f32 v74, v74, v40
    v_sub_f32 v90, v90, v40
    v_mul_f32 v107, v107, v41
    v_sub_f32 v75, v75, v40
    v_sub_f32 v91, v91, v40
    v_mul_f32 v108, v108, v41
    v_sub_f32 v76, v76, v40
    v_sub_f32 v92, v92, v40
    v_mul_f32 v109, v109, v41
    v_sub_f32 v77, v77, v40
    v_sub_f32 v93, v93, v40
    v_mul_f32 v110, v110, v41
    v_sub_f32 v78, v78, v40
    v_sub_f32 v94, v94, v40
    v_mul_f32 v111, v111, v41
    v_sub_f32 v79, v79, v40
    v_sub_f32 v95, v95, v40
il_attnB_kernel_ok_7:
    v_exp_f32 v64, v64
    v_exp_f32 v65, v65
    v_exp_f32 v66, v66
    v_exp_f32 v67, v67
    v_exp_f32 v68, v68
    v_exp_f32 v69, v69
    v_exp_f32 v70, v70
    v_exp_f32 v71, v71
    v_exp_f32 v72, v72
    v_exp_f32 v73, v73
    v_exp_f32 v74, v74
    v_exp_f32 v75, v75
    v_exp_f32 v76, v76
    v_exp_f32 v77, v77
    v_exp_f32 v78, v78
    v_exp_f32 v79, v79
    s_nop 0
    v_cvt_pk_bf16_f32 v112, v64, v65
    v_cvt_pk_bf16_f32 v113, v66, v67
    v_cvt_pk_bf16_f32 v114, v68, v69
    v_cvt_pk_bf16_f32 v115, v70, v71
    v_cvt_pk_bf16_f32 v116, v72, v73
    v_cvt_pk_bf16_f32 v117, v74, v75
    v_cvt_pk_bf16_f32 v118, v76, v77
    v_cvt_pk_bf16_f32 v119, v78, v79
    s_nop 1
    v_mfma_f32_32x32x16_bf16 v[96:111], v[32:35], v[112:115], v[96:111]
    v_mfma_f32_32x32x16_bf16 v[96:111], v[36:39], v[116:119], v[96:111]
il_attnB_kernel_skip7:
    s_nop 15
    v_lshl_add_u32 v13, v3, 3, v13
    v_mov_b32 v40, v104
    v_mov_b32 v41, v104
    s_nop 1
    v_permlane32_swap_b32 v40, v41
    s_nop 1
    v_rcp_f32 v41, v41
    s_nop 0
    v_mul_f32 v96, v96, v41
    v_mul_f32 v97, v97, v41
    v_mul_f32 v98, v98, v41
    v_mul_f32 v99, v99, v41
    v_mul_f32 v100, v100, v41
    v_mul_f32 v101, v101, v41
    v_mul_f32 v102, v102, v41
    v_mul_f32 v103, v103, v41
    v_mul_f32 v104, v104, v41
    v_mul_f32 v105, v105, v41
    v_mul_f32 v106, v106, v41
    v_mul_f32 v107, v107, v41
    v_cvt_pk_bf16_f32 v42, v96, v97
    v_cvt_pk_bf16_f32 v43, v98, v99
    buffer_store_dwordx2 v[42:43], v13, s[20:23], 0 offen offset:0
    v_cvt_pk_bf16_f32 v42, v100, v101
    v_cvt_pk_bf16_f32 v43, v102, v103
    buffer_store_dwordx2 v[42:43], v13, s[20:23], 0 offen offset:16
    v_cvt_pk_bf16_f32 v42, v104, v105
    v_cvt_pk_bf16_f32 v43, v106, v107
    v_cmp_eq_u32 vcc, 0, v3
    s_and_saveexec_b64 s[50:51], vcc
    buffer_store_dwordx2 v[42:43], v13, s[20:23], 0 offen offset:32
    s_mov_b64 exec, s[50:51]
    s_waitcnt vmcnt(0)
il_attnB_kernel_done:
    s_endpgm
.globl il_opB0_kernel
.p2align 8
.type il_opB0_kernel,@function
il_opB0_kernel:
    s_cmp_ge_u32 s2, 160
    s_cbranch_scc1 il_opB0_kernel_done
    s_load_dwordx2 s[4:5], s[0:1], 80
    s_load_dwordx2 s[12:13], s[0:1], 56
    s_and_b32 s34, s2, 15
    s_lshr_b32 s35, s2, 4
    s_mov_b32 s37, s35
    s_mul_i32 s34, s34, 128
    s_mul_i32 s35, s35, 64
    v_and_b32 v1, 63, v0
    v_lshrrev_b32 v2, 6, v0
    v_lshrrev_b32 v3, 5, v1
    s_waitcnt lgkmcnt(0)
    s_add_u32 s8, s4, 10485760
    s_addc_u32 s9, s5, 0
    s_mov_b32 s10, 2621440
    s_mov_b32 s11, 0x00020000
    s_mov_b32 s14, 819200
    s_mov_b32 s15, 0x00020000
    s_add_u32 s20, s4, 2621440
    s_addc_u32 s21, s5, 0
    s_mov_b32 s22, 2621440
    s_mov_b32 s23, 0x00020000
    s_add_u32 s24, s4, 0
    s_addc_u32 s25, s5, 0
    s_mov_b32 s26, 2621440
    s_mov_b32 s27, 0x00020000
    s_mov_b32 s36, 0x3f803f80
    v_lshrrev_b32 v17, 3, v1
    v_mul_u32_u24 v18, 32, v2
    v_add_u32 v18, v18, v17
    v_and_b32 v19, 7, v1
    v_lshrrev_b32 v16, 1, v17
    v_xor_b32 v16, v16, v19
    v_lshlrev_b32 v16, 4, v16
    v_add_u32 v4, s34, v18
    v_add_u32 v4, 0, v4
    s_mov_b32 s3, 1280
    v_mul_lo_u32 v4, v4, s3
    v_add_u32 v4, v4, v16
    v_lshrrev_b32 v16, 1, v17
    v_xor_b32 v16, 4, v16
    v_xor_b32 v16, v16, v19
    v_lshlrev_b32 v16, 4, v16
    v_add_u32 v5, s34, v18
    v_add_u32 v5, 8, v5
    s_mov_b32 s3, 1280
    v_mul_lo_u32 v5, v5, s3
    v_add_u32 v5, v5, v16
    v_lshrrev_b32 v16, 1, v17
    v_xor_b32 v16, v16, v19
    v_lshlrev_b32 v16, 4, v16
    v_add_u32 v6, s34, v18
    v_add_u32 v6, 16, v6
    s_mov_b32 s3, 1280
    v_mul_lo_u32 v6, v6, s3
    v_add_u32 v6, v6, v16
    v_lshrrev_b32 v16, 1, v17
    v_xor_b32 v16, 4, v16
    v_xor_b32 v16, v16, v19
    v_lshlrev_b32 v16, 4, v16
    v_add_u32 v7, s34, v18
    v_add_u32 v7, 24, v7
    s_mov_b32 s3, 1280
    v_mul_lo_u32 v7, v7, s3
    v_add_u32 v7, v7, v16
    v_lshrrev_b32 v16, 2, v1
    v_lshl_add_u32 v16, v2, 4, v16
    v_and_b32 v17, 3, v1
    v_lshlrev_b32 v17, 4, v17
    s_mov_b32 s38, 1280
    s_mov_b32 s39, s35
    v_mul_lo_u32 v16, v16, s38
    v_add_u32 v16, v16, v17
    s_lshl_b32 s3, s39, 1
    v_add_u32 v8, s3, v16
    v_add_u32 v9, 64, v8
    v_and_b32 v16, 31, v1
    v_and_b32 v17, 1, v2
    v_mul_u32_u24 v17, 64, v17
    v_add_u32 v17, v17, v16
    v_lshrrev_b32 v16, 1, v16
    v_and_b32 v16, 7, v16
    v_lshlrev_b32 v17, 7, v17
    v_add_u32 v18, 0, v3
    v_xor_b32 v18, v18, v16
    v_lshl_add_u32 v12, v18, 4, v17
    v_add_u32 v18, 2, v3
    v_xor_b32 v18, v18, v16
    v_lshl_add_u32 v13, v18, 4, v17
    v_add_u32 v18, 4, v3
    v_xor_b32 v18, v18, v16
    v_lshl_add_u32 v14, v18, 4, v17
    v_add_u32 v18, 6, v3
    v_xor_b32 v18, v18, v16
    v_lshl_add_u32 v15, v18, 4, v17
    v_lshrrev_b32 v17, 4, v1
    v_and_b32 v17, 1, v17
    v_lshlrev_b32 v17, 5, v17
    v_and_b32 v18, 15, v1
    v_lshrrev_b32 v18, 2, v18
    v_lshl_add_u32 v18, v3, 3, v18
    v_lshl_add_u32 v17, v18, 6, v17
    v_and_b32 v18, 3, v1
    v_lshl_add_u32 v17, v18, 3, v17
    v_lshrrev_b32 v18, 1, v2
    v_mul_u32_u24 v18, 4096, v18
    v_add3_u32 v16, v17, v18, 0
    v_add_u32 v16, 16384, v16
    v_mov_b32 v64, 0
    v_mov_b32 v65, 0
    v_mov_b32 v66, 0
    v_mov_b32 v67, 0
    v_mov_b32 v68, 0
    v_mov_b32 v69, 0
    v_mov_b32 v70, 0
    v_mov_b32 v71, 0
    v_mov_b32 v72, 0
    v_mov_b32 v73, 0
    v_mov_b32 v74, 0
    v_mov_b32 v75, 0
    v_mov_b32 v76, 0
    v_mov_b32 v77, 0
    v_mov_b32 v78, 0
    v_mov_b32 v79, 0
    v_mov_b32 v80, 0
    v_mov_b32 v81, 0
    v_mov_b32 v82, 0
    v_mov_b32 v83, 0
    v_mov_b32 v84, 0
    v_mov_b32 v85, 0
    v_mov_b32 v86, 0
    v_mov_b32 v87, 0
    v_mov_b32 v88, 0
    v_mov_b32 v89, 0
    v_mov_b32 v90, 0
    v_mov_b32 v91, 0
    v_mov_b32 v92, 0
    v_mov_b32 v93, 0
    v_mov_b32 v94, 0
    v_mov_b32 v95, 0
    v_mov_b32 v20, 0
    v_mov_b32 v21, 0
    v_mov_b32 v22, 0
    v_mov_b32 v23, 0
    v_mov_b32 v24, 0
    v_mov_b32 v25, 0
    v_mov_b32 v26, 0
    v_mov_b32 v27, 0
    s_mov_b32 s32, 0
    s_mov_b32 s33, 0
    v_readfirstlane_b32 s3, v2
    s_mul_i32 s3, s3, 4096
    s_add_u32 s3, s3, 0
    s_mov_b32 m0, s3
    s_nop 0
    buffer_load_dwordx4 v4, s[8:11], s32 offen lds
    v_readfirstlane_b32 s3, v2
    s_mul_i32 s3, s3, 4096
    s_add_u32 s3, s3, 1024
    s_mov_b32 m0, s3
    s_nop 0
    buffer_load_dwordx4 v5, s[8:11], s32 offen lds
    v_readfirstlane_b32 s3, v2
    s_mul_i32 s3, s3, 4096
    s_add_u32 s3, s3, 2048
    s_mov_b32 m0, s3
    s_nop 0
    buffer_load_dwordx4 v6, s[8:11], s32 offen lds
    v_readfirstlane_b32 s3, v2
    s_mul_i32 s3, s3, 4096
    s_add_u32 s3, s3, 3072
    s_mov_b32 m0, s3
    s_nop 0
    buffer_load_dwordx4 v7, s[8:11], s32 offen lds
    v_readfirstlane_b32 s3, v2
    s_lshl_b32 s3, s3, 10
    s_add_u32 s3, s3, 16384
    s_mov_b32 m0, s3
    s_nop 0
    buffer_load_dwordx4 v8, s[12:15], s33 offen lds
    v_readfirstlane_b32 s3, v2
    s_lshl_b32 s3, s3, 10
    s_add_u32 s3, s3, 20480
    s_mov_b32 m0, s3
    s_nop 0
    buffer_load_dwordx4 v9, s[12:15], s33 offen lds
    s_add_u32 s32, s32, 128
    s_mul_i32 s3, s38, 64
    s_add_u32 s33, s33, s3
    s_mov_b32 s48, 0
il_opB0_kernel_loop:
    s_waitcnt vmcnt(0)
    s_barrier
    s_add_u32 s3, s48, 0
    s_cmp_ge_u32 s3, 9
    s_cbranch_scc1 il_opB0_kernel_nopf0
    v_readfirstlane_b32 s3, v2
    s_mul_i32 s3, s3, 4096
    s_add_u32 s3, s3, 24576
    s_mov_b32 m0, s3
    s_nop 0
    buffer_load_dwordx4 v4, s[8:11], s32 offen lds
    v_readfirstlane_b32 s3, v2
    s_mul_i32 s3, s3, 4096
    s_add_u32 s3, s3, 25600
    s_mov_b32 m0, s3
    s_nop 0
    buffer_load_dwordx4 v5, s[8:11], s32 offen lds
    v_readfirstlane_b32 s3, v2
    s_mul_i32 s3, s3, 4096
    s_add_u32 s3, s3, 26624
    s_mov_b32 m0, s3
    s_nop 0
    buffer_load_dwordx4 v6, s[8:11], s32 offen lds
    v_readfirstlane_b32 s3, v2
    s_mul_i32 s3, s3, 4096
    s_add_u32 s3, s3, 27648
    s_mov_b32 m0, s3
    s_nop 0
    buffer_load_dwordx4 v7, s[8:11], s32 offen lds
    v_readfirstlane_b32 s3, v2
    s_lshl_b32 s3, s3, 10
    s_add_u32 s3, s3, 40960
    s_mov_b32 m0, s3
    s_nop 0
    buffer_load_dwordx4 v8, s[12:15], s33 offen lds
    v_readfirstlane_b32 s3, v2
    s_lshl_b32 s3, s3, 10
    s_add_u32 s3, s3, 45056
    s_mov_b32 m0, s3
    s_nop 0
    buffer_load_dwordx4 v9, s[12:15], s33 offen lds
    s_add_u32 s32, s32, 128
    s_mul_i32 s3, s38, 64
    s_add_u32 s33, s33, s3
il_opB0_kernel_nopf0:
    ds_read_b128 v[32:35], v12 offset:0
    ds_read_b128 v[36:39], v12 offset:4096
    ds_read_b64_tr_b16 v[40:41], v16 offset:0
    ds_read_b64_tr_b16 v[42:43], v16 offset:256
    s_waitcnt lgkmcnt(0)
    ds_read_b128 v[44:47], v13 offset:0
    ds_read_b128 v[48:51], v13 offset:4096
    ds_read_b64_tr_b16 v[52:53], v16 offset:1024
    ds_read_b64_tr_b16 v[54:55], v16 offset:1280
    v_mfma_f32_32x32x16_bf16 v[64:79], v[40:43], v[32:35], v[64:79]
    v_mfma_f32_32x32x16_bf16 v[80:95], v[40:43], v[36:39], v[80:95]
    s_waitcnt lgkmcnt(0)
    ds_read_b128 v[32:35], v14 offset:0
    ds_read_b128 v[36:39], v14 offset:4096
    ds_read_b64_tr_b16 v[40:41], v16 offset:2048
    ds_read_b64_tr_b16 v[42:43], v16 offset:2304
    v_mfma_f32_32x32x16_bf16 v[64:79], v[52:55], v[44:47], v[64:79]
    v_mfma_f32_32x32x16_bf16 v[80:95], v[52:55], v[48:51], v[80:95]
    s_waitcnt lgkmcnt(0)
    ds_read_b128 v[44:47], v15 offset:0
    ds_read_b128 v[48:51], v15 offset:4096
    ds_read_b64_tr_b16 v[52:53], v16 offset:3072
    ds_read_b64_tr_b16 v[54:55], v16 offset:3328
    v_mfma_f32_32x32x16_bf16 v[64:79], v[40:43], v[32:35], v[64:79]
    v_mfma_f32_32x32x16_bf16 v[80:95], v[40:43], v[36:39], v[80:95]
    s_waitcnt lgkmcnt(0)
    v_mfma_f32_32x32x16_bf16 v[64:79], v[52:55], v[44:47], v[64:79]
    v_mfma_f32_32x32x16_bf16 v[80:95], v[52:55], v[48:51], v[80:95]
    s_waitcnt vmcnt(0)
    s_barrier
    s_add_u32 s3, s48, 1
    s_cmp_ge_u32 s3, 9
    s_cbranch_scc1 il_opB0_kernel_nopf1
    v_readfirstlane_b32 s3, v2
    s_mul_i32 s3, s3, 4096
    s_add_u32 s3, s3, 0
    s_mov_b32 m0, s3
    s_nop 0
    buffer_load_dwordx4 v4, s[8:11], s32 offen lds
    v_readfirstlane_b32 s3, v2
    s_mul_i32 s3, s3, 4096
    s_add_u32 s3, s3, 1024
    s_mov_b32 m0, s3
    s_nop 0
    buffer_load_dwordx4 v5, s[8:11], s32 offen lds
    v_readfirstlane_b32 s3, v2
    s_mul_i32 s3, s3, 4096
    s_add_u32 s3, s3, 2048
    s_mov_b32 m0, s3
    s_nop 0
    buffer_load_dwordx4 v6, s[8:11], s32 offen lds
    v_readfirstlane_b32 s3, v2
    s_mul_i32 s3, s3, 4096
    s_add_u32 s3, s3, 3072
    s_mov_b32 m0, s3
    s_nop 0
    buffer_load_dwordx4 v7, s[8:11], s32 offen lds
    v_readfirstlane_b32 s3, v2
    s_lshl_b32 s3, s3, 10
    s_add_u32 s3, s3, 16384
    s_mov_b32 m0, s3
    s_nop 0
    buffer_load_dwordx4 v8, s[12:15], s33 offen lds
    v_readfirstlane_b32 s3, v2
    s_lshl_b32 s3, s3, 10
    s_add_u32 s3, s3, 20480
    s_mov_b32 m0, s3
    s_nop 0
    buffer_load_dwordx4 v9, s[12:15], s33 offen lds
    s_add_u32 s32, s32, 128
    s_mul_i32 s3, s38, 64
    s_add_u32 s33, s33, s3
il_opB0_kernel_nopf1:
    ds_read_b128 v[32:35], v12 offset:24576
    ds_read_b128 v[36:39], v12 offset:28672
    ds_read_b64_tr_b16 v[40:41], v16 offset:24576
    ds_read_b64_tr_b16 v[42:43], v16 offset:24832
    s_waitcnt lgkmcnt(0)
    ds_read_b128 v[44:47], v13 offset:24576
    ds_read_b128 v[48:51], v13 offset:28672
    ds_read_b64_tr_b16 v[52:53], v16 offset:25600
    ds_read_b64_tr_b16 v[54:55], v16 offset:25856
    v_mfma_f32_32x32x16_bf16 v[64:79], v[40:43], v[32:35], v[64:79]
    v_mfma_f32_32x32x16_bf16 v[80:95], v[40:43], v[36:39], v[80:95]
    s_waitcnt lgkmcnt(0)
    ds_read_b128 v[32:35], v14 offset:24576
    ds_read_b128 v[36:39], v14 offset:28672
    ds_read_b64_tr_b16 v[40:41], v16 offset:26624
    ds_read_b64_tr_b16 v[42:43], v16 offset:26880
    v_mfma_f32_32x32x16_bf16 v[64:79], v[52:55], v[44:47], v[64:79]
    v_mfma_f32_32x32x16_bf16 v[80:95], v[52:55], v[48:51], v[80:95]
    s_waitcnt lgkmcnt(0)
    ds_read_b128 v[44:47], v15 offset:24576
    ds_read_b128 v[48:51], v15 offset:28672
    ds_read_b64_tr_b16 v[52:53], v16 offset:27648
    ds_read_b64_tr_b16 v[54:55], v16 offset:27904
    v_mfma_f32_32x32x16_bf16 v[64:79], v[40:43], v[32:35], v[64:79]
    v_mfma_f32_32x32x16_bf16 v[80:95], v[40:43], v[36:39], v[80:95]
    s_waitcnt lgkmcnt(0)
    v_mfma_f32_32x32x16_bf16 v[64:79], v[52:55], v[44:47], v[64:79]
    v_mfma_f32_32x32x16_bf16 v[80:95], v[52:55], v[48:51], v[80:95]
    s_add_u32 s48, s48, 2
    s_cmp_lt_u32 s48, 10
    s_cbranch_scc1 il_opB0_kernel_loop
    s_nop 15
    s_nop 7
    v_and_b32 v4, 31, v1
    v_and_b32 v5, 1, v2
    v_mul_u32_u24 v5, 64, v5
    v_add3_u32 v4, v4, v5, s34
    v_lshrrev_b32 v5, 1, v2
    v_mul_u32_u24 v5, 32, v5
    v_lshl_add_u32 v5, v3, 2, v5
    v_add_u32 v5, s35, v5
    v_add_u32 v8, 0, v4
    v_add_u32 v9, 0, v5
    v_mul_u32_u24 v10, 1280, v8
    v_lshl_add_u32 v10, v9, 1, v10
    buffer_load_dwordx2 v[12:13], v10, s[24:27], 0 offen
    v_cvt_pk_bf16_f32 v14, v64, v65
    v_cvt_pk_bf16_f32 v15, v66, v67
    s_waitcnt vmcnt(0)
    v_lshlrev_b32 v16, 16, v14
    v_and_b32 v17, 0xffff0000, v14
    v_lshlrev_b32 v18, 16, v12
    v_and_b32 v19, 0xffff0000, v12
    v_add_f32 v16, v16, v18
    v_add_f32 v17, v17, v19
    v_cvt_pk_bf16_f32 v14, v16, v17
    v_lshlrev_b32 v16, 16, v15
    v_and_b32 v17, 0xffff0000, v15
    v_lshlrev_b32 v18, 16, v13
    v_and_b32 v19, 0xffff0000, v13
    v_add_f32 v16, v16, v18
    v_add_f32 v17, v17, v19
    v_cvt_pk_bf16_f32 v15, v16, v17
    buffer_store_dwordx2 v[14:15], v10, s[20:23], 0 offen
    v_add_u32 v9, 8, v5
    v_mul_u32_u24 v10, 1280, v8
    v_lshl_add_u32 v10, v9, 1, v10
    buffer_load_dwordx2 v[12:13], v10, s[24:27], 0 offen
    v_cvt_pk_bf16_f32 v14, v68, v69
    v_cvt_pk_bf16_f32 v15, v70, v71
    s_waitcnt vmcnt(0)
    v_lshlrev_b32 v16, 16, v14
    v_and_b32 v17, 0xffff0000, v14
    v_lshlrev_b32 v18, 16, v12
    v_and_b32 v19, 0xffff0000, v12
    v_add_f32 v16, v16, v18
    v_add_f32 v17, v17, v19
    v_cvt_pk_bf16_f32 v14, v16, v17
    v_lshlrev_b32 v16, 16, v15
    v_and_b32 v17, 0xffff0000, v15
    v_lshlrev_b32 v18, 16, v13
    v_and_b32 v19, 0xffff0000, v13
    v_add_f32 v16, v16, v18
    v_add_f32 v17, v17, v19
    v_cvt_pk_bf16_f32 v15, v16, v17
    buffer_store_dwordx2 v[14:15], v10, s[20:23], 0 offen
    v_add_u32 v9, 16, v5
    v_mul_u32_u24 v10, 1280, v8
    v_lshl_add_u32 v10, v9, 1, v10
    buffer_load_dwordx2 v[12:13], v10, s[24:27], 0 offen
    v_cvt_pk_bf16_f32 v14, v72, v73
    v_cvt_pk_bf16_f32 v15, v74, v75
    s_waitcnt vmcnt(0)
    v_lshlrev_b32 v16, 16, v14
    v_and_b32 v17, 0xffff0000, v14
    v_lshlrev_b32 v18, 16, v12
    v_and_b32 v19, 0xffff0000, v12
    v_add_f32 v16, v16, v18
    v_add_f32 v17, v17, v19
    v_cvt_pk_bf16_f32 v14, v16, v17
    v_lshlrev_b32 v16, 16, v15
    v_and_b32 v17, 0xffff0000, v15
    v_lshlrev_b32 v18, 16, v13
    v_and_b32 v19, 0xffff0000, v13
    v_add_f32 v16, v16, v18
    v_add_f32 v17, v17, v19
    v_cvt_pk_bf16_f32 v15, v16, v17
    buffer_store_dwordx2 v[14:15], v10, s[20:23], 0 offen
    v_add_u32 v9, 24, v5
    v_mul_u32_u24 v10, 1280, v8
    v_lshl_add_u32 v10, v9, 1, v10
    buffer_load_dwordx2 v[12:13], v10, s[24:27], 0 offen
    v_cvt_pk_bf16_f32 v14, v76, v77
    v_cvt_pk_bf16_f32 v15, v78, v79
    s_waitcnt vmcnt(0)
    v_lshlrev_b32 v16, 16, v14
    v_and_b32 v17, 0xffff0000, v14
    v_lshlrev_b32 v18, 16, v12
    v_and_b32 v19, 0xffff0000, v12
    v_add_f32 v16, v16, v18
    v_add_f32 v17, v17, v19
    v_cvt_pk_bf16_f32 v14, v16, v17
    v_lshlrev_b32 v16, 16, v15
    v_and_b32 v17, 0xffff0000, v15
    v_lshlrev_b32 v18, 16, v13
    v_and_b32 v19, 0xffff0000, v13
    v_add_f32 v16, v16, v18
    v_add_f32 v17, v17, v19
    v_cvt_pk_bf16_f32 v15, v16, v17
    buffer_store_dwordx2 v[14:15], v10, s[20:23], 0 offen
    v_add_u32 v8, 32, v4
    v_add_u32 v9, 0, v5
    v_mul_u32_u24 v10, 1280, v8
    v_lshl_add_u32 v10, v9, 1, v10
    buffer_load_dwordx2 v[12:13], v10, s[24:27], 0 offen
    v_cvt_pk_bf16_f32 v14, v80, v81
    v_cvt_pk_bf16_f32 v15, v82, v83
    s_waitcnt vmcnt(0)
    v_lshlrev_b32 v16, 16, v14
    v_and_b32 v17, 0xffff0000, v14
    v_lshlrev_b32 v18, 16, v12
    v_and_b32 v19, 0xffff0000, v12
    v_add_f32 v16, v16, v18
    v_add_f32 v17, v17, v19
    v_cvt_pk_bf16_f32 v14, v16, v17
    v_lshlrev_b32 v16, 16, v15
    v_and_b32 v17, 0xffff0000, v15
    v_lshlrev_b32 v18, 16, v13
    v_and_b32 v19, 0xffff0000, v13
    v_add_f32 v16, v16, v18
    v_add_f32 v17, v17, v19
    v_cvt_pk_bf16_f32 v15, v16, v17
    buffer_store_dwordx2 v[14:15], v10, s[20:23], 0 offen
    v_add_u32 v9, 8, v5
    v_mul_u32_u24 v10, 1280, v8
    v_lshl_add_u32 v10, v9, 1, v10
    buffer_load_dwordx2 v[12:13], v10, s[24:27], 0 offen
    v_cvt_pk_bf16_f32 v14, v84, v85
    v_cvt_pk_bf16_f32 v15, v86, v87
    s_waitcnt vmcnt(0)
    v_lshlrev_b32 v16, 16, v14
    v_and_b32 v17, 0xffff0000, v14
    v_lshlrev_b32 v18, 16, v12
    v_and_b32 v19, 0xffff0000, v12
    v_add_f32 v16, v16, v18
    v_add_f32 v17, v17, v19
    v_cvt_pk_bf16_f32 v14, v16, v17
    v_lshlrev_b32 v16, 16, v15
    v_and_b32 v17, 0xffff0000, v15
    v_lshlrev_b32 v18, 16, v13
    v_and_b32 v19, 0xffff0000, v13
    v_add_f32 v16, v16, v18
    v_add_f32 v17, v17, v19
    v_cvt_pk_bf16_f32 v15, v16, v17
    buffer_store_dwordx2 v[14:15], v10, s[20:23], 0 offen
    v_add_u32 v9, 16, v5
    v_mul_u32_u24 v10, 1280, v8
    v_lshl_add_u32 v10, v9, 1, v10
    buffer_load_dwordx2 v[12:13], v10, s[24:27], 0 offen
    v_cvt_pk_bf16_f32 v14, v88, v89
    v_cvt_pk_bf16_f32 v15, v90, v91
    s_waitcnt vmcnt(0)
    v_lshlrev_b32 v16, 16, v14
    v_and_b32 v17, 0xffff0000, v14
    v_lshlrev_b32 v18, 16, v12
    v_and_b32 v19, 0xffff0000, v12
    v_add_f32 v16, v16, v18
    v_add_f32 v17, v17, v19
    v_cvt_pk_bf16_f32 v14, v16, v17
    v_lshlrev_b32 v16, 16, v15
    v_and_b32 v17, 0xffff0000, v15
    v_lshlrev_b32 v18, 16, v13
    v_and_b32 v19, 0xffff0000, v13
    v_add_f32 v16, v16, v18
    v_add_f32 v17, v17, v19
    v_cvt_pk_bf16_f32 v15, v16, v17
    buffer_store_dwordx2 v[14:15], v10, s[20:23], 0 offen
    v_add_u32 v9, 24, v5
    v_mul_u32_u24 v10, 1280, v8
    v_lshl_add_u32 v10, v9, 1, v10
    buffer_load_dwordx2 v[12:13], v10, s[24:27], 0 offen
    v_cvt_pk_bf16_f32 v14, v92, v93
    v_cvt_pk_bf16_f32 v15, v94, v95
    s_waitcnt vmcnt(0)
    v_lshlrev_b32 v16, 16, v14
    v_and_b32 v17, 0xffff0000, v14
    v_lshlrev_b32 v18, 16, v12
    v_and_b32 v19, 0xffff0000, v12
    v_add_f32 v16, v16, v18
    v_add_f32 v17, v17, v19
    v_cvt_pk_bf16_f32 v14, v16, v17
    v_lshlrev_b32 v16, 16, v15
    v_and_b32 v17, 0xffff0000, v15
    v_lshlrev_b32 v18, 16, v13
    v_and_b32 v19, 0xffff0000, v13
    v_add_f32 v16, v16, v18
    v_add_f32 v17, v17, v19
    v_cvt_pk_bf16_f32 v15, v16, v17
    buffer_store_dwordx2 v[14:15], v10, s[20:23], 0 offen
    s_waitcnt vmcnt(0)
il_opB0_kernel_done:
    s_endpgm
.globl il_qkvA1_kernel
.p2align 8
.type il_qkvA1_kernel,@function
il_qkvA1_kernel:
    s_cmp_ge_u32 s2, 176
    s_cbranch_scc1 il_qkvA1_kernel_done
    s_load_dwordx2 s[4:5], s[0:1], 80
    s_load_dwordx2 s[12:13], s[0:1], 8
    s_load_dwordx2 s[40:41], s[0:1], 16
    s_load_dwordx2 s[16:17], s[0:1], 24
    s_and_b32 s34, s2, 15
    s_lshr_b32 s35, s2, 4
    s_mov_b32 s37, s35
    s_mul_i32 s34, s34, 128
    s_mul_i32 s35, s35, 64
    v_and_b32 v1, 63, v0
    v_lshrrev_b32 v2, 6, v0
    v_lshrrev_b32 v3, 5, v1
    s_waitcnt lgkmcnt(0)
    s_add_u32 s8, s4, 2621440
    s_addc_u32 s9, s5, 0
    s_mov_b32 s10, 2621440
    s_mov_b32 s11, 0x00020000
    s_mov_b32 s14, 819200
    s_mov_b32 s15, 0x00020000
    s_mov_b32 s18, 25600
    s_mov_b32 s19, 0x00020000
    s_cmp_lg_u32 s37, 10
    s_cbranch_scc1 il_qkvA1_kernel_notkv
    s_mov_b32 s12, s40
    s_mov_b32 s13, s41
    s_mov_b32 s14, 25600
il_qkvA1_kernel_notkv:
    s_add_u32 s20, s4, 7864320
    s_addc_u32 s21, s5, 0
    s_mov_b32 s22, 2621440
    s_mov_b32 s23, 0x00020000
    s_add_u32 s24, s4, 13107200
    s_addc_u32 s25, s5, 0
    s_mov_b32 s26, 4194304
    s_mov_b32 s27, 0x00020000
    s_add_u32 s28, s4, 17301504
    s_addc_u32 s29, s5, 0
    s_mov_b32 s30, 4194304
    s_mov_b32 s31, 0x00020000
    s_mov_b32 s36, 0x3f803f80
    v_lshrrev_b32 v17, 3, v1
    v_mul_u32_u24 v18, 32, v2
    v_add_u32 v18, v18, v17
    v_and_b32 v19, 7, v1
    v_lshrrev_b32 v16, 1, v17
    v_xor_b32 v16, v16, v19
    v_lshlrev_b32 v16, 4, v16
    v_add_u32 v4, s34, v18
    v_add_u32 v4, 0, v4
    s_mov_b32 s3, 1280
    v_mul_lo_u32 v4, v4, s3
    v_add_u32 v4, v4, v16
    v_lshrrev_b32 v16, 1, v17
    v_xor_b32 v16, 4, v16
    v_xor_b32 v16, v16, v19
    v_lshlrev_b32 v16, 4, v16
    v_add_u32 v5, s34, v18
    v_add_u32 v5, 8, v5
    s_mov_b32 s3, 1280
    v_mul_lo_u32 v5, v5, s3
    v_add_u32 v5, v5, v16
    v_lshrrev_b32 v16, 1, v17
    v_xor_b32 v16, v16, v19
    v_lshlrev_b32 v16, 4, v16
    v_add_u32 v6, s34, v18
    v_add_u32 v6, 16, v6
    s_mov_b32 s3, 1280
    v_mul_lo_u32 v6, v6, s3
    v_add_u32 v6, v6, v16
    v_lshrrev_b32 v16, 1, v17
    v_xor_b32 v16, 4, v16
    v_xor_b32 v16, v16, v19
    v_lshlrev_b32 v16, 4, v16
    v_add_u32 v7, s34, v18
    v_add_u32 v7, 24, v7
    s_mov_b32 s3, 1280
    v_mul_lo_u32 v7, v7, s3
    v_add_u32 v7, v7, v16
    v_lshrrev_b32 v16, 2, v1
    v_lshl_add_u32 v16, v2, 4, v16
    v_and_b32 v17, 3, v1
    v_lshlrev_b32 v17, 4, v17
    s_mov_b32 s38, 1280
    s_cmp_lg_u32 s37, 10
    s_cselect_b32 s38, s38, 40
    s_cselect_b32 s39, s35, 0
    v_mul_lo_u32 v16, v16, s38
    v_add_u32 v16, v16, v17
    s_lshl_b32 s3, s39, 1
    v_add_u32 v8, s3, v16
    s_cmp_lg_u32 s37, 10
    s_cselect_b32 s3, 64, 0
    v_add_u32 v9, s3, v8
    v_and_b32 v16, 31, v1
    v_and_b32 v17, 1, v2
    v_mul_u32_u24 v17, 64, v17
    v_add_u32 v17, v17, v16
    v_lshrrev_b32 v16, 1, v16
    v_and_b32 v16, 7, v16
    v_lshlrev_b32 v17, 7, v17
    v_add_u32 v18, 0, v3
    v_xor_b32 v18, v18, v16
    v_lshl_add_u32 v12, v18, 4, v17
    v_add_u32 v18, 2, v3
    v_xor_b32 v18, v18, v16
    v_lshl_add_u32 v13, v18, 4, v17
    v_add_u32 v18, 4, v3
    v_xor_b32 v18, v18, v16
    v_lshl_add_u32 v14, v18, 4, v17
    v_add_u32 v18, 6, v3
    v_xor_b32 v18, v18, v16
    v_lshl_add_u32 v15, v18, 4, v17
    v_lshrrev_b32 v17, 4, v1
    v_and_b32 v17, 1, v17
    v_lshlrev_b32 v17, 5, v17
    v_and_b32 v18, 15, v1
    v_lshrrev_b32 v18, 2, v18
    v_lshl_add_u32 v18, v3, 3, v18
    v_lshl_add_u32 v17, v18, 6, v17
    v_and_b32 v18, 3, v1
    v_lshl_add_u32 v17, v18, 3, v17
    v_lshrrev_b32 v18, 1, v2
    v_mul_u32_u24 v18, 4096, v18
    v_add3_u32 v16, v17, v18, 0
    v_add_u32 v16, 16384, v16
    v_mov_b32 v64, 0
    v_mov_b32 v65, 0
    v_mov_b32 v66, 0
    v_mov_b32 v67, 0
    v_mov_b32 v68, 0
    v_mov_b32 v69, 0
    v_mov_b32 v70, 0
    v_mov_b32 v71, 0
    v_mov_b32 v72, 0
    v_mov_b32 v73, 0
    v_mov_b32 v74, 0
    v_mov_b32 v75, 0
    v_mov_b32 v76, 0
    v_mov_b32 v77, 0
    v_mov_b32 v78, 0
    v_mov_b32 v79, 0
    v_mov_b32 v80, 0
    v_mov_b32 v81, 0
    v_mov_b32 v82, 0
    v_mov_b32 v83, 0
    v_mov_b32 v84, 0
    v_mov_b32 v85, 0
    v_mov_b32 v86, 0
    v_mov_b32 v87, 0
    v_mov_b32 v88, 0
    v_mov_b32 v89, 0
    v_mov_b32 v90, 0
    v_mov_b32 v91, 0
    v_mov_b32 v92, 0
    v_mov_b32 v93, 0
    v_mov_b32 v94, 0
    v_mov_b32 v95, 0
    v_mov_b32 v20, 0
    v_mov_b32 v21, 0
    v_mov_b32 v22, 0
    v_mov_b32 v23, 0
    v_mov_b32 v24, 0
    v_mov_b32 v25, 0
    v_mov_b32 v26, 0
    v_mov_b32 v27, 0
    s_mov_b32 s32, 0
    s_mov_b32 s33, 0
    s_cmp_lg_u32 s37, 10
    s_cselect_b32 s44, s12, s16
    s_cselect_b32 s45, s13, s17
    s_cselect_b32 s46, s14, s18
    s_mov_b32 s47, 0x00020000
    v_readfirstlane_b32 s3, v2
    s_mul_i32 s3, s3, 4096
    s_add_u32 s3, s3, 0
    s_mov_b32 m0, s3
    s_nop 0
    buffer_load_dwordx4 v4, s[8:11], s32 offen lds
    v_readfirstlane_b32 s3, v2
    s_mul_i32 s3, s3, 4096
    s_add_u32 s3, s3, 1024
    s_mov_b32 m0, s3
    s_nop 0
    buffer_load_dwordx4 v5, s[8:11], s32 offen lds
    v_readfirstlane_b32 s3, v2
    s_mul_i32 s3, s3, 4096
    s_add_u32 s3, s3, 2048
    s_mov_b32 m0, s3
    s_nop 0
    buffer_load_dwordx4 v6, s[8:11], s32 offen lds
    v_readfirstlane_b32 s3, v2
    s_mul_i32 s3, s3, 4096
    s_add_u32 s3, s3, 3072
    s_mov_b32 m0, s3
    s_nop 0
    buffer_load_dwordx4 v7, s[8:11], s32 offen lds
    v_readfirstlane_b32 s3, v2
    s_lshl_b32 s3, s3, 10
    s_add_u32 s3, s3, 16384
    s_mov_b32 m0, s3
    s_nop 0
    buffer_load_dwordx4 v8, s[12:15], s33 offen lds
    v_readfirstlane_b32 s3, v2
    s_lshl_b32 s3, s3, 10
    s_add_u32 s3, s3, 20480
    s_mov_b32 m0, s3
    s_nop 0
    buffer_load_dwordx4 v9, s[44:47], s33 offen lds
    s_add_u32 s32, s32, 128
    s_mul_i32 s3, s38, 64
    s_add_u32 s33, s33, s3
    s_mov_b32 s48, 0
il_qkvA1_kernel_loop:
    s_waitcnt vmcnt(0)
    s_barrier
    s_add_u32 s3, s48, 0
    s_cmp_ge_u32 s3, 9
    s_cbranch_scc1 il_qkvA1_kernel_nopf0
    v_readfirstlane_b32 s3, v2
    s_mul_i32 s3, s3, 4096
    s_add_u32 s3, s3, 24576
    s_mov_b32 m0, s3
    s_nop 0
    buffer_load_dwordx4 v4, s[8:11], s32 offen lds
    v_readfirstlane_b32 s3, v2
    s_mul_i32 s3, s3, 4096
    s_add_u32 s3, s3, 25600
    s_mov_b32 m0, s3
    s_nop 0
    buffer_load_dwordx4 v5, s[8:11], s32 offen lds
    v_readfirstlane_b32 s3, v2
    s_mul_i32 s3, s3, 4096
    s_add_u32 s3, s3, 26624
    s_mov_b32 m0, s3
    s_nop 0
    buffer_load_dwordx4 v6, s[8:11], s32 offen lds
    v_readfirstlane_b32 s3, v2
    s_mul_i32 s3, s3, 4096
    s_add_u32 s3, s3, 27648
    s_mov_b32 m0, s3
    s_nop 0
    buffer_load_dwordx4 v7, s[8:11], s32 offen lds
    v_readfirstlane_b32 s3, v2
    s_lshl_b32 s3, s3, 10
    s_add_u32 s3, s3, 40960
    s_mov_b32 m0, s3
    s_nop 0
    buffer_load_dwordx4 v8, s[12:15], s33 offen lds
    v_readfirstlane_b32 s3, v2
    s_lshl_b32 s3, s3, 10
    s_add_u32 s3, s3, 45056
    s_mov_b32 m0, s3
    s_nop 0
    buffer_load_dwordx4 v9, s[44:47], s33 offen lds
    s_add_u32 s32, s32, 128
    s_mul_i32 s3, s38, 64
    s_add_u32 s33, s33, s3
il_qkvA1_kernel_nopf0:
    ds_read_b128 v[32:35], v12 offset:0
    ds_read_b128 v[36:39], v12 offset:4096
    ds_read_b64_tr_b16 v[40:41], v16 offset:0
    ds_read_b64_tr_b16 v[42:43], v16 offset:256
    s_waitcnt lgkmcnt(0)
    ds_read_b128 v[44:47], v13 offset:0
    ds_read_b128 v[48:51], v13 offset:4096
    ds_read_b64_tr_b16 v[52:53], v16 offset:1024
    ds_read_b64_tr_b16 v[54:55], v16 offset:1280
    v_mfma_f32_32x32x16_bf16 v[64:79], v[40:43], v[32:35], v[64:79]
    v_mfma_f32_32x32x16_bf16 v[80:95], v[40:43], v[36:39], v[80:95]
    v_dot2_f32_bf16 v22, v32, v32, v22
    v_dot2_f32_bf16 v20, v32, s36, v20
    v_dot2_f32_bf16 v22, v33, v33, v22
    v_dot2_f32_bf16 v20, v33, s36, v20
    v_dot2_f32_bf16 v22, v34, v34, v22
    v_dot2_f32_bf16 v20, v34, s36, v20
    v_dot2_f32_bf16 v22, v35, v35, v22
    v_dot2_f32_bf16 v20, v35, s36, v20
    v_dot2_f32_bf16 v23, v36, v36, v23
    v_dot2_f32_bf16 v21, v36, s36, v21
    v_dot2_f32_bf16 v23, v37, v37, v23
    v_dot2_f32_bf16 v21, v37, s36, v21
    v_dot2_f32_bf16 v23, v38, v38, v23
    v_dot2_f32_bf16 v21, v38, s36, v21
    v_dot2_f32_bf16 v23, v39, v39, v23
    v_dot2_f32_bf16 v21, v39, s36, v21
    v_dot2_f32_bf16 v24, v40, s36, v24
    v_dot2_f32_bf16 v24, v41, s36, v24
    v_dot2_f32_bf16 v24, v42, s36, v24
    v_dot2_f32_bf16 v24, v43, s36, v24
    s_waitcnt lgkmcnt(0)
    ds_read_b128 v[32:35], v14 offset:0
    ds_read_b128 v[36:39], v14 offset:4096
    ds_read_b64_tr_b16 v[40:41], v16 offset:2048
    ds_read_b64_tr_b16 v[42:43], v16 offset:2304
    v_mfma_f32_32x32x16_bf16 v[64:79], v[52:55], v[44:47], v[64:79]
    v_mfma_f32_32x32x16_bf16 v[80:95], v[52:55], v[48:51], v[80:95]
    v_dot2_f32_bf16 v22, v44, v44, v22
    v_dot2_f32_bf16 v20, v44, s36, v20
    v_dot2_f32_bf16 v22, v45, v45, v22
    v_dot2_f32_bf16 v20, v45, s36, v20
    v_dot2_f32_bf16 v22, v46, v46, v22
    v_dot2_f32_bf16 v20, v46, s36, v20
    v_dot2_f32_bf16 v22, v47, v47, v22
    v_dot2_f32_bf16 v20, v47, s36, v20
    v_dot2_f32_bf16 v23, v48, v48, v23
    v_dot2_f32_bf16 v21, v48, s36, v21
    v_dot2_f32_bf16 v23, v49, v49, v23
    v_dot2_f32_bf16 v21, v49, s36, v21
    v_dot2_f32_bf16 v23, v50, v50, v23
    v_dot2_f32_bf16 v21, v50, s36, v21
    v_dot2_f32_bf16 v23, v51, v51, v23
    v_dot2_f32_bf16 v21, v51, s36, v21
    v_dot2_f32_bf16 v24, v52, s36, v24
    v_dot2_f32_bf16 v24, v53, s36, v24
    v_dot2_f32_bf16 v24, v54, s36, v24
    v_dot2_f32_bf16 v24, v55, s36, v24
    s_waitcnt lgkmcnt(0)
    ds_read_b128 v[44:47], v15 offset:0
    ds_read_b128 v[48:51], v15 offset:4096
    ds_read_b64_tr_b16 v[52:53], v16 offset:3072
    ds_read_b64_tr_b16 v[54:55], v16 offset:3328
    v_mfma_f32_32x32x16_bf16 v[64:79], v[40:43], v[32:35], v[64:79]
    v_mfma_f32_32x32x16_bf16 v[80:95], v[40:43], v[36:39], v[80:95]
    v_dot2_f32_bf16 v22, v32, v32, v22
    v_dot2_f32_bf16 v20, v32, s36, v20
    v_dot2_f32_bf16 v22, v33, v33, v22
    v_dot2_f32_bf16 v20, v33, s36, v20
    v_dot2_f32_bf16 v22, v34, v34, v22
    v_dot2_f32_bf16 v20, v34, s36, v20
    v_dot2_f32_bf16 v22, v35, v35, v22
    v_dot2_f32_bf16 v20, v35, s36, v20
    v_dot2_f32_bf16 v23, v36, v36, v23
    v_dot2_f32_bf16 v21, v36, s36, v21
    v_dot2_f32_bf16 v23, v37, v37, v23
    v_dot2_f32_bf16 v21, v37, s36, v21
    v_dot2_f32_bf16 v23, v38, v38, v23
    v_dot2_f32_bf16 v21, v38, s36, v21
    v_dot2_f32_bf16 v23, v39, v39, v23
    v_dot2_f32_bf16 v21, v39, s36, v21
    v_dot2_f32_bf16 v24, v40, s36, v24
    v_dot2_f32_bf16 v24, v41, s36, v24
    v_dot2_f32_bf16 v24, v42, s36, v24
    v_dot2_f32_bf16 v24, v43, s36, v24
    s_waitcnt lgkmcnt(0)
    v_mfma_f32_32x32x16_bf16 v[64:79], v[52:55], v[44:47], v[64:79]
    v_mfma_f32_32x32x16_bf16 v[80:95], v[52:55], v[48:51], v[80:95]
    v_dot2_f32_bf16 v22, v44, v44, v22
    v_dot2_f32_bf16 v20, v44, s36, v20
    v_dot2_f32_bf16 v22, v45, v45, v22
    v_dot2_f32_bf16 v20, v45, s36, v20
    v_dot2_f32_bf16 v22, v46, v46, v22
    v_dot2_f32_bf16 v20, v46, s36, v20
    v_dot2_f32_bf16 v22, v47, v47, v22
    v_dot2_f32_bf16 v20, v47, s36, v20
    v_dot2_f32_bf16 v23, v48, v48, v23
    v_dot2_f32_bf16 v21, v48, s36, v21
    v_dot2_f32_bf16 v23, v49, v49, v23
    v_dot2_f32_bf16 v21, v49, s36, v21
    v_dot2_f32_bf16 v23, v50, v50, v23
    v_dot2_f32_bf16 v21, v50, s36, v21
    v_dot2_f32_bf16 v23, v51, v51, v23
    v_dot2_f32_bf16 v21, v51, s36, v21
    v_dot2_f32_bf16 v24, v52, s36, v24
    v_dot2_f32_bf16 v24, v53, s36, v24
    v_dot2_f32_bf16 v24, v54, s36, v24
    v_dot2_f32_bf16 v24, v55, s36, v24
    s_waitcnt vmcnt(0)
    s_barrier
    s_add_u32 s3, s48, 1
    s_cmp_ge_u32 s3, 9
    s_cbranch_scc1 il_qkvA1_kernel_nopf1
    v_readfirstlane_b32 s3, v2
    s_mul_i32 s3, s3, 4096
    s_add_u32 s3, s3, 0
    s_mov_b32 m0, s3
    s_nop 0
    buffer_load_dwordx4 v4, s[8:11], s32 offen lds
    v_readfirstlane_b32 s3, v2
    s_mul_i32 s3, s3, 4096
    s_add_u32 s3, s3, 1024
    s_mov_b32 m0, s3
    s_nop 0
    buffer_load_dwordx4 v5, s[8:11], s32 offen lds
    v_readfirstlane_b32 s3, v2
    s_mul_i32 s3, s3, 4096
    s_add_u32 s3, s3, 2048
    s_mov_b32 m0, s3
    s_nop 0
    buffer_load_dwordx4 v6, s[8:11], s32 offen lds
    v_readfirstlane_b32 s3, v2
    s_mul_i32 s3, s3, 4096
    s_add_u32 s3, s3, 3072
    s_mov_b32 m0, s3
    s_nop 0
    buffer_load_dwordx4 v7, s[8:11], s32 offen lds
    v_readfirstlane_b32 s3, v2
    s_lshl_b32 s3, s3, 10
    s_add_u32 s3, s3, 16384
    s_mov_b32 m0, s3
    s_nop 0
    buffer_load_dwordx4 v8, s[12:15], s33 offen lds
    v_readfirstlane_b32 s3, v2
    s_lshl_b32 s3, s3, 10
    s_add_u32 s3, s3, 20480
    s_mov_b32 m0, s3
    s_nop 0
    buffer_load_dwordx4 v9, s[44:47], s33 offen lds
    s_add_u32 s32, s32, 128
    s_mul_i32 s3, s38, 64
    s_add_u32 s33, s33, s3
il_qkvA1_kernel_nopf1:
    ds_read_b128 v[32:35], v12 offset:24576
    ds_read_b128 v[36:39], v12 offset:28672
    ds_read_b64_tr_b16 v[40:41], v16 offset:24576
    ds_read_b64_tr_b16 v[42:43], v16 offset:24832
    s_waitcnt lgkmcnt(0)
    ds_read_b128 v[44:47], v13 offset:24576
    ds_read_b128 v[48:51], v13 offset:28672
    ds_read_b64_tr_b16 v[52:53], v16 offset:25600
    ds_read_b64_tr_b16 v[54:55], v16 offset:25856
    v_mfma_f32_32x32x16_bf16 v[64:79], v[40:43], v[32:35], v[64:79]
    v_mfma_f32_32x32x16_bf16 v[80:95], v[40:43], v[36:39], v[80:95]
    v_dot2_f32_bf16 v22, v32, v32, v22
    v_dot2_f32_bf16 v20, v32, s36, v20
    v_dot2_f32_bf16 v22, v33, v33, v22
    v_dot2_f32_bf16 v20, v33, s36, v20
    v_dot2_f32_bf16 v22, v34, v34, v22
    v_dot2_f32_bf16 v20, v34, s36, v20
    v_dot2_f32_bf16 v22, v35, v35, v22
    v_dot2_f32_bf16 v20, v35, s36, v20
    v_dot2_f32_bf16 v23, v36, v36, v23
    v_dot2_f32_bf16 v21, v36, s36, v21
    v_dot2_f32_bf16 v23, v37, v37, v23
    v_dot2_f32_bf16 v21, v37, s36, v21
    v_dot2_f32_bf16 v23, v38, v38, v23
    v_dot2_f32_bf16 v21, v38, s36, v21
    v_dot2_f32_bf16 v23, v39, v39, v23
    v_dot2_f32_bf16 v21, v39, s36, v21
    v_dot2_f32_bf16 v24, v40, s36, v24
    v_dot2_f32_bf16 v24, v41, s36, v24
    v_dot2_f32_bf16 v24, v42, s36, v24
    v_dot2_f32_bf16 v24, v43, s36, v24
    s_waitcnt lgkmcnt(0)
    ds_read_b128 v[32:35], v14 offset:24576
    ds_read_b128 v[36:39], v14 offset:28672
    ds_read_b64_tr_b16 v[40:41], v16 offset:26624
    ds_read_b64_tr_b16 v[42:43], v16 offset:26880
    v_mfma_f32_32x32x16_bf16 v[64:79], v[52:55], v[44:47], v[64:79]
    v_mfma_f32_32x32x16_bf16 v[80:95], v[52:55], v[48:51], v[80:95]
    v_dot2_f32_bf16 v22, v44, v44, v22
    v_dot2_f32_bf16 v20, v44, s36, v20
    v_dot2_f32_bf16 v22, v45, v45, v22
    v_dot2_f32_bf16 v20, v45, s36, v20
    v_dot2_f32_bf16 v22, v46, v46, v22
    v_dot2_f32_bf16 v20, v46, s36, v20
    v_dot2_f32_bf16 v22, v47, v47, v22
    v_dot2_f32_bf16 v20, v47, s36, v20
    v_dot2_f32_bf16 v23, v48, v48, v23
    v_dot2_f32_bf16 v21, v48, s36, v21
    v_dot2_f32_bf16 v23, v49, v49, v23
    v_dot2_f32_bf16 v21, v49, s36, v21
    v_dot2_f32_bf16 v23, v50, v50, v23
    v_dot2_f32_bf16 v21, v50, s36, v21
    v_dot2_f32_bf16 v23, v51, v51, v23
    v_dot2_f32_bf16 v21, v51, s36, v21
    v_dot2_f32_bf16 v24, v52, s36, v24
    v_dot2_f32_bf16 v24, v53, s36, v24
    v_dot2_f32_bf16 v24, v54, s36, v24
    v_dot2_f32_bf16 v24, v55, s36, v24
    s_waitcnt lgkmcnt(0)
    ds_read_b128 v[44:47], v15 offset:24576
    ds_read_b128 v[48:51], v15 offset:28672
    ds_read_b64_tr_b16 v[52:53], v16 offset:27648
    ds_read_b64_tr_b16 v[54:55], v16 offset:27904
    v_mfma_f32_32x32x16_bf16 v[64:79], v[40:43], v[32:35], v[64:79]
    v_mfma_f32_32x32x16_bf16 v[80:95], v[40:43], v[36:39], v[80:95]
    v_dot2_f32_bf16 v22, v32, v32, v22
    v_dot2_f32_bf16 v20, v32, s36, v20
    v_dot2_f32_bf16 v22, v33, v33, v22
    v_dot2_f32_bf16 v20, v33, s36, v20
    v_dot2_f32_bf16 v22, v34, v34, v22
    v_dot2_f32_bf16 v20, v34, s36, v20
    v_dot2_f32_bf16 v22, v35, v35, v22
    v_dot2_f32_bf16 v20, v35, s36, v20
    v_dot2_f32_bf16 v23, v36, v36, v23
    v_dot2_f32_bf16 v21, v36, s36, v21
    v_dot2_f32_bf16 v23, v37, v37, v23
    v_dot2_f32_bf16 v21, v37, s36, v21
    v_dot2_f32_bf16 v23, v38, v38, v23
    v_dot2_f32_bf16 v21, v38, s36, v21
    v_dot2_f32_bf16 v23, v39, v39, v23
    v_dot2_f32_bf16 v21, v39, s36, v21
    v_dot2_f32_bf16 v24, v40, s36, v24
    v_dot2_f32_bf16 v24, v41, s36, v24
    v_dot2_f32_bf16 v24, v42, s36, v24
    v_dot2_f32_bf16 v24, v43, s36, v24
    s_waitcnt lgkmcnt(0)
    v_mfma_f32_32x32x16_bf16 v[64:79], v[52:55], v[44:47], v[64:79]
    v_mfma_f32_32x32x16_bf16 v[80:95], v[52:55], v[48:51], v[80:95]
    v_dot2_f32_bf16 v22, v44, v44, v22
    v_dot2_f32_bf16 v20, v44, s36, v20
    v_dot2_f32_bf16 v22, v45, v45, v22
    v_dot2_f32_bf16 v20, v45, s36, v20
    v_dot2_f32_bf16 v22, v46, v46, v22
    v_dot2_f32_bf16 v20, v46, s36, v20
    v_dot2_f32_bf16 v22, v47, v47, v22
    v_dot2_f32_bf16 v20, v47, s36, v20
    v_dot2_f32_bf16 v23, v48, v48, v23
    v_dot2_f32_bf16 v21, v48, s36, v21
    v_dot2_f32_bf16 v23, v49, v49, v23
    v_dot2_f32_bf16 v21, v49, s36, v21
    v_dot2_f32_bf16 v23, v50, v50, v23
    v_dot2_f32_bf16 v21, v50, s36, v21
    v_dot2_f32_bf16 v23, v51, v51, v23
    v_dot2_f32_bf16 v21, v51, s36, v21
    v_dot2_f32_bf16 v24, v52, s36, v24
    v_dot2_f32_bf16 v24, v53, s36, v24
    v_dot2_f32_bf16 v24, v54, s36, v24
    v_dot2_f32_bf16 v24, v55, s36, v24
    s_add_u32 s48, s48, 2
    s_cmp_lt_u32 s48, 10
    s_cbranch_scc1 il_qkvA1_kernel_loop
    s_nop 15
    s_nop 7
    v_and_b32 v4, 31, v1
    v_and_b32 v5, 1, v2
    v_mul_u32_u24 v5, 64, v5
    v_add3_u32 v4, v4, v5, s34
    v_lshrrev_b32 v5, 1, v2
    v_mul_u32_u24 v5, 32, v5
    v_lshl_add_u32 v5, v3, 2, v5
    v_add_u32 v5, s35, v5
    v_mov_b32 v6, v20
    s_nop 1
    v_permlane32_swap_b32 v6, v20
    s_nop 1
    v_add_f32 v20, v20, v6
    v_mov_b32 v6, v22
    s_nop 1
    v_permlane32_swap_b32 v6, v22
    s_nop 1
    v_add_f32 v22, v22, v6
    v_mov_b32 v6, v21
    s_nop 1
    v_permlane32_swap_b32 v6, v21
    s_nop 1
    v_add_f32 v21, v21, v6
    v_mov_b32 v6, v23
    s_nop 1
    v_permlane32_swap_b32 v6, v23
    s_nop 1
    v_add_f32 v23, v23, v6
    v_mov_b32 v6, v24
    s_nop 1
    v_permlane32_swap_b32 v6, v24
    s_nop 1
    v_add_f32 v24, v24, v6
    s_mov_b32 s3, 0x3acccccd
    v_mul_f32 v20, s3, v20
    v_mul_f32 v22, s3, v22
    v_fma_f32 v22, -v20, v20, v22
    v_max_f32 v22, 0, v22
    v_add_f32 v22, 0x3727c5ac, v22
    v_rsq_f32 v22, v22
    v_mul_f32 v21, s3, v21
    v_mul_f32 v23, s3, v23
    v_fma_f32 v23, -v21, v21, v23
    v_max_f32 v23, 0, v23
    v_add_f32 v23, 0x3727c5ac, v23
    v_rsq_f32 v23, v23
    v_lshlrev_b32 v6, 2, v1
    v_mul_u32_u24 v7, 256, v2
    v_add_u32 v6, v6, v7
    v_add_u32 v6, 49152, v6
    ds_write_b32 v6, v24 offset:0
    s_waitcnt lgkmcnt(0)
    v_lshlrev_b32 v6, 4, v3
    v_add3_u32 v6, v6, v7, 0
    v_add_u32 v6, 49152, v6
    ds_read_b128 v[32:35], v6 offset:0
    ds_read_b128 v[36:39], v6 offset:32
    ds_read_b128 v[40:43], v6 offset:64
    ds_read_b128 v[44:47], v6 offset:96
    s_waitcnt lgkmcnt(0)
    s_mov_b32 s49, 0x3ea52b5c
    s_mov_b32 s56, 640
    v_add_u32 v8, 0, v4
    v_fma_f32 v64, -v20, v32, v64
    v_mul_f32 v64, v22, v64
    v_fma_f32 v65, -v20, v33, v65
    v_mul_f32 v65, v22, v65
    v_fma_f32 v66, -v20, v34, v66
    v_mul_f32 v66, v22, v66
    v_fma_f32 v67, -v20, v35, v67
    v_mul_f32 v67, v22, v67
    v_fma_f32 v68, -v20, v36, v68
    v_mul_f32 v68, v22, v68
    v_fma_f32 v69, -v20, v37, v69
    v_mul_f32 v69, v22, v69
    v_fma_f32 v70, -v20, v38, v70
    v_mul_f32 v70, v22, v70
    v_fma_f32 v71, -v20, v39, v71
    v_mul_f32 v71, v22, v71
    v_fma_f32 v72, -v20, v40, v72
    v_mul_f32 v72, v22, v72
    v_fma_f32 v73, -v20, v41, v73
    v_mul_f32 v73, v22, v73
    v_fma_f32 v74, -v20, v42, v74
    v_mul_f32 v74, v22, v74
    v_fma_f32 v75, -v20, v43, v75
    v_mul_f32 v75, v22, v75
    v_fma_f32 v76, -v20, v44, v76
    v_mul_f32 v76, v22, v76
    v_fma_f32 v77, -v20, v45, v77
    v_mul_f32 v77, v22, v77
    v_fma_f32 v78, -v20, v46, v78
    v_mul_f32 v78, v22, v78
    v_fma_f32 v79, -v20, v47, v79
    v_mul_f32 v79, v22, v79
    v_add_u32 v9, 0, v5
    v_cmp_gt_u32 vcc, 640, v9
    s_and_saveexec_b64 s[50:51], vcc
    v_mul_f32 v16, s49, v64
    v_mul_f32 v17, s49, v65
    v_mul_f32 v18, s49, v66
    v_mul_f32 v19, s49, v67
    v_cvt_pk_bf16_f32 v14, v16, v17
    v_cvt_pk_bf16_f32 v15, v18, v19
    v_mul_u32_u24 v10, 1280, v8
    v_lshl_add_u32 v10, v9, 1, v10
    buffer_store_dwordx2 v[14:15], v10, s[20:23], 0 offen
    s_mov_b64 exec, s[50:51]
    v_cvt_pk_bf16_f32 v14, v64, v65
    v_cvt_pk_bf16_f32 v15, v66, v67
    v_subrev_u32 v11, 640, v9
    v_mov_b32 v12, 0
    v_and_b32 v13, 31, v11
    v_lshrrev_b32 v11, 5, v11
    v_cmp_le_u32 vcc, 640, v9
    v_cmp_gt_u32 s[52:53], 20, v13
    s_nop 1
    s_and_b64 vcc, vcc, s[52:53]
    s_and_saveexec_b64 s[50:51], vcc
    v_lshlrev_b32 v16, 17, v12
    v_lshl_add_u32 v16, v8, 6, v16
    v_lshrrev_b32 v17, 3, v13
    v_lshrrev_b32 v18, 2, v8
    v_and_b32 v18, 3, v18
    v_xor_b32 v17, v17, v18
    v_lshl_add_u32 v17, v17, 4, v16
    v_and_b32 v18, 7, v13
    v_lshl_add_u32 v17, v18, 1, v17
    v_lshl_add_u32 v16, v13, 1, v16
    v_cmp_eq_u32 vcc, 0, v11
    s_and_saveexec_b64 s[52:53], vcc
    buffer_store_dwordx2 v[14:15], v17, s[24:27], 0 offen
    v_cmp_eq_u32 vcc, 16, v13
    s_and_saveexec_b64 s[54:55], vcc
    v_mov_b32 v18, 0
    v_mov_b32 v19, 0
    buffer_store_dwordx2 v[18:19], v17, s[24:27], 0 offen offset:8
    v_lshrrev_b32 v18, 2, v8
    v_and_b32 v18, 3, v18
    v_xor_b32 v18, 3, v18
    v_and_b32 v19, 0xffffffc0, v17
    v_lshl_add_u32 v18, v18, 4, v19
    v_mov_b32 v28, 0
    v_mov_b32 v29, 0
    v_mov_b32 v30, 0
    v_mov_b32 v31, 0
    buffer_store_dwordx4 v[28:31], v18, s[24:27], 0 offen
    s_mov_b64 exec, s[50:51]
    v_cmp_ne_u32 vcc, 0, v11
    v_cmp_le_u32 s[52:53], s56, v9
    s_and_b64 vcc, vcc, s[52:53]
    v_cmp_gt_u32 s[52:53], 20, v13
    s_nop 1
    s_and_b64 vcc, vcc, s[52:53]
    s_and_saveexec_b64 s[52:53], vcc
    buffer_store_dwordx2 v[14:15], v16, s[28:31], 0 offen
    v_cmp_eq_u32 vcc, 16, v13
    s_and_saveexec_b64 s[54:55], vcc
    v_mov_b32 v18, 0x3f80
    v_mov_b32 v19, 0
    buffer_store_dwordx2 v[18:19], v16, s[28:31], 0 offen offset:8
    s_mov_b64 exec, -1
    v_add_u32 v9, 8, v5
    v_cmp_gt_u32 vcc, 640, v9
    s_and_saveexec_b64 s[50:51], vcc
    v_mul_f32 v16, s49, v68
    v_mul_f32 v17, s49, v69
    v_mul_f32 v18, s49, v70
    v_mul_f32 v19, s49, v71
    v_cvt_pk_bf16_f32 v14, v16, v17
    v_cvt_pk_bf16_f32 v15, v18, v19
    v_mul_u32_u24 v10, 1280, v8
    v_lshl_add_u32 v10, v9, 1, v10
    buffer_store_dwordx2 v[14:15], v10, s[20:23], 0 offen
    s_mov_b64 exec, s[50:51]
    v_cvt_pk_bf16_f32 v14, v68, v69
    v_cvt_pk_bf16_f32 v15, v70, v71
    v_subrev_u32 v11, 640, v9
    v_mov_b32 v12, 0
    v_and_b32 v13, 31, v11
    v_lshrrev_b32 v11, 5, v11
    v_cmp_le_u32 vcc, 640, v9
    v_cmp_gt_u32 s[52:53], 20, v13
    s_nop 1
    s_and_b64 vcc, vcc, s[52:53]
    s_and_saveexec_b64 s[50:51], vcc
    v_lshlrev_b32 v16, 17, v12
    v_lshl_add_u32 v16, v8, 6, v16
    v_lshrrev_b32 v17, 3, v13
    v_lshrrev_b32 v18, 2, v8
    v_and_b32 v18, 3, v18
    v_xor_b32 v17, v17, v18
    v_lshl_add_u32 v17, v17, 4, v16
    v_and_b32 v18, 7, v13
    v_lshl_add_u32 v17, v18, 1, v17
    v_lshl_add_u32 v16, v13, 1, v16
    v_cmp_eq_u32 vcc, 0, v11
    s_and_saveexec_b64 s[52:53], vcc
    buffer_store_dwordx2 v[14:15], v17, s[24:27], 0 offen
    v_cmp_eq_u32 vcc, 16, v13
    s_and_saveexec_b64 s[54:55], vcc
    v_mov_b32 v18, 0
    v_mov_b32 v19, 0
    buffer_store_dwordx2 v[18:19], v17, s[24:27], 0 offen offset:8
    v_lshrrev_b32 v18, 2, v8
    v_and_b32 v18, 3, v18
    v_xor_b32 v18, 3, v18
    v_and_b32 v19, 0xffffffc0, v17
    v_lshl_add_u32 v18, v18, 4, v19
    v_mov_b32 v28, 0
    v_mov_b32 v29, 0
    v_mov_b32 v30, 0
    v_mov_b32 v31, 0
    buffer_store_dwordx4 v[28:31], v18, s[24:27], 0 offen
    s_mov_b64 exec, s[50:51]
    v_cmp_ne_u32 vcc, 0, v11
    v_cmp_le_u32 s[52:53], s56, v9
    s_and_b64 vcc, vcc, s[52:53]
    v_cmp_gt_u32 s[52:53], 20, v13
    s_nop 1
    s_and_b64 vcc, vcc, s[52:53]
    s_and_saveexec_b64 s[52:53], vcc
    buffer_store_dwordx2 v[14:15], v16, s[28:31], 0 offen
    v_cmp_eq_u32 vcc, 16, v13
    s_and_saveexec_b64 s[54:55], vcc
    v_mov_b32 v18, 0x3f80
    v_mov_b32 v19, 0
    buffer_store_dwordx2 v[18:19], v16, s[28:31], 0 offen offset:8
    s_mov_b64 exec, -1
    v_add_u32 v9, 16, v5
    v_cmp_gt_u32 vcc, 640, v9
    s_and_saveexec_b64 s[50:51], vcc
    v_mul_f32 v16, s49, v72
    v_mul_f32 v17, s49, v73
    v_mul_f32 v18, s49, v74
    v_mul_f32 v19, s49, v75
    v_cvt_pk_bf16_f32 v14, v16, v17
    v_cvt_pk_bf16_f32 v15, v18, v19
    v_mul_u32_u24 v10, 1280, v8
    v_lshl_add_u32 v10, v9, 1, v10
    buffer_store_dwordx2 v[14:15], v10, s[20:23], 0 offen
    s_mov_b64 exec, s[50:51]
    v_cvt_pk_bf16_f32 v14, v72, v73
    v_cvt_pk_bf16_f32 v15, v74, v75
    v_subrev_u32 v11, 640, v9
    v_mov_b32 v12, 0
    v_and_b32 v13, 31, v11
    v_lshrrev_b32 v11, 5, v11
    v_cmp_le_u32 vcc, 640, v9
    v_cmp_gt_u32 s[52:53], 20, v13
    s_nop 1
    s_and_b64 vcc, vcc, s[52:53]
    s_and_saveexec_b64 s[50:51], vcc
    v_lshlrev_b32 v16, 17, v12
    v_lshl_add_u32 v16, v8, 6, v16
    v_lshrrev_b32 v17, 3, v13
    v_lshrrev_b32 v18, 2, v8
    v_and_b32 v18, 3, v18
    v_xor_b32 v17, v17, v18
    v_lshl_add_u32 v17, v17, 4, v16
    v_and_b32 v18, 7, v13
    v_lshl_add_u32 v17, v18, 1, v17
    v_lshl_add_u32 v16, v13, 1, v16
    v_cmp_eq_u32 vcc, 0, v11
    s_and_saveexec_b64 s[52:53], vcc
    buffer_store_dwordx2 v[14:15], v17, s[24:27], 0 offen
    v_cmp_eq_u32 vcc, 16, v13
    s_and_saveexec_b64 s[54:55], vcc
    v_mov_b32 v18, 0
    v_mov_b32 v19, 0
    buffer_store_dwordx2 v[18:19], v17, s[24:27], 0 offen offset:8
    v_lshrrev_b32 v18, 2, v8
    v_and_b32 v18, 3, v18
    v_xor_b32 v18, 3, v18
    v_and_b32 v19, 0xffffffc0, v17
    v_lshl_add_u32 v18, v18, 4, v19
    v_mov_b32 v28, 0
    v_mov_b32 v29, 0
    v_mov_b32 v30, 0
    v_mov_b32 v31, 0
    buffer_store_dwordx4 v[28:31], v18, s[24:27], 0 offen
    s_mov_b64 exec, s[50:51]
    v_cmp_ne_u32 vcc, 0, v11
    v_cmp_le_u32 s[52:53], s56, v9
    s_and_b64 vcc, vcc, s[52:53]
    v_cmp_gt_u32 s[52:53], 20, v13
    s_nop 1
    s_and_b64 vcc, vcc, s[52:53]
    s_and_saveexec_b64 s[52:53], vcc
    buffer_store_dwordx2 v[14:15], v16, s[28:31], 0 offen
    v_cmp_eq_u32 vcc, 16, v13
    s_and_saveexec_b64 s[54:55], vcc
    v_mov_b32 v18, 0x3f80
    v_mov_b32 v19, 0
    buffer_store_dwordx2 v[18:19], v16, s[28:31], 0 offen offset:8
    s_mov_b64 exec, -1
    v_add_u32 v9, 24, v5
    v_cmp_gt_u32 vcc, 640, v9
    s_and_saveexec_b64 s[50:51], vcc
    v_mul_f32 v16, s49, v76
    v_mul_f32 v17, s49, v77
    v_mul_f32 v18, s49, v78
    v_mul_f32 v19, s49, v79
    v_cvt_pk_bf16_f32 v14, v16, v17
    v_cvt_pk_bf16_f32 v15, v18, v19
    v_mul_u32_u24 v10, 1280, v8
    v_lshl_add_u32 v10, v9, 1, v10
    buffer_store_dwordx2 v[14:15], v10, s[20:23], 0 offen
    s_mov_b64 exec, s[50:51]
    v_cvt_pk_bf16_f32 v14, v76, v77
    v_cvt_pk_bf16_f32 v15, v78, v79
    v_subrev_u32 v11, 640, v9
    v_mov_b32 v12, 0
    v_and_b32 v13, 31, v11
    v_lshrrev_b32 v11, 5, v11
    v_cmp_le_u32 vcc, 640, v9
    v_cmp_gt_u32 s[52:53], 20, v13
    s_nop 1
    s_and_b64 vcc, vcc, s[52:53]
    s_and_saveexec_b64 s[50:51], vcc
    v_lshlrev_b32 v16, 17, v12
    v_lshl_add_u32 v16, v8, 6, v16
    v_lshrrev_b32 v17, 3, v13
    v_lshrrev_b32 v18, 2, v8
    v_and_b32 v18, 3, v18
    v_xor_b32 v17, v17, v18
    v_lshl_add_u32 v17, v17, 4, v16
    v_and_b32 v18, 7, v13
    v_lshl_add_u32 v17, v18, 1, v17
    v_lshl_add_u32 v16, v13, 1, v16
    v_cmp_eq_u32 vcc, 0, v11
    s_and_saveexec_b64 s[52:53], vcc
    buffer_store_dwordx2 v[14:15], v17, s[24:27], 0 offen
    v_cmp_eq_u32 vcc, 16, v13
    s_and_saveexec_b64 s[54:55], vcc
    v_mov_b32 v18, 0
    v_mov_b32 v19, 0
    buffer_store_dwordx2 v[18:19], v17, s[24:27], 0 offen offset:8
    v_lshrrev_b32 v18, 2, v8
    v_and_b32 v18, 3, v18
    v_xor_b32 v18, 3, v18
    v_and_b32 v19, 0xffffffc0, v17
    v_lshl_add_u32 v18, v18, 4, v19
    v_mov_b32 v28, 0
    v_mov_b32 v29, 0
    v_mov_b32 v30, 0
    v_mov_b32 v31, 0
    buffer_store_dwordx4 v[28:31], v18, s[24:27], 0 offen
    s_mov_b64 exec, s[50:51]
    v_cmp_ne_u32 vcc, 0, v11
    v_cmp_le_u32 s[52:53], s56, v9
    s_and_b64 vcc, vcc, s[52:53]
    v_cmp_gt_u32 s[52:53], 20, v13
    s_nop 1
    s_and_b64 vcc, vcc, s[52:53]
    s_and_saveexec_b64 s[52:53], vcc
    buffer_store_dwordx2 v[14:15], v16, s[28:31], 0 offen
    v_cmp_eq_u32 vcc, 16, v13
    s_and_saveexec_b64 s[54:55], vcc
    v_mov_b32 v18, 0x3f80
    v_mov_b32 v19, 0
    buffer_store_dwordx2 v[18:19], v16, s[28:31], 0 offen offset:8
    s_mov_b64 exec, -1
    v_add_u32 v8, 32, v4
    v_fma_f32 v80, -v21, v32, v80
    v_mul_f32 v80, v23, v80
    v_fma_f32 v81, -v21, v33, v81
    v_mul_f32 v81, v23, v81
    v_fma_f32 v82, -v21, v34, v82
    v_mul_f32 v82, v23, v82
    v_fma_f32 v83, -v21, v35, v83
    v_mul_f32 v83, v23, v83
    v_fma_f32 v84, -v21, v36, v84
    v_mul_f32 v84, v23, v84
    v_fma_f32 v85, -v21, v37, v85
    v_mul_f32 v85, v23, v85
    v_fma_f32 v86, -v21, v38, v86
    v_mul_f32 v86, v23, v86
    v_fma_f32 v87, -v21, v39, v87
    v_mul_f32 v87, v23, v87
    v_fma_f32 v88, -v21, v40, v88
    v_mul_f32 v88, v23, v88
    v_fma_f32 v89, -v21, v41, v89
    v_mul_f32 v89, v23, v89
    v_fma_f32 v90, -v21, v42, v90
    v_mul_f32 v90, v23, v90
    v_fma_f32 v91, -v21, v43, v91
    v_mul_f32 v91, v23, v91
    v_fma_f32 v92, -v21, v44, v92
    v_mul_f32 v92, v23, v92
    v_fma_f32 v93, -v21, v45, v93
    v_mul_f32 v93, v23, v93
    v_fma_f32 v94, -v21, v46, v94
    v_mul_f32 v94, v23, v94
    v_fma_f32 v95, -v21, v47, v95
    v_mul_f32 v95, v23, v95
    v_add_u32 v9, 0, v5
    v_cmp_gt_u32 vcc, 640, v9
    s_and_saveexec_b64 s[50:51], vcc
    v_mul_f32 v16, s49, v80
    v_mul_f32 v17, s49, v81
    v_mul_f32 v18, s49, v82
    v_mul_f32 v19, s49, v83
    v_cvt_pk_bf16_f32 v14, v16, v17
    v_cvt_pk_bf16_f32 v15, v18, v19
    v_mul_u32_u24 v10, 1280, v8
    v_lshl_add_u32 v10, v9, 1, v10
    buffer_store_dwordx2 v[14:15], v10, s[20:23], 0 offen
    s_mov_b64 exec, s[50:51]
    v_cvt_pk_bf16_f32 v14, v80, v81
    v_cvt_pk_bf16_f32 v15, v82, v83
    v_subrev_u32 v11, 640, v9
    v_mov_b32 v12, 0
    v_and_b32 v13, 31, v11
    v_lshrrev_b32 v11, 5, v11
    v_cmp_le_u32 vcc, 640, v9
    v_cmp_gt_u32 s[52:53], 20, v13
    s_nop 1
    s_and_b64 vcc, vcc, s[52:53]
    s_and_saveexec_b64 s[50:51], vcc
    v_lshlrev_b32 v16, 17, v12
    v_lshl_add_u32 v16, v8, 6, v16
    v_lshrrev_b32 v17, 3, v13
    v_lshrrev_b32 v18, 2, v8
    v_and_b32 v18, 3, v18
    v_xor_b32 v17, v17, v18
    v_lshl_add_u32 v17, v17, 4, v16
    v_and_b32 v18, 7, v13
    v_lshl_add_u32 v17, v18, 1, v17
    v_lshl_add_u32 v16, v13, 1, v16
    v_cmp_eq_u32 vcc, 0, v11
    s_and_saveexec_b64 s[52:53], vcc
    buffer_store_dwordx2 v[14:15], v17, s[24:27], 0 offen
    v_cmp_eq_u32 vcc, 16, v13
    s_and_saveexec_b64 s[54:55], vcc
    v_mov_b32 v18, 0
    v_mov_b32 v19, 0
    buffer_store_dwordx2 v[18:19], v17, s[24:27], 0 offen offset:8
    v_lshrrev_b32 v18, 2, v8
    v_and_b32 v18, 3, v18
    v_xor_b32 v18, 3, v18
    v_and_b32 v19, 0xffffffc0, v17
    v_lshl_add_u32 v18, v18, 4, v19
    v_mov_b32 v28, 0
    v_mov_b32 v29, 0
    v_mov_b32 v30, 0
    v_mov_b32 v31, 0
    buffer_store_dwordx4 v[28:31], v18, s[24:27], 0 offen
    s_mov_b64 exec, s[50:51]
    v_cmp_ne_u32 vcc, 0, v11
    v_cmp_le_u32 s[52:53], s56, v9
    s_and_b64 vcc, vcc, s[52:53]
    v_cmp_gt_u32 s[52:53], 20, v13
    s_nop 1
    s_and_b64 vcc, vcc, s[52:53]
    s_and_saveexec_b64 s[52:53], vcc
    buffer_store_dwordx2 v[14:15], v16, s[28:31], 0 offen
    v_cmp_eq_u32 vcc, 16, v13
    s_and_saveexec_b64 s[54:55], vcc
    v_mov_b32 v18, 0x3f80
    v_mov_b32 v19, 0
    buffer_store_dwordx2 v[18:19], v16, s[28:31], 0 offen offset:8
    s_mov_b64 exec, -1
    v_add_u32 v9, 8, v5
    v_cmp_gt_u32 vcc, 640, v9
    s_and_saveexec_b64 s[50:51], vcc
    v_mul_f32 v16, s49, v84
    v_mul_f32 v17, s49, v85
    v_mul_f32 v18, s49, v86
    v_mul_f32 v19, s49, v87
    v_cvt_pk_bf16_f32 v14, v16, v17
    v_cvt_pk_bf16_f32 v15, v18, v19
    v_mul_u32_u24 v10, 1280, v8
    v_lshl_add_u32 v10, v9, 1, v10
    buffer_store_dwordx2 v[14:15], v10, s[20:23], 0 offen
    s_mov_b64 exec, s[50:51]
    v_cvt_pk_bf16_f32 v14, v84, v85
    v_cvt_pk_bf16_f32 v15, v86, v87
    v_subrev_u32 v11, 640, v9
    v_mov_b32 v12, 0
    v_and_b32 v13, 31, v11
    v_lshrrev_b32 v11, 5, v11
    v_cmp_le_u32 vcc, 640, v9
    v_cmp_gt_u32 s[52:53], 20, v13
    s_nop 1
    s_and_b64 vcc, vcc, s[52:53]
    s_and_saveexec_b64 s[50:51], vcc
    v_lshlrev_b32 v16, 17, v12
    v_lshl_add_u32 v16, v8, 6, v16
    v_lshrrev_b32 v17, 3, v13
    v_lshrrev_b32 v18, 2, v8
    v_and_b32 v18, 3, v18
    v_xor_b32 v17, v17, v18
    v_lshl_add_u32 v17, v17, 4, v16
    v_and_b32 v18, 7, v13
    v_lshl_add_u32 v17, v18, 1, v17
    v_lshl_add_u32 v16, v13, 1, v16
    v_cmp_eq_u32 vcc, 0, v11
    s_and_saveexec_b64 s[52:53], vcc
    buffer_store_dwordx2 v[14:15], v17, s[24:27], 0 offen
    v_cmp_eq_u32 vcc, 16, v13
    s_and_saveexec_b64 s[54:55], vcc
    v_mov_b32 v18, 0
    v_mov_b32 v19, 0
    buffer_store_dwordx2 v[18:19], v17, s[24:27], 0 offen offset:8
    v_lshrrev_b32 v18, 2, v8
    v_and_b32 v18, 3, v18
    v_xor_b32 v18, 3, v18
    v_and_b32 v19, 0xffffffc0, v17
    v_lshl_add_u32 v18, v18, 4, v19
    v_mov_b32 v28, 0
    v_mov_b32 v29, 0
    v_mov_b32 v30, 0
    v_mov_b32 v31, 0
    buffer_store_dwordx4 v[28:31], v18, s[24:27], 0 offen
    s_mov_b64 exec, s[50:51]
    v_cmp_ne_u32 vcc, 0, v11
    v_cmp_le_u32 s[52:53], s56, v9
    s_and_b64 vcc, vcc, s[52:53]
    v_cmp_gt_u32 s[52:53], 20, v13
    s_nop 1
    s_and_b64 vcc, vcc, s[52:53]
    s_and_saveexec_b64 s[52:53], vcc
    buffer_store_dwordx2 v[14:15], v16, s[28:31], 0 offen
    v_cmp_eq_u32 vcc, 16, v13
    s_and_saveexec_b64 s[54:55], vcc
    v_mov_b32 v18, 0x3f80
    v_mov_b32 v19, 0
    buffer_store_dwordx2 v[18:19], v16, s[28:31], 0 offen offset:8
    s_mov_b64 exec, -1
    v_add_u32 v9, 16, v5
    v_cmp_gt_u32 vcc, 640, v9
    s_and_saveexec_b64 s[50:51], vcc
    v_mul_f32 v16, s49, v88
    v_mul_f32 v17, s49, v89
    v_mul_f32 v18, s49, v90
    v_mul_f32 v19, s49, v91
    v_cvt_pk_bf16_f32 v14, v16, v17
    v_cvt_pk_bf16_f32 v15, v18, v19
    v_mul_u32_u24 v10, 1280, v8
    v_lshl_add_u32 v10, v9, 1, v10
    buffer_store_dwordx2 v[14:15], v10, s[20:23], 0 offen
    s_mov_b64 exec, s[50:51]
    v_cvt_pk_bf16_f32 v14, v88, v89
    v_cvt_pk_bf16_f32 v15, v90, v91
    v_subrev_u32 v11, 640, v9
    v_mov_b32 v12, 0
    v_and_b32 v13, 31, v11
    v_lshrrev_b32 v11, 5, v11
    v_cmp_le_u32 vcc, 640, v9
    v_cmp_gt_u32 s[52:53], 20, v13
    s_nop 1
    s_and_b64 vcc, vcc, s[52:53]
    s_and_saveexec_b64 s[50:51], vcc
    v_lshlrev_b32 v16, 17, v12
    v_lshl_add_u32 v16, v8, 6, v16
    v_lshrrev_b32 v17, 3, v13
    v_lshrrev_b32 v18, 2, v8
    v_and_b32 v18, 3, v18
    v_xor_b32 v17, v17, v18
    v_lshl_add_u32 v17, v17, 4, v16
    v_and_b32 v18, 7, v13
    v_lshl_add_u32 v17, v18, 1, v17
    v_lshl_add_u32 v16, v13, 1, v16
    v_cmp_eq_u32 vcc, 0, v11
    s_and_saveexec_b64 s[52:53], vcc
    buffer_store_dwordx2 v[14:15], v17, s[24:27], 0 offen
    v_cmp_eq_u32 vcc, 16, v13
    s_and_saveexec_b64 s[54:55], vcc
    v_mov_b32 v18, 0
    v_mov_b32 v19, 0
    buffer_store_dwordx2 v[18:19], v17, s[24:27], 0 offen offset:8
    v_lshrrev_b32 v18, 2, v8
    v_and_b32 v18, 3, v18
    v_xor_b32 v18, 3, v18
    v_and_b32 v19, 0xffffffc0, v17
    v_lshl_add_u32 v18, v18, 4, v19
    v_mov_b32 v28, 0
    v_mov_b32 v29, 0
    v_mov_b32 v30, 0
    v_mov_b32 v31, 0
    buffer_store_dwordx4 v[28:31], v18, s[24:27], 0 offen
    s_mov_b64 exec, s[50:51]
    v_cmp_ne_u32 vcc, 0, v11
    v_cmp_le_u32 s[52:53], s56, v9
    s_and_b64 vcc, vcc, s[52:53]
    v_cmp_gt_u32 s[52:53], 20, v13
    s_nop 1
    s_and_b64 vcc, vcc, s[52:53]
    s_and_saveexec_b64 s[52:53], vcc
    buffer_store_dwordx2 v[14:15], v16, s[28:31], 0 offen
    v_cmp_eq_u32 vcc, 16, v13
    s_and_saveexec_b64 s[54:55], vcc
    v_mov_b32 v18, 0x3f80
    v_mov_b32 v19, 0
    buffer_store_dwordx2 v[18:19], v16, s[28:31], 0 offen offset:8
    s_mov_b64 exec, -1
    v_add_u32 v9, 24, v5
    v_cmp_gt_u32 vcc, 640, v9
    s_and_saveexec_b64 s[50:51], vcc
    v_mul_f32 v16, s49, v92
    v_mul_f32 v17, s49, v93
    v_mul_f32 v18, s49, v94
    v_mul_f32 v19, s49, v95
    v_cvt_pk_bf16_f32 v14, v16, v17
    v_cvt_pk_bf16_f32 v15, v18, v19
    v_mul_u32_u24 v10, 1280, v8
    v_lshl_add_u32 v10, v9, 1, v10
    buffer_store_dwordx2 v[14:15], v10, s[20:23], 0 offen
    s_mov_b64 exec, s[50:51]
    v_cvt_pk_bf16_f32 v14, v92, v93
    v_cvt_pk_bf16_f32 v15, v94, v95
    v_subrev_u32 v11, 640, v9
    v_mov_b32 v12, 0
    v_and_b32 v13, 31, v11
    v_lshrrev_b32 v11, 5, v11
    v_cmp_le_u32 vcc, 640, v9
    v_cmp_gt_u32 s[52:53], 20, v13
    s_nop 1
    s_and_b64 vcc, vcc, s[52:53]
    s_and_saveexec_b64 s[50:51], vcc
    v_lshlrev_b32 v16, 17, v12
    v_lshl_add_u32 v16, v8, 6, v16
    v_lshrrev_b32 v17, 3, v13
    v_lshrrev_b32 v18, 2, v8
    v_and_b32 v18, 3, v18
    v_xor_b32 v17, v17, v18
    v_lshl_add_u32 v17, v17, 4, v16
    v_and_b32 v18, 7, v13
    v_lshl_add_u32 v17, v18, 1, v17
    v_lshl_add_u32 v16, v13, 1, v16
    v_cmp_eq_u32 vcc, 0, v11
    s_and_saveexec_b64 s[52:53], vcc
    buffer_store_dwordx2 v[14:15], v17, s[24:27], 0 offen
    v_cmp_eq_u32 vcc, 16, v13
    s_and_saveexec_b64 s[54:55], vcc
    v_mov_b32 v18, 0
    v_mov_b32 v19, 0
    buffer_store_dwordx2 v[18:19], v17, s[24:27], 0 offen offset:8
    v_lshrrev_b32 v18, 2, v8
    v_and_b32 v18, 3, v18
    v_xor_b32 v18, 3, v18
    v_and_b32 v19, 0xffffffc0, v17
    v_lshl_add_u32 v18, v18, 4, v19
    v_mov_b32 v28, 0
    v_mov_b32 v29, 0
    v_mov_b32 v30, 0
    v_mov_b32 v31, 0
    buffer_store_dwordx4 v[28:31], v18, s[24:27], 0 offen
    s_mov_b64 exec, s[50:51]
    v_cmp_ne_u32 vcc, 0, v11
    v_cmp_le_u32 s[52:53], s56, v9
    s_and_b64 vcc, vcc, s[52:53]
    v_cmp_gt_u32 s[52:53], 20, v13
    s_nop 1
    s_and_b64 vcc, vcc, s[52:53]
    s_and_saveexec_b64 s[52:53], vcc
    buffer_store_dwordx2 v[14:15], v16, s[28:31], 0 offen
    v_cmp_eq_u32 vcc, 16, v13
    s_and_saveexec_b64 s[54:55], vcc
    v_mov_b32 v18, 0x3f80
    v_mov_b32 v19, 0
    buffer_store_dwordx2 v[18:19], v16, s[28:31], 0 offen offset:8
    s_mov_b64 exec, -1
    s_waitcnt vmcnt(0)
il_qkvA1_kernel_done:
    s_endpgm
.globl il_opA1_kernel
.p2align 8
.type il_opA1_kernel,@function
il_opA1_kernel:
    s_cmp_ge_u32 s2, 160
    s_cbranch_scc1 il_opA1_kernel_done
    s_load_dwordx2 s[4:5], s[0:1], 80
    s_load_dwordx2 s[12:13], s[0:1], 32
    s_and_b32 s34, s2, 15
    s_lshr_b32 s35, s2, 4
    s_mov_b32 s37, s35
    s_mul_i32 s34, s34, 128
    s_mul_i32 s35, s35, 64
    v_and_b32 v1, 63, v0
    v_lshrrev_b32 v2, 6, v0
    v_lshrrev_b32 v3, 5, v1
    s_waitcnt lgkmcnt(0)
    s_add_u32 s8, s4, 10485760
    s_addc_u32 s9, s5, 0
    s_mov_b32 s10, 2621440
    s_mov_b32 s11, 0x00020000
    s_mov_b32 s14, 819200
    s_mov_b32 s15, 0x00020000
    s_add_u32 s20, s4, 5242880
    s_addc_u32 s21, s5, 0
    s_mov_b32 s22, 2621440
    s_mov_b32 s23, 0x00020000
    s_add_u32 s24, s4, 2621440
    s_addc_u32 s25, s5, 0
    s_mov_b32 s26, 2621440
    s_mov_b32 s27, 0x00020000
    s_mov_b32 s36, 0x3f803f80
    v_lshrrev_b32 v17, 3, v1
    v_mul_u32_u24 v18, 32, v2
    v_add_u32 v18, v18, v17
    v_and_b32 v19, 7, v1
    v_lshrrev_b32 v16, 1, v17
    v_xor_b32 v16, v16, v19
    v_lshlrev_b32 v16, 4, v16
    v_add_u32 v4, s34, v18
    v_add_u32 v4, 0, v4
    s_mov_b32 s3, 1280
    v_mul_lo_u32 v4, v4, s3
    v_add_u32 v4, v4, v16
    v_lshrrev_b32 v16, 1, v17
    v_xor_b32 v16, 4, v16
    v_xor_b32 v16, v16, v19
    v_lshlrev_b32 v16, 4, v16
    v_add_u32 v5, s34, v18
    v_add_u32 v5, 8, v5
    s_mov_b32 s3, 1280
    v_mul_lo_u32 v5, v5, s3
    v_add_u32 v5, v5, v16
    v_lshrrev_b32 v16, 1, v17
    v_xor_b32 v16, v16, v19
    v_lshlrev_b32 v16, 4, v16
    v_add_u32 v6, s34, v18
    v_add_u32 v6, 16, v6
    s_mov_b32 s3, 1280
    v_mul_lo_u32 v6, v6, s3
    v_add_u32 v6, v6, v16
    v_lshrrev_b32 v16, 1, v17
    v_xor_b32 v16, 4, v16
    v_xor_b32 v16, v16, v19
    v_lshlrev_b32 v16, 4, v16
    v_add_u32 v7, s34, v18
    v_add_u32 v7, 24, v7
    s_mov_b32 s3, 1280
    v_mul_lo_u32 v7, v7, s3
    v_add_u32 v7, v7, v16
    v_lshrrev_b32 v16, 2, v1
    v_lshl_add_u32 v16, v2, 4, v16
    v_and_b32 v17, 3, v1
    v_lshlrev_b32 v17, 4, v17
    s_mov_b32 s38, 1280
    s_mov_b32 s39, s35
    v_mul_lo_u32 v16, v16, s38
    v_add_u32 v16, v16, v17
    s_lshl_b32 s3, s39, 1
    v_add_u32 v8, s3, v16
    v_add_u32 v9, 64, v8
    v_and_b32 v16, 31, v1
    v_and_b32 v17, 1, v2
    v_mul_u32_u24 v17, 64, v17
    v_add_u32 v17, v17, v16
    v_lshrrev_b32 v16, 1, v16
    v_and_b32 v16, 7, v16
    v_lshlrev_b32 v17, 7, v17
    v_add_u32 v18, 0, v3
    v_xor_b32 v18, v18, v16
    v_lshl_add_u32 v12, v18, 4, v17
    v_add_u32 v18, 2, v3
    v_xor_b32 v18, v18, v16
    v_lshl_add_u32 v13, v18, 4, v17
    v_add_u32 v18, 4, v3
    v_xor_b32 v18, v18, v16
    v_lshl_add_u32 v14, v18, 4, v17
    v_add_u32 v18, 6, v3
    v_xor_b32 v18, v18, v16
    v_lshl_add_u32 v15, v18, 4, v17
    v_lshrrev_b32 v17, 4, v1
    v_and_b32 v17, 1, v17
    v_lshlrev_b32 v17, 5, v17
    v_and_b32 v18, 15, v1
    v_lshrrev_b32 v18, 2, v18
    v_lshl_add_u32 v18, v3, 3, v18
    v_lshl_add_u32 v17, v18, 6, v17
    v_and_b32 v18, 3, v1
    v_lshl_add_u32 v17, v18, 3, v17
    v_lshrrev_b32 v18, 1, v2
    v_mul_u32_u24 v18, 4096, v18
    v_add3_u32 v16, v17, v18, 0
    v_add_u32 v16, 16384, v16
    v_mov_b32 v64, 0
    v_mov_b32 v65, 0
    v_mov_b32 v66, 0
    v_mov_b32 v67, 0
    v_mov_b32 v68, 0
    v_mov_b32 v69, 0
    v_mov_b32 v70, 0
    v_mov_b32 v71, 0
    v_mov_b32 v72, 0
    v_mov_b32 v73, 0
    v_mov_b32 v74, 0
    v_mov_b32 v75, 0
    v_mov_b32 v76, 0
    v_mov_b32 v77, 0
    v_mov_b32 v78, 0
    v_mov_b32 v79, 0
    v_mov_b32 v80, 0
    v_mov_b32 v81, 0
    v_mov_b32 v82, 0
    v_mov_b32 v83, 0
    v_mov_b32 v84, 0
    v_mov_b32 v85, 0
    v_mov_b32 v86, 0
    v_mov_b32 v87, 0
    v_mov_b32 v88, 0
    v_mov_b32 v89, 0
    v_mov_b32 v90, 0
    v_mov_b32 v91, 0
    v_mov_b32 v92, 0
    v_mov_b32 v93, 0
    v_mov_b32 v94, 0
    v_mov_b32 v95, 0
    v_mov_b32 v20, 0
    v_mov_b32 v21, 0
    v_mov_b32 v22, 0
    v_mov_b32 v23, 0
    v_mov_b32 v24, 0
    v_mov_b32 v25, 0
    v_mov_b32 v26, 0
    v_mov_b32 v27, 0
    s_mov_b32 s32, 0
    s_mov_b32 s33, 0
    v_readfirstlane_b32 s3, v2
    s_mul_i32 s3, s3, 4096
    s_add_u32 s3, s3, 0
    s_mov_b32 m0, s3
    s_nop 0
    buffer_load_dwordx4 v4, s[8:11], s32 offen lds
    v_readfirstlane_b32 s3, v2
    s_mul_i32 s3, s3, 4096
    s_add_u32 s3, s3, 1024
    s_mov_b32 m0, s3
    s_nop 0
    buffer_load_dwordx4 v5, s[8:11], s32 offen lds
    v_readfirstlane_b32 s3, v2
    s_mul_i32 s3, s3, 4096
    s_add_u32 s3, s3, 2048
    s_mov_b32 m0, s3
    s_nop 0
    buffer_load_dwordx4 v6, s[8:11], s32 offen lds
    v_readfirstlane_b32 s3, v2
    s_mul_i32 s3, s3, 4096
    s_add_u32 s3, s3, 3072
    s_mov_b32 m0, s3
    s_nop 0
    buffer_load_dwordx4 v7, s[8:11], s32 offen lds
    v_readfirstlane_b32 s3, v2
    s_lshl_b32 s3, s3, 10
    s_add_u32 s3, s3, 16384
    s_mov_b32 m0, s3
    s_nop 0
    buffer_load_dwordx4 v8, s[12:15], s33 offen lds
    v_readfirstlane_b32 s3, v2
    s_lshl_b32 s3, s3, 10
    s_add_u32 s3, s3, 20480
    s_mov_b32 m0, s3
    s_nop 0
    buffer_load_dwordx4 v9, s[12:15], s33 offen lds
    s_add_u32 s32, s32, 128
    s_mul_i32 s3, s38, 64
    s_add_u32 s33, s33, s3
    s_mov_b32 s48, 0
il_opA1_kernel_loop:
    s_waitcnt vmcnt(0)
    s_barrier
    s_add_u32 s3, s48, 0
    s_cmp_ge_u32 s3, 9
    s_cbranch_scc1 il_opA1_kernel_nopf0
    v_readfirstlane_b32 s3, v2
    s_mul_i32 s3, s3, 4096
    s_add_u32 s3, s3, 24576
    s_mov_b32 m0, s3
    s_nop 0
    buffer_load_dwordx4 v4, s[8:11], s32 offen lds
    v_readfirstlane_b32 s3, v2
    s_mul_i32 s3, s3, 4096
    s_add_u32 s3, s3, 25600
    s_mov_b32 m0, s3
    s_nop 0
    buffer_load_dwordx4 v5, s[8:11], s32 offen lds
    v_readfirstlane_b32 s3, v2
    s_mul_i32 s3, s3, 4096
    s_add_u32 s3, s3, 26624
    s_mov_b32 m0, s3
    s_nop 0
    buffer_load_dwordx4 v6, s[8:11], s32 offen lds
    v_readfirstlane_b32 s3, v2
    s_mul_i32 s3, s3, 4096
    s_add_u32 s3, s3, 27648
    s_mov_b32 m0, s3
    s_nop 0
    buffer_load_dwordx4 v7, s[8:11], s32 offen lds
    v_readfirstlane_b32 s3, v2
    s_lshl_b32 s3, s3, 10
    s_add_u32 s3, s3, 40960
    s_mov_b32 m0, s3
    s_nop 0
    buffer_load_dwordx4 v8, s[12:15], s33 offen lds
    v_readfirstlane_b32 s3, v2
    s_lshl_b32 s3, s3, 10
    s_add_u32 s3, s3, 45056
    s_mov_b32 m0, s3
    s_nop 0
    buffer_load_dwordx4 v9, s[12:15], s33 offen lds
    s_add_u32 s32, s32, 128
    s_mul_i32 s3, s38, 64
    s_add_u32 s33, s33, s3
il_opA1_kernel_nopf0:
    ds_read_b128 v[32:35], v12 offset:0
    ds_read_b128 v[36:39], v12 offset:4096
    ds_read_b64_tr_b16 v[40:41], v16 offset:0
    ds_read_b64_tr_b16 v[42:43], v16 offset:256
    s_waitcnt lgkmcnt(0)
    ds_read_b128 v[44:47], v13 offset:0
    ds_read_b128 v[48:51], v13 offset:4096
    ds_read_b64_tr_b16 v[52:53], v16 offset:1024
    ds_read_b64_tr_b16 v[54:55], v16 offset:1280
    v_mfma_f32_32x32x16_bf16 v[64:79], v[40:43], v[32:35], v[64:79]
    v_mfma_f32_32x32x16_bf16 v[80:95], v[40:43], v[36:39], v[80:95]
    s_waitcnt lgkmcnt(0)
    ds_read_b128 v[32:35], v14 offset:0
    ds_read_b128 v[36:39], v14 offset:4096
    ds_read_b64_tr_b16 v[40:41], v16 offset:2048
    ds_read_b64_tr_b16 v[42:43], v16 offset:2304
    v_mfma_f32_32x32x16_bf16 v[64:79], v[52:55], v[44:47], v[64:79]
    v_mfma_f32_32x32x16_bf16 v[80:95], v[52:55], v[48:51], v[80:95]
    s_waitcnt lgkmcnt(0)
    ds_read_b128 v[44:47], v15 offset:0
    ds_read_b128 v[48:51], v15 offset:4096
    ds_read_b64_tr_b16 v[52:53], v16 offset:3072
    ds_read_b64_tr_b16 v[54:55], v16 offset:3328
    v_mfma_f32_32x32x16_bf16 v[64:79], v[40:43], v[32:35], v[64:79]
    v_mfma_f32_32x32x16_bf16 v[80:95], v[40:43], v[36:39], v[80:95]
    s_waitcnt lgkmcnt(0)
    v_mfma_f32_32x32x16_bf16 v[64:79], v[52:55], v[44:47], v[64:79]
    v_mfma_f32_32x32x16_bf16 v[80:95], v[52:55], v[48:51], v[80:95]
    s_waitcnt vmcnt(0)
    s_barrier
    s_add_u32 s3, s48, 1
    s_cmp_ge_u32 s3, 9
    s_cbranch_scc1 il_opA1_kernel_nopf1
    v_readfirstlane_b32 s3, v2
    s_mul_i32 s3, s3, 4096
    s_add_u32 s3, s3, 0
    s_mov_b32 m0, s3
    s_nop 0
    buffer_load_dwordx4 v4, s[8:11], s32 offen lds
    v_readfirstlane_b32 s3, v2
    s_mul_i32 s3, s3, 4096
    s_add_u32 s3, s3, 1024
    s_mov_b32 m0, s3
    s_nop 0
    buffer_load_dwordx4 v5, s[8:11], s32 offen lds
    v_readfirstlane_b32 s3, v2
    s_mul_i32 s3, s3, 4096
    s_add_u32 s3, s3, 2048
    s_mov_b32 m0, s3
    s_nop 0
    buffer_load_dwordx4 v6, s[8:11], s32 offen lds
    v_readfirstlane_b32 s3, v2
    s_mul_i32 s3, s3, 4096
    s_add_u32 s3, s3, 3072
    s_mov_b32 m0, s3
    s_nop 0
    buffer_load_dwordx4 v7, s[8:11], s32 offen lds
    v_readfirstlane_b32 s3, v2
    s_lshl_b32 s3, s3, 10
    s_add_u32 s3, s3, 16384
    s_mov_b32 m0, s3
    s_nop 0
    buffer_load_dwordx4 v8, s[12:15], s33 offen lds
    v_readfirstlane_b32 s3, v2
    s_lshl_b32 s3, s3, 10
    s_add_u32 s3, s3, 20480
    s_mov_b32 m0, s3
    s_nop 0
    buffer_load_dwordx4 v9, s[12:15], s33 offen lds
    s_add_u32 s32, s32, 128
    s_mul_i32 s3, s38, 64
    s_add_u32 s33, s33, s3
il_opA1_kernel_nopf1:
    ds_read_b128 v[32:35], v12 offset:24576
    ds_read_b128 v[36:39], v12 offset:28672
    ds_read_b64_tr_b16 v[40:41], v16 offset:24576
    ds_read_b64_tr_b16 v[42:43], v16 offset:24832
    s_waitcnt lgkmcnt(0)
    ds_read_b128 v[44:47], v13 offset:24576
    ds_read_b128 v[48:51], v13 offset:28672
    ds_read_b64_tr_b16 v[52:53], v16 offset:25600
    ds_read_b64_tr_b16 v[54:55], v16 offset:25856
    v_mfma_f32_32x32x16_bf16 v[64:79], v[40:43], v[32:35], v[64:79]
    v_mfma_f32_32x32x16_bf16 v[80:95], v[40:43], v[36:39], v[80:95]
    s_waitcnt lgkmcnt(0)
    ds_read_b128 v[32:35], v14 offset:24576
    ds_read_b128 v[36:39], v14 offset:28672
    ds_read_b64_tr_b16 v[40:41], v16 offset:26624
    ds_read_b64_tr_b16 v[42:43], v16 offset:26880
    v_mfma_f32_32x32x16_bf16 v[64:79], v[52:55], v[44:47], v[64:79]
    v_mfma_f32_32x32x16_bf16 v[80:95], v[52:55], v[48:51], v[80:95]
    s_waitcnt lgkmcnt(0)
    ds_read_b128 v[44:47], v15 offset:24576
    ds_read_b128 v[48:51], v15 offset:28672
    ds_read_b64_tr_b16 v[52:53], v16 offset:27648
    ds_read_b64_tr_b16 v[54:55], v16 offset:27904
    v_mfma_f32_32x32x16_bf16 v[64:79], v[40:43], v[32:35], v[64:79]
    v_mfma_f32_32x32x16_bf16 v[80:95], v[40:43], v[36:39], v[80:95]
    s_waitcnt lgkmcnt(0)
    v_mfma_f32_32x32x16_bf16 v[64:79], v[52:55], v[44:47], v[64:79]
    v_mfma_f32_32x32x16_bf16 v[80:95], v[52:55], v[48:51], v[80:95]
    s_add_u32 s48, s48, 2
    s_cmp_lt_u32 s48, 10
    s_cbranch_scc1 il_opA1_kernel_loop
    s_nop 15
    s_nop 7
    v_and_b32 v4, 31, v1
    v_and_b32 v5, 1, v2
    v_mul_u32_u24 v5, 64, v5
    v_add3_u32 v4, v4, v5, s34
    v_lshrrev_b32 v5, 1, v2
    v_mul_u32_u24 v5, 32, v5
    v_lshl_add_u32 v5, v3, 2, v5
    v_add_u32 v5, s35, v5
    v_add_u32 v8, 0, v4
    v_add_u32 v9, 0, v5
    v_mul_u32_u24 v10, 1280, v8
    v_lshl_add_u32 v10, v9, 1, v10
    buffer_load_dwordx2 v[12:13], v10, s[24:27], 0 offen
    v_cvt_pk_bf16_f32 v14, v64, v65
    v_cvt_pk_bf16_f32 v15, v66, v67
    s_waitcnt vmcnt(0)
    v_lshlrev_b32 v16, 16, v14
    v_and_b32 v17, 0xffff0000, v14
    v_lshlrev_b32 v18, 16, v12
    v_and_b32 v19, 0xffff0000, v12
    v_add_f32 v16, v16, v18
    v_add_f32 v17, v17, v19
    v_cvt_pk_bf16_f32 v14, v16, v17
    v_lshlrev_b32 v16, 16, v15
    v_and_b32 v17, 0xffff0000, v15
    v_lshlrev_b32 v18, 16, v13
    v_and_b32 v19, 0xffff0000, v13
    v_add_f32 v16, v16, v18
    v_add_f32 v17, v17, v19
    v_cvt_pk_bf16_f32 v15, v16, v17
    buffer_store_dwordx2 v[14:15], v10, s[20:23], 0 offen
    v_add_u32 v9, 8, v5
    v_mul_u32_u24 v10, 1280, v8
    v_lshl_add_u32 v10, v9, 1, v10
    buffer_load_dwordx2 v[12:13], v10, s[24:27], 0 offen
    v_cvt_pk_bf16_f32 v14, v68, v69
    v_cvt_pk_bf16_f32 v15, v70, v71
    s_waitcnt vmcnt(0)
    v_lshlrev_b32 v16, 16, v14
    v_and_b32 v17, 0xffff0000, v14
    v_lshlrev_b32 v18, 16, v12
    v_and_b32 v19, 0xffff0000, v12
    v_add_f32 v16, v16, v18
    v_add_f32 v17, v17, v19
    v_cvt_pk_bf16_f32 v14, v16, v17
    v_lshlrev_b32 v16, 16, v15
    v_and_b32 v17, 0xffff0000, v15
    v_lshlrev_b32 v18, 16, v13
    v_and_b32 v19, 0xffff0000, v13
    v_add_f32 v16, v16, v18
    v_add_f32 v17, v17, v19
    v_cvt_pk_bf16_f32 v15, v16, v17
    buffer_store_dwordx2 v[14:15], v10, s[20:23], 0 offen
    v_add_u32 v9, 16, v5
    v_mul_u32_u24 v10, 1280, v8
    v_lshl_add_u32 v10, v9, 1, v10
    buffer_load_dwordx2 v[12:13], v10, s[24:27], 0 offen
    v_cvt_pk_bf16_f32 v14, v72, v73
    v_cvt_pk_bf16_f32 v15, v74, v75
    s_waitcnt vmcnt(0)
    v_lshlrev_b32 v16, 16, v14
    v_and_b32 v17, 0xffff0000, v14
    v_lshlrev_b32 v18, 16, v12
    v_and_b32 v19, 0xffff0000, v12
    v_add_f32 v16, v16, v18
    v_add_f32 v17, v17, v19
    v_cvt_pk_bf16_f32 v14, v16, v17
    v_lshlrev_b32 v16, 16, v15
    v_and_b32 v17, 0xffff0000, v15
    v_lshlrev_b32 v18, 16, v13
    v_and_b32 v19, 0xffff0000, v13
    v_add_f32 v16, v16, v18
    v_add_f32 v17, v17, v19
    v_cvt_pk_bf16_f32 v15, v16, v17
    buffer_store_dwordx2 v[14:15], v10, s[20:23], 0 offen
    v_add_u32 v9, 24, v5
    v_mul_u32_u24 v10, 1280, v8
    v_lshl_add_u32 v10, v9, 1, v10
    buffer_load_dwordx2 v[12:13], v10, s[24:27], 0 offen
    v_cvt_pk_bf16_f32 v14, v76, v77
    v_cvt_pk_bf16_f32 v15, v78, v79
    s_waitcnt vmcnt(0)
    v_lshlrev_b32 v16, 16, v14
    v_and_b32 v17, 0xffff0000, v14
    v_lshlrev_b32 v18, 16, v12
    v_and_b32 v19, 0xffff0000, v12
    v_add_f32 v16, v16, v18
    v_add_f32 v17, v17, v19
    v_cvt_pk_bf16_f32 v14, v16, v17
    v_lshlrev_b32 v16, 16, v15
    v_and_b32 v17, 0xffff0000, v15
    v_lshlrev_b32 v18, 16, v13
    v_and_b32 v19, 0xffff0000, v13
    v_add_f32 v16, v16, v18
    v_add_f32 v17, v17, v19
    v_cvt_pk_bf16_f32 v15, v16, v17
    buffer_store_dwordx2 v[14:15], v10, s[20:23], 0 offen
    v_add_u32 v8, 32, v4
    v_add_u32 v9, 0, v5
    v_mul_u32_u24 v10, 1280, v8
    v_lshl_add_u32 v10, v9, 1, v10
    buffer_load_dwordx2 v[12:13], v10, s[24:27], 0 offen
    v_cvt_pk_bf16_f32 v14, v80, v81
    v_cvt_pk_bf16_f32 v15, v82, v83
    s_waitcnt vmcnt(0)
    v_lshlrev_b32 v16, 16, v14
    v_and_b32 v17, 0xffff0000, v14
    v_lshlrev_b32 v18, 16, v12
    v_and_b32 v19, 0xffff0000, v12
    v_add_f32 v16, v16, v18
    v_add_f32 v17, v17, v19
    v_cvt_pk_bf16_f32 v14, v16, v17
    v_lshlrev_b32 v16, 16, v15
    v_and_b32 v17, 0xffff0000, v15
    v_lshlrev_b32 v18, 16, v13
    v_and_b32 v19, 0xffff0000, v13
    v_add_f32 v16, v16, v18
    v_add_f32 v17, v17, v19
    v_cvt_pk_bf16_f32 v15, v16, v17
    buffer_store_dwordx2 v[14:15], v10, s[20:23], 0 offen
    v_add_u32 v9, 8, v5
    v_mul_u32_u24 v10, 1280, v8
    v_lshl_add_u32 v10, v9, 1, v10
    buffer_load_dwordx2 v[12:13], v10, s[24:27], 0 offen
    v_cvt_pk_bf16_f32 v14, v84, v85
    v_cvt_pk_bf16_f32 v15, v86, v87
    s_waitcnt vmcnt(0)
    v_lshlrev_b32 v16, 16, v14
    v_and_b32 v17, 0xffff0000, v14
    v_lshlrev_b32 v18, 16, v12
    v_and_b32 v19, 0xffff0000, v12
    v_add_f32 v16, v16, v18
    v_add_f32 v17, v17, v19
    v_cvt_pk_bf16_f32 v14, v16, v17
    v_lshlrev_b32 v16, 16, v15
    v_and_b32 v17, 0xffff0000, v15
    v_lshlrev_b32 v18, 16, v13
    v_and_b32 v19, 0xffff0000, v13
    v_add_f32 v16, v16, v18
    v_add_f32 v17, v17, v19
    v_cvt_pk_bf16_f32 v15, v16, v17
    buffer_store_dwordx2 v[14:15], v10, s[20:23], 0 offen
    v_add_u32 v9, 16, v5
    v_mul_u32_u24 v10, 1280, v8
    v_lshl_add_u32 v10, v9, 1, v10
    buffer_load_dwordx2 v[12:13], v10, s[24:27], 0 offen
    v_cvt_pk_bf16_f32 v14, v88, v89
    v_cvt_pk_bf16_f32 v15, v90, v91
    s_waitcnt vmcnt(0)
    v_lshlrev_b32 v16, 16, v14
    v_and_b32 v17, 0xffff0000, v14
    v_lshlrev_b32 v18, 16, v12
    v_and_b32 v19, 0xffff0000, v12
    v_add_f32 v16, v16, v18
    v_add_f32 v17, v17, v19
    v_cvt_pk_bf16_f32 v14, v16, v17
    v_lshlrev_b32 v16, 16, v15
    v_and_b32 v17, 0xffff0000, v15
    v_lshlrev_b32 v18, 16, v13
    v_and_b32 v19, 0xffff0000, v13
    v_add_f32 v16, v16, v18
    v_add_f32 v17, v17, v19
    v_cvt_pk_bf16_f32 v15, v16, v17
    buffer_store_dwordx2 v[14:15], v10, s[20:23], 0 offen
    v_add_u32 v9, 24, v5
    v_mul_u32_u24 v10, 1280, v8
    v_lshl_add_u32 v10, v9, 1, v10
    buffer_load_dwordx2 v[12:13], v10, s[24:27], 0 offen
    v_cvt_pk_bf16_f32 v14, v92, v93
    v_cvt_pk_bf16_f32 v15, v94, v95
    s_waitcnt vmcnt(0)
    v_lshlrev_b32 v16, 16, v14
    v_and_b32 v17, 0xffff0000, v14
    v_lshlrev_b32 v18, 16, v12
    v_and_b32 v19, 0xffff0000, v12
    v_add_f32 v16, v16, v18
    v_add_f32 v17, v17, v19
    v_cvt_pk_bf16_f32 v14, v16, v17
    v_lshlrev_b32 v16, 16, v15
    v_and_b32 v17, 0xffff0000, v15
    v_lshlrev_b32 v18, 16, v13
    v_and_b32 v19, 0xffff0000, v13
    v_add_f32 v16, v16, v18
    v_add_f32 v17, v17, v19
    v_cvt_pk_bf16_f32 v15, v16, v17
    buffer_store_dwordx2 v[14:15], v10, s[20:23], 0 offen
    s_waitcnt vmcnt(0)
il_opA1_kernel_done:
    s_endpgm
.globl il_qkvB1_kernel
.p2align 8
.type il_qkvB1_kernel,@function
il_qkvB1_kernel:
    s_cmp_ge_u32 s2, 240
    s_cbranch_scc1 il_qkvB1_kernel_done
    s_load_dwordx2 s[4:5], s[0:1], 80
    s_load_dwordx2 s[12:13], s[0:1], 48
    s_and_b32 s34, s2, 15
    s_lshr_b32 s35, s2, 4
    s_mov_b32 s37, s35
    s_mul_i32 s34, s34, 128
    s_mul_i32 s35, s35, 128
    v_and_b32 v1, 63, v0
    v_lshrrev_b32 v2, 6, v0
    v_lshrrev_b32 v3, 5, v1
    s_waitcnt lgkmcnt(0)
    s_add_u32 s8, s4, 5242880
    s_addc_u32 s9, s5, 0
    s_mov_b32 s10, 2621440
    s_mov_b32 s11, 0x00020000
    s_mov_b32 s14, 2457600
    s_mov_b32 s15, 0x00020000
    s_add_u32 s20, s4, 7864320
    s_addc_u32 s21, s5, 0
    s_mov_b32 s22, 2621440
    s_mov_b32 s23, 0x00020000
    s_add_u32 s24, s4, 13107200
    s_addc_u32 s25, s5, 0
    s_mov_b32 s26, 4194304
    s_mov_b32 s27, 0x00020000
    s_add_u32 s28, s4, 17301504
    s_addc_u32 s29, s5, 0
    s_mov_b32 s30, 4194304
    s_mov_b32 s31, 0x00020000
    s_mov_b32 s36, 0x3f803f80
    v_lshrrev_b32 v17, 3, v1
    v_mul_u32_u24 v18, 32, v2
    v_add_u32 v18, v18, v17
    v_and_b32 v19, 7, v1
    v_lshrrev_b32 v16, 1, v17
    v_xor_b32 v16, v16, v19
    v_lshlrev_b32 v16, 4, v16
    v_add_u32 v4, s34, v18
    v_add_u32 v4, 0, v4
    s_mov_b32 s3, 1280
    v_mul_lo_u32 v4, v4, s3
    v_add_u32 v4, v4, v16
    v_lshrrev_b32 v16, 1, v17
    v_xor_b32 v16, 4, v16
    v_xor_b32 v16, v16, v19
    v_lshlrev_b32 v16, 4, v16
    v_add_u32 v5, s34, v18
    v_add_u32 v5, 8, v5
    s_mov_b32 s3, 1280
    v_mul_lo_u32 v5, v5, s3
    v_add_u32 v5, v5, v16
    v_lshrrev_b32 v16, 1, v17
    v_xor_b32 v16, v16, v19
    v_lshlrev_b32 v16, 4, v16
    v_add_u32 v6, s34, v18
    v_add_u32 v6, 16, v6
    s_mov_b32 s3, 1280
    v_mul_lo_u32 v6, v6, s3
    v_add_u32 v6, v6, v16
    v_lshrrev_b32 v16, 1, v17
    v_xor_b32 v16, 4, v16
    v_xor_b32 v16, v16, v19
    v_lshlrev_b32 v16, 4, v16
    v_add_u32 v7, s34, v18
    v_add_u32 v7, 24, v7
    s_mov_b32 s3, 1280
    v_mul_lo_u32 v7, v7, s3
    v_add_u32 v7, v7, v16
    v_lshrrev_b32 v16, 2, v1
    v_lshl_add_u32 v16, v2, 4, v16
    v_and_b32 v17, 3, v1
    v_lshlrev_b32 v17, 4, v17
    s_mov_b32 s38, 3840
    s_mov_b32 s39, s35
    v_mul_lo_u32 v16, v16, s38
    v_add_u32 v16, v16, v17
    s_lshl_b32 s3, s39, 1
    v_add_u32 v8, s3, v16
    v_add_u32 v9, 64, v8
    v_add_u32 v10, 128, v8
    v_add_u32 v11, 192, v8
    v_and_b32 v16, 31, v1
    v_and_b32 v17, 1, v2
    v_mul_u32_u24 v17, 64, v17
    v_add_u32 v17, v17, v16
    v_lshrrev_b32 v16, 1, v16
    v_and_b32 v16, 7, v16
    v_lshlrev_b32 v17, 7, v17
    v_add_u32 v18, 0, v3
    v_xor_b32 v18, v18, v16
    v_lshl_add_u32 v12, v18, 4, v17
    v_add_u32 v18, 2, v3
    v_xor_b32 v18, v18, v16
    v_lshl_add_u32 v13, v18, 4, v17
    v_add_u32 v18, 4, v3
    v_xor_b32 v18, v18, v16
    v_lshl_add_u32 v14, v18, 4, v17
    v_add_u32 v18, 6, v3
    v_xor_b32 v18, v18, v16
    v_lshl_add_u32 v15, v18, 4, v17
    v_lshrrev_b32 v17, 4, v1
    v_and_b32 v17, 1, v17
    v_lshlrev_b32 v17, 5, v17
    v_and_b32 v18, 15, v1
    v_lshrrev_b32 v18, 2, v18
    v_lshl_add_u32 v18, v3, 3, v18
    v_lshl_add_u32 v17, v18, 6, v17
    v_and_b32 v18, 3, v1
    v_lshl_add_u32 v17, v18, 3, v17
    v_lshrrev_b32 v18, 1, v2
    v_mul_u32_u24 v18, 8192, v18
    v_add3_u32 v16, v17, v18, 0
    v_add_u32 v16, 16384, v16
    v_mov_b32 v64, 0
    v_mov_b32 v65, 0
    v_mov_b32 v66, 0
    v_mov_b32 v67, 0
    v_mov_b32 v68, 0
    v_mov_b32 v69, 0
    v_mov_b32 v70, 0
    v_mov_b32 v71, 0
    v_mov_b32 v72, 0
    v_mov_b32 v73, 0
    v_mov_b32 v74, 0
    v_mov_b32 v75, 0
    v_mov_b32 v76, 0
    v_mov_b32 v77, 0
    v_mov_b32 v78, 0
    v_mov_b32 v79, 0
    v_mov_b32 v80, 0
    v_mov_b32 v81, 0
    v_mov_b32 v82, 0
    v_mov_b32 v83, 0
    v_mov_b32 v84, 0
    v_mov_b32 v85, 0
    v_mov_b32 v86, 0
    v_mov_b32 v87, 0
    v_mov_b32 v88, 0
    v_mov_b32 v89, 0
    v_mov_b32 v90, 0
    v_mov_b32 v91, 0
    v_mov_b32 v92, 0
    v_mov_b32 v93, 0
    v_mov_b32 v94, 0
    v_mov_b32 v95, 0
    v_mov_b32 v96, 0
    v_mov_b32 v97, 0
    v_mov_b32 v98, 0
    v_mov_b32 v99, 0
    v_mov_b32 v100, 0
    v_mov_b32 v101, 0
    v_mov_b32 v102, 0
    v_mov_b32 v103, 0
    v_mov_b32 v104, 0
    v_mov_b32 v105, 0
    v_mov_b32 v106, 0
    v_mov_b32 v107, 0
    v_mov_b32 v108, 0
    v_mov_b32 v109, 0
    v_mov_b32 v110, 0
    v_mov_b32 v111, 0
    v_mov_b32 v112, 0
    v_mov_b32 v113, 0
    v_mov_b32 v114, 0
    v_mov_b32 v115, 0
    v_mov_b32 v116, 0
    v_mov_b32 v117, 0
    v_mov_b32 v118, 0
    v_mov_b32 v119, 0
    v_mov_b32 v120, 0
    v_mov_b32 v121, 0
    v_mov_b32 v122, 0
    v_mov_b32 v123, 0
    v_mov_b32 v124, 0
    v_mov_b32 v125, 0
    v_mov_b32 v126, 0
    v_mov_b32 v127, 0
    v_mov_b32 v20, 0
    v_mov_b32 v21, 0
    v_mov_b32 v22, 0
    v_mov_b32 v23, 0
    v_mov_b32 v24, 0
    v_mov_b32 v25, 0
    v_mov_b32 v26, 0
    v_mov_b32 v27, 0
    s_mov_b32 s32, 0
    s_mov_b32 s33, 0
    v_readfirstlane_b32 s3, v2
    s_mul_i32 s3, s3, 4096
    s_add_u32 s3, s3, 0
    s_mov_b32 m0, s3
    s_nop 0
    buffer_load_dwordx4 v4, s[8:11], s32 offen lds
    v_readfirstlane_b32 s3, v2
    s_mul_i32 s3, s3, 4096
    s_add_u32 s3, s3, 1024
    s_mov_b32 m0, s3
    s_nop 0
    buffer_load_dwordx4 v5, s[8:11], s32 offen lds
    v_readfirstlane_b32 s3, v2
    s_mul_i32 s3, s3, 4096
    s_add_u32 s3, s3, 2048
    s_mov_b32 m0, s3
    s_nop 0
    buffer_load_dwordx4 v6, s[8:11], s32 offen lds
    v_readfirstlane_b32 s3, v2
    s_mul_i32 s3, s3, 4096
    s_add_u32 s3, s3, 3072
    s_mov_b32 m0, s3
    s_nop 0
    buffer_load_dwordx4 v7, s[8:11], s32 offen lds
    v_readfirstlane_b32 s3, v2
    s_lshl_b32 s3, s3, 10
    s_add_u32 s3, s3, 16384
    s_mov_b32 m0, s3
    s_nop 0
    buffer_load_dwordx4 v8, s[12:15], s33 offen lds
    v_readfirstlane_b32 s3, v2
    s_lshl_b32 s3, s3, 10
    s_add_u32 s3, s3, 20480
    s_mov_b32 m0, s3
    s_nop 0
    buffer_load_dwordx4 v9, s[12:15], s33 offen lds
    v_readfirstlane_b32 s3, v2
    s_lshl_b32 s3, s3, 10
    s_add_u32 s3, s3, 24576
    s_mov_b32 m0, s3
    s_nop 0
    buffer_load_dwordx4 v10, s[12:15], s33 offen lds
    v_readfirstlane_b32 s3, v2
    s_lshl_b32 s3, s3, 10
    s_add_u32 s3, s3, 28672
    s_mov_b32 m0, s3
    s_nop 0
    buffer_load_dwordx4 v11, s[12:15], s33 offen lds
    s_add_u32 s32, s32, 128
    s_mul_i32 s3, s38, 64
    s_add_u32 s33, s33, s3
    s_mov_b32 s48, 0
il_qkvB1_kernel_loop:
    s_waitcnt vmcnt(0)
    s_barrier
    s_add_u32 s3, s48, 0
    s_cmp_ge_u32 s3, 9
    s_cbranch_scc1 il_qkvB1_kernel_nopf0
    v_readfirstlane_b32 s3, v2
    s_mul_i32 s3, s3, 4096
    s_add_u32 s3, s3, 32768
    s_mov_b32 m0, s3
    s_nop 0
    buffer_load_dwordx4 v4, s[8:11], s32 offen lds
    v_readfirstlane_b32 s3, v2
    s_mul_i32 s3, s3, 4096
    s_add_u32 s3, s3, 33792
    s_mov_b32 m0, s3
    s_nop 0
    buffer_load_dwordx4 v5, s[8:11], s32 offen lds
    v_readfirstlane_b32 s3, v2
    s_mul_i32 s3, s3, 4096
    s_add_u32 s3, s3, 34816
    s_mov_b32 m0, s3
    s_nop 0
    buffer_load_dwordx4 v6, s[8:11], s32 offen lds
    v_readfirstlane_b32 s3, v2
    s_mul_i32 s3, s3, 4096
    s_add_u32 s3, s3, 35840
    s_mov_b32 m0, s3
    s_nop 0
    buffer_load_dwordx4 v7, s[8:11], s32 offen lds
    v_readfirstlane_b32 s3, v2
    s_lshl_b32 s3, s3, 10
    s_add_u32 s3, s3, 49152
    s_mov_b32 m0, s3
    s_nop 0
    buffer_load_dwordx4 v8, s[12:15], s33 offen lds
    v_readfirstlane_b32 s3, v2
    s_lshl_b32 s3, s3, 10
    s_add_u32 s3, s3, 53248
    s_mov_b32 m0, s3
    s_nop 0
    buffer_load_dwordx4 v9, s[12:15], s33 offen lds
    v_readfirstlane_b32 s3, v2
    s_lshl_b32 s3, s3, 10
    s_add_u32 s3, s3, 57344
    s_mov_b32 m0, s3
    s_nop 0
    buffer_load_dwordx4 v10, s[12:15], s33 offen lds
    v_readfirstlane_b32 s3, v2
    s_lshl_b32 s3, s3, 10
    s_add_u32 s3, s3, 61440
    s_mov_b32 m0, s3
    s_nop 0
    buffer_load_dwordx4 v11, s[12:15], s33 offen lds
    s_add_u32 s32, s32, 128
    s_mul_i32 s3, s38, 64
    s_add_u32 s33, s33, s3
il_qkvB1_kernel_nopf0:
    ds_read_b128 v[32:35], v12 offset:0
    ds_read_b128 v[36:39], v12 offset:4096
    ds_read_b64_tr_b16 v[40:41], v16 offset:0
    ds_read_b64_tr_b16 v[42:43], v16 offset:256
    ds_read_b64_tr_b16 v[44:45], v16 offset:4096
    ds_read_b64_tr_b16 v[46:47], v16 offset:4352
    s_waitcnt lgkmcnt(0)
    ds_read_b128 v[48:51], v13 offset:0
    ds_read_b128 v[52:55], v13 offset:4096
    ds_read_b64_tr_b16 v[56:57], v16 offset:1024
    ds_read_b64_tr_b16 v[58:59], v16 offset:1280
    ds_read_b64_tr_b16 v[60:61], v16 offset:5120
    ds_read_b64_tr_b16 v[62:63], v16 offset:5376
    v_mfma_f32_32x32x16_bf16 v[64:79], v[40:43], v[32:35], v[64:79]
    v_mfma_f32_32x32x16_bf16 v[80:95], v[40:43], v[36:39], v[80:95]
    v_mfma_f32_32x32x16_bf16 v[96:111], v[44:47], v[32:35], v[96:111]
    v_mfma_f32_32x32x16_bf16 v[112:127], v[44:47], v[36:39], v[112:127]
    v_dot2_f32_bf16 v22, v32, v32, v22
    v_dot2_f32_bf16 v20, v32, s36, v20
    v_dot2_f32_bf16 v22, v33, v33, v22
    v_dot2_f32_bf16 v20, v33, s36, v20
    v_dot2_f32_bf16 v22, v34, v34, v22
    v_dot2_f32_bf16 v20, v34, s36, v20
    v_dot2_f32_bf16 v22, v35, v35, v22
    v_dot2_f32_bf16 v20, v35, s36, v20
    v_dot2_f32_bf16 v23, v36, v36, v23
    v_dot2_f32_bf16 v21, v36, s36, v21
    v_dot2_f32_bf16 v23, v37, v37, v23
    v_dot2_f32_bf16 v21, v37, s36, v21
    v_dot2_f32_bf16 v23, v38, v38, v23
    v_dot2_f32_bf16 v21, v38, s36, v21
    v_dot2_f32_bf16 v23, v39, v39, v23
    v_dot2_f32_bf16 v21, v39, s36, v21
    v_dot2_f32_bf16 v24, v40, s36, v24
    v_dot2_f32_bf16 v24, v41, s36, v24
    v_dot2_f32_bf16 v24, v42, s36, v24
    v_dot2_f32_bf16 v24, v43, s36, v24
    v_dot2_f32_bf16 v25, v44, s36, v25
    v_dot2_f32_bf16 v25, v45, s36, v25
    v_dot2_f32_bf16 v25, v46, s36, v25
    v_dot2_f32_bf16 v25, v47, s36, v25
    s_waitcnt lgkmcnt(0)
    ds_read_b128 v[32:35], v14 offset:0
    ds_read_b128 v[36:39], v14 offset:4096
    ds_read_b64_tr_b16 v[40:41], v16 offset:2048
    ds_read_b64_tr_b16 v[42:43], v16 offset:2304
    ds_read_b64_tr_b16 v[44:45], v16 offset:6144
    ds_read_b64_tr_b16 v[46:47], v16 offset:6400
    v_mfma_f32_32x32x16_bf16 v[64:79], v[56:59], v[48:51], v[64:79]
    v_mfma_f32_32x32x16_bf16 v[80:95], v[56:59], v[52:55], v[80:95]
    v_mfma_f32_32x32x16_bf16 v[96:111], v[60:63], v[48:51], v[96:111]
    v_mfma_f32_32x32x16_bf16 v[112:127], v[60:63], v[52:55], v[112:127]
    v_dot2_f32_bf16 v22, v48, v48, v22
    v_dot2_f32_bf16 v20, v48, s36, v20
    v_dot2_f32_bf16 v22, v49, v49, v22
    v_dot2_f32_bf16 v20, v49, s36, v20
    v_dot2_f32_bf16 v22, v50, v50, v22
    v_dot2_f32_bf16 v20, v50, s36, v20
    v_dot2_f32_bf16 v22, v51, v51, v22
    v_dot2_f32_bf16 v20, v51, s36, v20
    v_dot2_f32_bf16 v23, v52, v52, v23
    v_dot2_f32_bf16 v21, v52, s36, v21
    v_dot2_f32_bf16 v23, v53, v53, v23
    v_dot2_f32_bf16 v21, v53, s36, v21
    v_dot2_f32_bf16 v23, v54, v54, v23
    v_dot2_f32_bf16 v21, v54, s36, v21
    v_dot2_f32_bf16 v23, v55, v55, v23
    v_dot2_f32_bf16 v21, v55, s36, v21
    v_dot2_f32_bf16 v24, v56, s36, v24
    v_dot2_f32_bf16 v24, v57, s36, v24
    v_dot2_f32_bf16 v24, v58, s36, v24
    v_dot2_f32_bf16 v24, v59, s36, v24
    v_dot2_f32_bf16 v25, v60, s36, v25
    v_dot2_f32_bf16 v25, v61, s36, v25
    v_dot2_f32_bf16 v25, v62, s36, v25
    v_dot2_f32_bf16 v25, v63, s36, v25
    s_waitcnt lgkmcnt(0)
    ds_read_b128 v[48:51], v15 offset:0
    ds_read_b128 v[52:55], v15 offset:4096
    ds_read_b64_tr_b16 v[56:57], v16 offset:3072
    ds_read_b64_tr_b16 v[58:59], v16 offset:3328
    ds_read_b64_tr_b16 v[60:61], v16 offset:7168
    ds_read_b64_tr_b16 v[62:63], v16 offset:7424
    v_mfma_f32_32x32x16_bf16 v[64:79], v[40:43], v[32:35], v[64:79]
    v_mfma_f32_32x32x16_bf16 v[80:95], v[40:43], v[36:39], v[80:95]
    v_mfma_f32_32x32x16_bf16 v[96:111], v[44:47], v[32:35], v[96:111]
    v_mfma_f32_32x32x16_bf16 v[112:127], v[44:47], v[36:39], v[112:127]
    v_dot2_f32_bf16 v22, v32, v32, v22
    v_dot2_f32_bf16 v20, v32, s36, v20
    v_dot2_f32_bf16 v22, v33, v33, v22
    v_dot2_f32_bf16 v20, v33, s36, v20
    v_dot2_f32_bf16 v22, v34, v34, v22
    v_dot2_f32_bf16 v20, v34, s36, v20
    v_dot2_f32_bf16 v22, v35, v35, v22
    v_dot2_f32_bf16 v20, v35, s36, v20
    v_dot2_f32_bf16 v23, v36, v36, v23
    v_dot2_f32_bf16 v21, v36, s36, v21
    v_dot2_f32_bf16 v23, v37, v37, v23
    v_dot2_f32_bf16 v21, v37, s36, v21
    v_dot2_f32_bf16 v23, v38, v38, v23
    v_dot2_f32_bf16 v21, v38, s36, v21
    v_dot2_f32_bf16 v23, v39, v39, v23
    v_dot2_f32_bf16 v21, v39, s36, v21
    v_dot2_f32_bf16 v24, v40, s36, v24
    v_dot2_f32_bf16 v24, v41, s36, v24
    v_dot2_f32_bf16 v24, v42, s36, v24
    v_dot2_f32_bf16 v24, v43, s36, v24
    v_dot2_f32_bf16 v25, v44, s36, v25
    v_dot2_f32_bf16 v25, v45, s36, v25
    v_dot2_f32_bf16 v25, v46, s36, v25
    v_dot2_f32_bf16 v25, v47, s36, v25
    s_waitcnt lgkmcnt(0)
    v_mfma_f32_32x32x16_bf16 v[64:79], v[56:59], v[48:51], v[64:79]
    v_mfma_f32_32x32x16_bf16 v[80:95], v[56:59], v[52:55], v[80:95]
    v_mfma_f32_32x32x16_bf16 v[96:111], v[60:63], v[48:51], v[96:111]
    v_mfma_f32_32x32x16_bf16 v[112:127], v[60:63], v[52:55], v[112:127]
    v_dot2_f32_bf16 v22, v48, v48, v22
    v_dot2_f32_bf16 v20, v48, s36, v20
    v_dot2_f32_bf16 v22, v49, v49, v22
    v_dot2_f32_bf16 v20, v49, s36, v20
    v_dot2_f32_bf16 v22, v50, v50, v22
    v_dot2_f32_bf16 v20, v50, s36, v20
    v_dot2_f32_bf16 v22, v51, v51, v22
    v_dot2_f32_bf16 v20, v51, s36, v20
    v_dot2_f32_bf16 v23, v52, v52, v23
    v_dot2_f32_bf16 v21, v52, s36, v21
    v_dot2_f32_bf16 v23, v53, v53, v23
    v_dot2_f32_bf16 v21, v53, s36, v21
    v_dot2_f32_bf16 v23, v54, v54, v23
    v_dot2_f32_bf16 v21, v54, s36, v21
    v_dot2_f32_bf16 v23, v55, v55, v23
    v_dot2_f32_bf16 v21, v55, s36, v21
    v_dot2_f32_bf16 v24, v56, s36, v24
    v_dot2_f32_bf16 v24, v57, s36, v24
    v_dot2_f32_bf16 v24, v58, s36, v24
    v_dot2_f32_bf16 v24, v59, s36, v24
    v_dot2_f32_bf16 v25, v60, s36, v25
    v_dot2_f32_bf16 v25, v61, s36, v25
    v_dot2_f32_bf16 v25, v62, s36, v25
    v_dot2_f32_bf16 v25, v63, s36, v25
    s_waitcnt vmcnt(0)
    s_barrier
    s_add_u32 s3, s48, 1
    s_cmp_ge_u32 s3, 9
    s_cbranch_scc1 il_qkvB1_kernel_nopf1
    v_readfirstlane_b32 s3, v2
    s_mul_i32 s3, s3, 4096
    s_add_u32 s3, s3, 0
    s_mov_b32 m0, s3
    s_nop 0
    buffer_load_dwordx4 v4, s[8:11], s32 offen lds
    v_readfirstlane_b32 s3, v2
    s_mul_i32 s3, s3, 4096
    s_add_u32 s3, s3, 1024
    s_mov_b32 m0, s3
    s_nop 0
    buffer_load_dwordx4 v5, s[8:11], s32 offen lds
    v_readfirstlane_b32 s3, v2
    s_mul_i32 s3, s3, 4096
    s_add_u32 s3, s3, 2048
    s_mov_b32 m0, s3
    s_nop 0
    buffer_load_dwordx4 v6, s[8:11], s32 offen lds
    v_readfirstlane_b32 s3, v2
    s_mul_i32 s3, s3, 4096
    s_add_u32 s3, s3, 3072
    s_mov_b32 m0, s3
    s_nop 0
    buffer_load_dwordx4 v7, s[8:11], s32 offen lds
    v_readfirstlane_b32 s3, v2
    s_lshl_b32 s3, s3, 10
    s_add_u32 s3, s3, 16384
    s_mov_b32 m0, s3
    s_nop 0
    buffer_load_dwordx4 v8, s[12:15], s33 offen lds
    v_readfirstlane_b32 s3, v2
    s_lshl_b32 s3, s3, 10
    s_add_u32 s3, s3, 20480
    s_mov_b32 m0, s3
    s_nop 0
    buffer_load_dwordx4 v9, s[12:15], s33 offen lds
    v_readfirstlane_b32 s3, v2
    s_lshl_b32 s3, s3, 10
    s_add_u32 s3, s3, 24576
    s_mov_b32 m0, s3
    s_nop 0
    buffer_load_dwordx4 v10, s[12:15], s33 offen lds
    v_readfirstlane_b32 s3, v2
    s_lshl_b32 s3, s3, 10
    s_add_u32 s3, s3, 28672
    s_mov_b32 m0, s3
    s_nop 0
    buffer_load_dwordx4 v11, s[12:15], s33 offen lds
    s_add_u32 s32, s32, 128
    s_mul_i32 s3, s38, 64
    s_add_u32 s33, s33, s3
il_qkvB1_kernel_nopf1:
    ds_read_b128 v[32:35], v12 offset:32768
    ds_read_b128 v[36:39], v12 offset:36864
    ds_read_b64_tr_b16 v[40:41], v16 offset:32768
    ds_read_b64_tr_b16 v[42:43], v16 offset:33024
    ds_read_b64_tr_b16 v[44:45], v16 offset:36864
    ds_read_b64_tr_b16 v[46:47], v16 offset:37120
    s_waitcnt lgkmcnt(0)
    ds_read_b128 v[48:51], v13 offset:32768
    ds_read_b128 v[52:55], v13 offset:36864
    ds_read_b64_tr_b16 v[56:57], v16 offset:33792
    ds_read_b64_tr_b16 v[58:59], v16 offset:34048
    ds_read_b64_tr_b16 v[60:61], v16 offset:37888
    ds_read_b64_tr_b16 v[62:63], v16 offset:38144
    v_mfma_f32_32x32x16_bf16 v[64:79], v[40:43], v[32:35], v[64:79]
    v_mfma_f32_32x32x16_bf16 v[80:95], v[40:43], v[36:39], v[80:95]
    v_mfma_f32_32x32x16_bf16 v[96:111], v[44:47], v[32:35], v[96:111]
    v_mfma_f32_32x32x16_bf16 v[112:127], v[44:47], v[36:39], v[112:127]
    v_dot2_f32_bf16 v22, v32, v32, v22
    v_dot2_f32_bf16 v20, v32, s36, v20
    v_dot2_f32_bf16 v22, v33, v33, v22
    v_dot2_f32_bf16 v20, v33, s36, v20
    v_dot2_f32_bf16 v22, v34, v34, v22
    v_dot2_f32_bf16 v20, v34, s36, v20
    v_dot2_f32_bf16 v22, v35, v35, v22
    v_dot2_f32_bf16 v20, v35, s36, v20
    v_dot2_f32_bf16 v23, v36, v36, v23
    v_dot2_f32_bf16 v21, v36, s36, v21
    v_dot2_f32_bf16 v23, v37, v37, v23
    v_dot2_f32_bf16 v21, v37, s36, v21
    v_dot2_f32_bf16 v23, v38, v38, v23
    v_dot2_f32_bf16 v21, v38, s36, v21
    v_dot2_f32_bf16 v23, v39, v39, v23
    v_dot2_f32_bf16 v21, v39, s36, v21
    v_dot2_f32_bf16 v24, v40, s36, v24
    v_dot2_f32_bf16 v24, v41, s36, v24
    v_dot2_f32_bf16 v24, v42, s36, v24
    v_dot2_f32_bf16 v24, v43, s36, v24
    v_dot2_f32_bf16 v25, v44, s36, v25
    v_dot2_f32_bf16 v25, v45, s36, v25
    v_dot2_f32_bf16 v25, v46, s36, v25
    v_dot2_f32_bf16 v25, v47, s36, v25
    s_waitcnt lgkmcnt(0)
    ds_read_b128 v[32:35], v14 offset:32768
    ds_read_b128 v[36:39], v14 offset:36864
    ds_read_b64_tr_b16 v[40:41], v16 offset:34816
    ds_read_b64_tr_b16 v[42:43], v16 offset:35072
    ds_read_b64_tr_b16 v[44:45], v16 offset:38912
    ds_read_b64_tr_b16 v[46:47], v16 offset:39168
    v_mfma_f32_32x32x16_bf16 v[64:79], v[56:59], v[48:51], v[64:79]
    v_mfma_f32_32x32x16_bf16 v[80:95], v[56:59], v[52:55], v[80:95]
    v_mfma_f32_32x32x16_bf16 v[96:111], v[60:63], v[48:51], v[96:111]
    v_mfma_f32_32x32x16_bf16 v[112:127], v[60:63], v[52:55], v[112:127]
    v_dot2_f32_bf16 v22, v48, v48, v22
    v_dot2_f32_bf16 v20, v48, s36, v20
    v_dot2_f32_bf16 v22, v49, v49, v22
    v_dot2_f32_bf16 v20, v49, s36, v20
    v_dot2_f32_bf16 v22, v50, v50, v22
    v_dot2_f32_bf16 v20, v50, s36, v20
    v_dot2_f32_bf16 v22, v51, v51, v22
    v_dot2_f32_bf16 v20, v51, s36, v20
    v_dot2_f32_bf16 v23, v52, v52, v23
    v_dot2_f32_bf16 v21, v52, s36, v21
    v_dot2_f32_bf16 v23, v53, v53, v23
    v_dot2_f32_bf16 v21, v53, s36, v21
    v_dot2_f32_bf16 v23, v54, v54, v23
    v_dot2_f32_bf16 v21, v54, s36, v21
    v_dot2_f32_bf16 v23, v55, v55, v23
    v_dot2_f32_bf16 v21, v55, s36, v21
    v_dot2_f32_bf16 v24, v56, s36, v24
    v_dot2_f32_bf16 v24, v57, s36, v24
    v_dot2_f32_bf16 v24, v58, s36, v24
    v_dot2_f32_bf16 v24, v59, s36, v24
    v_dot2_f32_bf16 v25, v60, s36, v25
    v_dot2_f32_bf16 v25, v61, s36, v25
    v_dot2_f32_bf16 v25, v62, s36, v25
    v_dot2_f32_bf16 v25, v63, s36, v25
    s_waitcnt lgkmcnt(0)
    ds_read_b128 v[48:51], v15 offset:32768
    ds_read_b128 v[52:55], v15 offset:36864
    ds_read_b64_tr_b16 v[56:57], v16 offset:35840
    ds_read_b64_tr_b16 v[58:59], v16 offset:36096
    ds_read_b64_tr_b16 v[60:61], v16 offset:39936
    ds_read_b64_tr_b16 v[62:63], v16 offset:40192
    v_mfma_f32_32x32x16_bf16 v[64:79], v[40:43], v[32:35], v[64:79]
    v_mfma_f32_32x32x16_bf16 v[80:95], v[40:43], v[36:39], v[80:95]
    v_mfma_f32_32x32x16_bf16 v[96:111], v[44:47], v[32:35], v[96:111]
    v_mfma_f32_32x32x16_bf16 v[112:127], v[44:47], v[36:39], v[112:127]
    v_dot2_f32_bf16 v22, v32, v32, v22
    v_dot2_f32_bf16 v20, v32, s36, v20
    v_dot2_f32_bf16 v22, v33, v33, v22
    v_dot2_f32_bf16 v20, v33, s36, v20
    v_dot2_f32_bf16 v22, v34, v34, v22
    v_dot2_f32_bf16 v20, v34, s36, v20
    v_dot2_f32_bf16 v22, v35, v35, v22
    v_dot2_f32_bf16 v20, v35, s36, v20
    v_dot2_f32_bf16 v23, v36, v36, v23
    v_dot2_f32_bf16 v21, v36, s36, v21
    v_dot2_f32_bf16 v23, v37, v37, v23
    v_dot2_f32_bf16 v21, v37, s36, v21
    v_dot2_f32_bf16 v23, v38, v38, v23
    v_dot2_f32_bf16 v21, v38, s36, v21
    v_dot2_f32_bf16 v23, v39, v39, v23
    v_dot2_f32_bf16 v21, v39, s36, v21
    v_dot2_f32_bf16 v24, v40, s36, v24
    v_dot2_f32_bf16 v24, v41, s36, v24
    v_dot2_f32_bf16 v24, v42, s36, v24
    v_dot2_f32_bf16 v24, v43, s36, v24
    v_dot2_f32_bf16 v25, v44, s36, v25
    v_dot2_f32_bf16 v25, v45, s36, v25
    v_dot2_f32_bf16 v25, v46, s36, v25
    v_dot2_f32_bf16 v25, v47, s36, v25
    s_waitcnt lgkmcnt(0)
    v_mfma_f32_32x32x16_bf16 v[64:79], v[56:59], v[48:51], v[64:79]
    v_mfma_f32_32x32x16_bf16 v[80:95], v[56:59], v[52:55], v[80:95]
    v_mfma_f32_32x32x16_bf16 v[96:111], v[60:63], v[48:51], v[96:111]
    v_mfma_f32_32x32x16_bf16 v[112:127], v[60:63], v[52:55], v[112:127]
    v_dot2_f32_bf16 v22, v48, v48, v22
    v_dot2_f32_bf16 v20, v48, s36, v20
    v_dot2_f32_bf16 v22, v49, v49, v22
    v_dot2_f32_bf16 v20, v49, s36, v20
    v_dot2_f32_bf16 v22, v50, v50, v22
    v_dot2_f32_bf16 v20, v50, s36, v20
    v_dot2_f32_bf16 v22, v51, v51, v22
    v_dot2_f32_bf16 v20, v51, s36, v20
    v_dot2_f32_bf16 v23, v52, v52, v23
    v_dot2_f32_bf16 v21, v52, s36, v21
    v_dot2_f32_bf16 v23, v53, v53, v23
    v_dot2_f32_bf16 v21, v53, s36, v21
    v_dot2_f32_bf16 v23, v54, v54, v23
    v_dot2_f32_bf16 v21, v54, s36, v21
    v_dot2_f32_bf16 v23, v55, v55, v23
    v_dot2_f32_bf16 v21, v55, s36, v21
    v_dot2_f32_bf16 v24, v56, s36, v24
    v_dot2_f32_bf16 v24, v57, s36, v24
    v_dot2_f32_bf16 v24, v58, s36, v24
    v_dot2_f32_bf16 v24, v59, s36, v24
    v_dot2_f32_bf16 v25, v60, s36, v25
    v_dot2_f32_bf16 v25, v61, s36, v25
    v_dot2_f32_bf16 v25, v62, s36, v25
    v_dot2_f32_bf16 v25, v63, s36, v25
    s_add_u32 s48, s48, 2
    s_cmp_lt_u32 s48, 10
    s_cbranch_scc1 il_qkvB1_kernel_loop
    s_nop 15
    s_nop 7
    v_and_b32 v4, 31, v1
    v_and_b32 v5, 1, v2
    v_mul_u32_u24 v5, 64, v5
    v_add3_u32 v4, v4, v5, s34
    v_lshrrev_b32 v5, 1, v2
    v_mul_u32_u24 v5, 64, v5
    v_lshl_add_u32 v5, v3, 2, v5
    v_add_u32 v5, s35, v5
    v_mov_b32 v6, v20
    s_nop 1
    v_permlane32_swap_b32 v6, v20
    s_nop 1
    v_add_f32 v20, v20, v6
    v_mov_b32 v6, v22
    s_nop 1
    v_permlane32_swap_b32 v6, v22
    s_nop 1
    v_add_f32 v22, v22, v6
    v_mov_b32 v6, v21
    s_nop 1
    v_permlane32_swap_b32 v6, v21
    s_nop 1
    v_add_f32 v21, v21, v6
    v_mov_b32 v6, v23
    s_nop 1
    v_permlane32_swap_b32 v6, v23
    s_nop 1
    v_add_f32 v23, v23, v6
    v_mov_b32 v6, v24
    s_nop 1
    v_permlane32_swap_b32 v6, v24
    s_nop 1
    v_add_f32 v24, v24, v6
    v_mov_b32 v6, v25
    s_nop 1
    v_permlane32_swap_b32 v6, v25
    s_nop 1
    v_add_f32 v25, v25, v6
    s_mov_b32 s3, 0x3acccccd
    v_mul_f32 v20, s3, v20
    v_mul_f32 v22, s3, v22
    v_fma_f32 v22, -v20, v20, v22
    v_max_f32 v22, 0, v22
    v_add_f32 v22, 0x3727c5ac, v22
    v_rsq_f32 v22, v22
    v_mul_f32 v21, s3, v21
    v_mul_f32 v23, s3, v23
    v_fma_f32 v23, -v21, v21, v23
    v_max_f32 v23, 0, v23
    v_add_f32 v23, 0x3727c5ac, v23
    v_rsq_f32 v23, v23
    v_lshlrev_b32 v6, 2, v1
    v_mul_u32_u24 v7, 512, v2
    v_add_u32 v6, v6, v7
    v_add_u32 v6, 65536, v6
    ds_write_b32 v6, v24 offset:0
    ds_write_b32 v6, v25 offset:256
    s_waitcnt lgkmcnt(0)
    v_lshlrev_b32 v6, 4, v3
    v_add3_u32 v6, v6, v7, 0
    v_add_u32 v6, 65536, v6
    ds_read_b128 v[32:35], v6 offset:0
    ds_read_b128 v[36:39], v6 offset:32
    ds_read_b128 v[40:43], v6 offset:64
    ds_read_b128 v[44:47], v6 offset:96
    ds_read_b128 v[48:51], v6 offset:256
    ds_read_b128 v[52:55], v6 offset:288
    ds_read_b128 v[56:59], v6 offset:320
    ds_read_b128 v[60:63], v6 offset:352
    s_waitcnt lgkmcnt(0)
    s_mov_b32 s49, 0x3ea52b5c
    s_mov_b32 s56, 640
    v_add_u32 v8, 0, v4
    v_fma_f32 v64, -v20, v32, v64
    v_mul_f32 v64, v22, v64
    v_fma_f32 v65, -v20, v33, v65
    v_mul_f32 v65, v22, v65
    v_fma_f32 v66, -v20, v34, v66
    v_mul_f32 v66, v22, v66
    v_fma_f32 v67, -v20, v35, v67
    v_mul_f32 v67, v22, v67
    v_fma_f32 v68, -v20, v36, v68
    v_mul_f32 v68, v22, v68
    v_fma_f32 v69, -v20, v37, v69
    v_mul_f32 v69, v22, v69
    v_fma_f32 v70, -v20, v38, v70
    v_mul_f32 v70, v22, v70
    v_fma_f32 v71, -v20, v39, v71
    v_mul_f32 v71, v22, v71
    v_fma_f32 v72, -v20, v40, v72
    v_mul_f32 v72, v22, v72
    v_fma_f32 v73, -v20, v41, v73
    v_mul_f32 v73, v22, v73
    v_fma_f32 v74, -v20, v42, v74
    v_mul_f32 v74, v22, v74
    v_fma_f32 v75, -v20, v43, v75
    v_mul_f32 v75, v22, v75
    v_fma_f32 v76, -v20, v44, v76
    v_mul_f32 v76, v22, v76
    v_fma_f32 v77, -v20, v45, v77
    v_mul_f32 v77, v22, v77
    v_fma_f32 v78, -v20, v46, v78
    v_mul_f32 v78, v22, v78
    v_fma_f32 v79, -v20, v47, v79
    v_mul_f32 v79, v22, v79
    v_add_u32 v9, 0, v5
    v_cmp_gt_u32 vcc, 640, v9
    s_and_saveexec_b64 s[50:51], vcc
    v_mul_f32 v16, s49, v64
    v_mul_f32 v17, s49, v65
    v_mul_f32 v18, s49, v66
    v_mul_f32 v19, s49, v67
    v_cvt_pk_bf16_f32 v14, v16, v17
    v_cvt_pk_bf16_f32 v15, v18, v19
    v_mul_u32_u24 v10, 1280, v8
    v_lshl_add_u32 v10, v9, 1, v10
    buffer_store_dwordx2 v[14:15], v10, s[20:23], 0 offen
    s_mov_b64 exec, s[50:51]
    v_cvt_pk_bf16_f32 v14, v64, v65
    v_cvt_pk_bf16_f32 v15, v66, v67
    v_subrev_u32 v11, 640, v9
    v_cmp_le_u32 vcc, 640, v11
    s_nop 1
    v_cndmask_b32 v16, 0, 1, vcc
    v_mul_u32_u24 v17, 640, v16
    v_sub_u32 v17, v11, v17
    v_lshrrev_b32 v18, 2, v17
    v_mul_u32_u24 v12, 52429, v18
    v_lshrrev_b32 v12, 18, v12
    v_mul_u32_u24 v13, 20, v12
    v_sub_u32 v13, v17, v13
    v_mov_b32 v11, v16
    v_cmp_le_u32 vcc, 640, v9
    v_cmp_gt_u32 s[52:53], 20, v13
    s_nop 1
    s_and_b64 vcc, vcc, s[52:53]
    s_and_saveexec_b64 s[50:51], vcc
    v_lshlrev_b32 v16, 17, v12
    v_lshl_add_u32 v16, v8, 6, v16
    v_lshrrev_b32 v17, 3, v13
    v_lshrrev_b32 v18, 2, v8
    v_and_b32 v18, 3, v18
    v_xor_b32 v17, v17, v18
    v_lshl_add_u32 v17, v17, 4, v16
    v_and_b32 v18, 7, v13
    v_lshl_add_u32 v17, v18, 1, v17
    v_lshl_add_u32 v16, v13, 1, v16
    v_cmp_eq_u32 vcc, 0, v11
    s_and_saveexec_b64 s[52:53], vcc
    buffer_store_dwordx2 v[14:15], v17, s[24:27], 0 offen
    v_cmp_eq_u32 vcc, 16, v13
    s_and_saveexec_b64 s[54:55], vcc
    v_mov_b32 v18, 0
    v_mov_b32 v19, 0
    buffer_store_dwordx2 v[18:19], v17, s[24:27], 0 offen offset:8
    v_lshrrev_b32 v18, 2, v8
    v_and_b32 v18, 3, v18
    v_xor_b32 v18, 3, v18
    v_and_b32 v19, 0xffffffc0, v17
    v_lshl_add_u32 v18, v18, 4, v19
    v_mov_b32 v28, 0
    v_mov_b32 v29, 0
    v_mov_b32 v30, 0
    v_mov_b32 v31, 0
    buffer_store_dwordx4 v[28:31], v18, s[24:27], 0 offen
    s_mov_b64 exec, s[50:51]
    v_cmp_ne_u32 vcc, 0, v11
    v_cmp_le_u32 s[52:53], s56, v9
    s_and_b64 vcc, vcc, s[52:53]
    v_cmp_gt_u32 s[52:53], 20, v13
    s_nop 1
    s_and_b64 vcc, vcc, s[52:53]
    s_and_saveexec_b64 s[52:53], vcc
    buffer_store_dwordx2 v[14:15], v16, s[28:31], 0 offen
    v_cmp_eq_u32 vcc, 16, v13
    s_and_saveexec_b64 s[54:55], vcc
    v_mov_b32 v18, 0x3f80
    v_mov_b32 v19, 0
    buffer_store_dwordx2 v[18:19], v16, s[28:31], 0 offen offset:8
    s_mov_b64 exec, -1
    v_add_u32 v9, 8, v5
    v_cmp_gt_u32 vcc, 640, v9
    s_and_saveexec_b64 s[50:51], vcc
    v_mul_f32 v16, s49, v68
    v_mul_f32 v17, s49, v69
    v_mul_f32 v18, s49, v70
    v_mul_f32 v19, s49, v71
    v_cvt_pk_bf16_f32 v14, v16, v17
    v_cvt_pk_bf16_f32 v15, v18, v19
    v_mul_u32_u24 v10, 1280, v8
    v_lshl_add_u32 v10, v9, 1, v10
    buffer_store_dwordx2 v[14:15], v10, s[20:23], 0 offen
    s_mov_b64 exec, s[50:51]
    v_cvt_pk_bf16_f32 v14, v68, v69
    v_cvt_pk_bf16_f32 v15, v70, v71
    v_subrev_u32 v11, 640, v9
    v_cmp_le_u32 vcc, 640, v11
    s_nop 1
    v_cndmask_b32 v16, 0, 1, vcc
    v_mul_u32_u24 v17, 640, v16
    v_sub_u32 v17, v11, v17
    v_lshrrev_b32 v18, 2, v17
    v_mul_u32_u24 v12, 52429, v18
    v_lshrrev_b32 v12, 18, v12
    v_mul_u32_u24 v13, 20, v12
    v_sub_u32 v13, v17, v13
    v_mov_b32 v11, v16
    v_cmp_le_u32 vcc, 640, v9
    v_cmp_gt_u32 s[52:53], 20, v13
    s_nop 1
    s_and_b64 vcc, vcc, s[52:53]
    s_and_saveexec_b64 s[50:51], vcc
    v_lshlrev_b32 v16, 17, v12
    v_lshl_add_u32 v16, v8, 6, v16
    v_lshrrev_b32 v17, 3, v13
    v_lshrrev_b32 v18, 2, v8
    v_and_b32 v18, 3, v18
    v_xor_b32 v17, v17, v18
    v_lshl_add_u32 v17, v17, 4, v16
    v_and_b32 v18, 7, v13
    v_lshl_add_u32 v17, v18, 1, v17
    v_lshl_add_u32 v16, v13, 1, v16
    v_cmp_eq_u32 vcc, 0, v11
    s_and_saveexec_b64 s[52:53], vcc
    buffer_store_dwordx2 v[14:15], v17, s[24:27], 0 offen
    v_cmp_eq_u32 vcc, 16, v13
    s_and_saveexec_b64 s[54:55], vcc
    v_mov_b32 v18, 0
    v_mov_b32 v19, 0
    buffer_store_dwordx2 v[18:19], v17, s[24:27], 0 offen offset:8
    v_lshrrev_b32 v18, 2, v8
    v_and_b32 v18, 3, v18
    v_xor_b32 v18, 3, v18
    v_and_b32 v19, 0xffffffc0, v17
    v_lshl_add_u32 v18, v18, 4, v19
    v_mov_b32 v28, 0
    v_mov_b32 v29, 0
    v_mov_b32 v30, 0
    v_mov_b32 v31, 0
    buffer_store_dwordx4 v[28:31], v18, s[24:27], 0 offen
    s_mov_b64 exec, s[50:51]
    v_cmp_ne_u32 vcc, 0, v11
    v_cmp_le_u32 s[52:53], s56, v9
    s_and_b64 vcc, vcc, s[52:53]
    v_cmp_gt_u32 s[52:53], 20, v13
    s_nop 1
    s_and_b64 vcc, vcc, s[52:53]
    s_and_saveexec_b64 s[52:53], vcc
    buffer_store_dwordx2 v[14:15], v16, s[28:31], 0 offen
    v_cmp_eq_u32 vcc, 16, v13
    s_and_saveexec_b64 s[54:55], vcc
    v_mov_b32 v18, 0x3f80
    v_mov_b32 v19, 0
    buffer_store_dwordx2 v[18:19], v16, s[28:31], 0 offen offset:8
    s_mov_b64 exec, -1
    v_add_u32 v9, 16, v5
    v_cmp_gt_u32 vcc, 640, v9
    s_and_saveexec_b64 s[50:51], vcc
    v_mul_f32 v16, s49, v72
    v_mul_f32 v17, s49, v73
    v_mul_f32 v18, s49, v74
    v_mul_f32 v19, s49, v75
    v_cvt_pk_bf16_f32 v14, v16, v17
    v_cvt_pk_bf16_f32 v15, v18, v19
    v_mul_u32_u24 v10, 1280, v8
    v_lshl_add_u32 v10, v9, 1, v10
    buffer_store_dwordx2 v[14:15], v10, s[20:23], 0 offen
    s_mov_b64 exec, s[50:51]
    v_cvt_pk_bf16_f32 v14, v72, v73
    v_cvt_pk_bf16_f32 v15, v74, v75
    v_subrev_u32 v11, 640, v9
    v_cmp_le_u32 vcc, 640, v11
    s_nop 1
    v_cndmask_b32 v16, 0, 1, vcc
    v_mul_u32_u24 v17, 640, v16
    v_sub_u32 v17, v11, v17
    v_lshrrev_b32 v18, 2, v17
    v_mul_u32_u24 v12, 52429, v18
    v_lshrrev_b32 v12, 18, v12
    v_mul_u32_u24 v13, 20, v12
    v_sub_u32 v13, v17, v13
    v_mov_b32 v11, v16
    v_cmp_le_u32 vcc, 640, v9
    v_cmp_gt_u32 s[52:53], 20, v13
    s_nop 1
    s_and_b64 vcc, vcc, s[52:53]
    s_and_saveexec_b64 s[50:51], vcc
    v_lshlrev_b32 v16, 17, v12
    v_lshl_add_u32 v16, v8, 6, v16
    v_lshrrev_b32 v17, 3, v13
    v_lshrrev_b32 v18, 2, v8
    v_and_b32 v18, 3, v18
    v_xor_b32 v17, v17, v18
    v_lshl_add_u32 v17, v17, 4, v16
    v_and_b32 v18, 7, v13
    v_lshl_add_u32 v17, v18, 1, v17
    v_lshl_add_u32 v16, v13, 1, v16
    v_cmp_eq_u32 vcc, 0, v11
    s_and_saveexec_b64 s[52:53], vcc
    buffer_store_dwordx2 v[14:15], v17, s[24:27], 0 offen
    v_cmp_eq_u32 vcc, 16, v13
    s_and_saveexec_b64 s[54:55], vcc
    v_mov_b32 v18, 0
    v_mov_b32 v19, 0
    buffer_store_dwordx2 v[18:19], v17, s[24:27], 0 offen offset:8
    v_lshrrev_b32 v18, 2, v8
    v_and_b32 v18, 3, v18
    v_xor_b32 v18, 3, v18
    v_and_b32 v19, 0xffffffc0, v17
    v_lshl_add_u32 v18, v18, 4, v19
    v_mov_b32 v28, 0
    v_mov_b32 v29, 0
    v_mov_b32 v30, 0
    v_mov_b32 v31, 0
    buffer_store_dwordx4 v[28:31], v18, s[24:27], 0 offen
    s_mov_b64 exec, s[50:51]
    v_cmp_ne_u32 vcc, 0, v11
    v_cmp_le_u32 s[52:53], s56, v9
    s_and_b64 vcc, vcc, s[52:53]
    v_cmp_gt_u32 s[52:53], 20, v13
    s_nop 1
    s_and_b64 vcc, vcc, s[52:53]
    s_and_saveexec_b64 s[52:53], vcc
    buffer_store_dwordx2 v[14:15], v16, s[28:31], 0 offen
    v_cmp_eq_u32 vcc, 16, v13
    s_and_saveexec_b64 s[54:55], vcc
    v_mov_b32 v18, 0x3f80
    v_mov_b32 v19, 0
    buffer_store_dwordx2 v[18:19], v16, s[28:31], 0 offen offset:8
    s_mov_b64 exec, -1
    v_add_u32 v9, 24, v5
    v_cmp_gt_u32 vcc, 640, v9
    s_and_saveexec_b64 s[50:51], vcc
    v_mul_f32 v16, s49, v76
    v_mul_f32 v17, s49, v77
    v_mul_f32 v18, s49, v78
    v_mul_f32 v19, s49, v79
    v_cvt_pk_bf16_f32 v14, v16, v17
    v_cvt_pk_bf16_f32 v15, v18, v19
    v_mul_u32_u24 v10, 1280, v8
    v_lshl_add_u32 v10, v9, 1, v10
    buffer_store_dwordx2 v[14:15], v10, s[20:23], 0 offen
    s_mov_b64 exec, s[50:51]
    v_cvt_pk_bf16_f32 v14, v76, v77
    v_cvt_pk_bf16_f32 v15, v78, v79
    v_subrev_u32 v11, 640, v9
    v_cmp_le_u32 vcc, 640, v11
    s_nop 1
    v_cndmask_b32 v16, 0, 1, vcc
    v_mul_u32_u24 v17, 640, v16
    v_sub_u32 v17, v11, v17
    v_lshrrev_b32 v18, 2, v17
    v_mul_u32_u24 v12, 52429, v18
    v_lshrrev_b32 v12, 18, v12
    v_mul_u32_u24 v13, 20, v12
    v_sub_u32 v13, v17, v13
    v_mov_b32 v11, v16
    v_cmp_le_u32 vcc, 640, v9
    v_cmp_gt_u32 s[52:53], 20, v13
    s_nop 1
    s_and_b64 vcc, vcc, s[52:53]
    s_and_saveexec_b64 s[50:51], vcc
    v_lshlrev_b32 v16, 17, v12
    v_lshl_add_u32 v16, v8, 6, v16
    v_lshrrev_b32 v17, 3, v13
    v_lshrrev_b32 v18, 2, v8
    v_and_b32 v18, 3, v18
    v_xor_b32 v17, v17, v18
    v_lshl_add_u32 v17, v17, 4, v16
    v_and_b32 v18, 7, v13
    v_lshl_add_u32 v17, v18, 1, v17
    v_lshl_add_u32 v16, v13, 1, v16
    v_cmp_eq_u32 vcc, 0, v11
    s_and_saveexec_b64 s[52:53], vcc
    buffer_store_dwordx2 v[14:15], v17, s[24:27], 0 offen
    v_cmp_eq_u32 vcc, 16, v13
    s_and_saveexec_b64 s[54:55], vcc
    v_mov_b32 v18, 0
    v_mov_b32 v19, 0
    buffer_store_dwordx2 v[18:19], v17, s[24:27], 0 offen offset:8
    v_lshrrev_b32 v18, 2, v8
    v_and_b32 v18, 3, v18
    v_xor_b32 v18, 3, v18
    v_and_b32 v19, 0xffffffc0, v17
    v_lshl_add_u32 v18, v18, 4, v19
    v_mov_b32 v28, 0
    v_mov_b32 v29, 0
    v_mov_b32 v30, 0
    v_mov_b32 v31, 0
    buffer_store_dwordx4 v[28:31], v18, s[24:27], 0 offen
    s_mov_b64 exec, s[50:51]
    v_cmp_ne_u32 vcc, 0, v11
    v_cmp_le_u32 s[52:53], s56, v9
    s_and_b64 vcc, vcc, s[52:53]
    v_cmp_gt_u32 s[52:53], 20, v13
    s_nop 1
    s_and_b64 vcc, vcc, s[52:53]
    s_and_saveexec_b64 s[52:53], vcc
    buffer_store_dwordx2 v[14:15], v16, s[28:31], 0 offen
    v_cmp_eq_u32 vcc, 16, v13
    s_and_saveexec_b64 s[54:55], vcc
    v_mov_b32 v18, 0x3f80
    v_mov_b32 v19, 0
    buffer_store_dwordx2 v[18:19], v16, s[28:31], 0 offen offset:8
    s_mov_b64 exec, -1
    v_add_u32 v8, 32, v4
    v_fma_f32 v80, -v21, v32, v80
    v_mul_f32 v80, v23, v80
    v_fma_f32 v81, -v21, v33, v81
    v_mul_f32 v81, v23, v81
    v_fma_f32 v82, -v21, v34, v82
    v_mul_f32 v82, v23, v82
    v_fma_f32 v83, -v21, v35, v83
    v_mul_f32 v83, v23, v83
    v_fma_f32 v84, -v21, v36, v84
    v_mul_f32 v84, v23, v84
    v_fma_f32 v85, -v21, v37, v85
    v_mul_f32 v85, v23, v85
    v_fma_f32 v86, -v21, v38, v86
    v_mul_f32 v86, v23, v86
    v_fma_f32 v87, -v21, v39, v87
    v_mul_f32 v87, v23, v87
    v_fma_f32 v88, -v21, v40, v88
    v_mul_f32 v88, v23, v88
    v_fma_f32 v89, -v21, v41, v89
    v_mul_f32 v89, v23, v89
    v_fma_f32 v90, -v21, v42, v90
    v_mul_f32 v90, v23, v90
    v_fma_f32 v91, -v21, v43, v91
    v_mul_f32 v91, v23, v91
    v_fma_f32 v92, -v21, v44, v92
    v_mul_f32 v92, v23, v92
    v_fma_f32 v93, -v21, v45, v93
    v_mul_f32 v93, v23, v93
    v_fma_f32 v94, -v21, v46, v94
    v_mul_f32 v94, v23, v94
    v_fma_f32 v95, -v21, v47, v95
    v_mul_f32 v95, v23, v95
    v_add_u32 v9, 0, v5
    v_cmp_gt_u32 vcc, 640, v9
    s_and_saveexec_b64 s[50:51], vcc
    v_mul_f32 v16, s49, v80
    v_mul_f32 v17, s49, v81
    v_mul_f32 v18, s49, v82
    v_mul_f32 v19, s49, v83
    v_cvt_pk_bf16_f32 v14, v16, v17
    v_cvt_pk_bf16_f32 v15, v18, v19
    v_mul_u32_u24 v10, 1280, v8
    v_lshl_add_u32 v10, v9, 1, v10
    buffer_store_dwordx2 v[14:15], v10, s[20:23], 0 offen
    s_mov_b64 exec, s[50:51]
    v_cvt_pk_bf16_f32 v14, v80, v81
    v_cvt_pk_bf16_f32 v15, v82, v83
    v_subrev_u32 v11, 640, v9
    v_cmp_le_u32 vcc, 640, v11
    s_nop 1
    v_cndmask_b32 v16, 0, 1, vcc
    v_mul_u32_u24 v17, 640, v16
    v_sub_u32 v17, v11, v17
    v_lshrrev_b32 v18, 2, v17
    v_mul_u32_u24 v12, 52429, v18
    v_lshrrev_b32 v12, 18, v12
    v_mul_u32_u24 v13, 20, v12
    v_sub_u32 v13, v17, v13
    v_mov_b32 v11, v16
    v_cmp_le_u32 vcc, 640, v9
    v_cmp_gt_u32 s[52:53], 20, v13
    s_nop 1
    s_and_b64 vcc, vcc, s[52:53]
    s_and_saveexec_b64 s[50:51], vcc
    v_lshlrev_b32 v16, 17, v12
    v_lshl_add_u32 v16, v8, 6, v16
    v_lshrrev_b32 v17, 3, v13
    v_lshrrev_b32 v18, 2, v8
    v_and_b32 v18, 3, v18
    v_xor_b32 v17, v17, v18
    v_lshl_add_u32 v17, v17, 4, v16
    v_and_b32 v18, 7, v13
    v_lshl_add_u32 v17, v18, 1, v17
    v_lshl_add_u32 v16, v13, 1, v16
    v_cmp_eq_u32 vcc, 0, v11
    s_and_saveexec_b64 s[52:53], vcc
    buffer_store_dwordx2 v[14:15], v17, s[24:27], 0 offen
    v_cmp_eq_u32 vcc, 16, v13
    s_and_saveexec_b64 s[54:55], vcc
    v_mov_b32 v18, 0
    v_mov_b32 v19, 0
    buffer_store_dwordx2 v[18:19], v17, s[24:27], 0 offen offset:8
    v_lshrrev_b32 v18, 2, v8
    v_and_b32 v18, 3, v18
    v_xor_b32 v18, 3, v18
    v_and_b32 v19, 0xffffffc0, v17
    v_lshl_add_u32 v18, v18, 4, v19
    v_mov_b32 v28, 0
    v_mov_b32 v29, 0
    v_mov_b32 v30, 0
    v_mov_b32 v31, 0
    buffer_store_dwordx4 v[28:31], v18, s[24:27], 0 offen
    s_mov_b64 exec, s[50:51]
    v_cmp_ne_u32 vcc, 0, v11
    v_cmp_le_u32 s[52:53], s56, v9
    s_and_b64 vcc, vcc, s[52:53]
    v_cmp_gt_u32 s[52:53], 20, v13
    s_nop 1
    s_and_b64 vcc, vcc, s[52:53]
    s_and_saveexec_b64 s[52:53], vcc
    buffer_store_dwordx2 v[14:15], v16, s[28:31], 0 offen
    v_cmp_eq_u32 vcc, 16, v13
    s_and_saveexec_b64 s[54:55], vcc
    v_mov_b32 v18, 0x3f80
    v_mov_b32 v19, 0
    buffer_store_dwordx2 v[18:19], v16, s[28:31], 0 offen offset:8
    s_mov_b64 exec, -1
    v_add_u32 v9, 8, v5
    v_cmp_gt_u32 vcc, 640, v9
    s_and_saveexec_b64 s[50:51], vcc
    v_mul_f32 v16, s49, v84
    v_mul_f32 v17, s49, v85
    v_mul_f32 v18, s49, v86
    v_mul_f32 v19, s49, v87
    v_cvt_pk_bf16_f32 v14, v16, v17
    v_cvt_pk_bf16_f32 v15, v18, v19
    v_mul_u32_u24 v10, 1280, v8
    v_lshl_add_u32 v10, v9, 1, v10
    buffer_store_dwordx2 v[14:15], v10, s[20:23], 0 offen
    s_mov_b64 exec, s[50:51]
    v_cvt_pk_bf16_f32 v14, v84, v85
    v_cvt_pk_bf16_f32 v15, v86, v87
    v_subrev_u32 v11, 640, v9
    v_cmp_le_u32 vcc, 640, v11
    s_nop 1
    v_cndmask_b32 v16, 0, 1, vcc
    v_mul_u32_u24 v17, 640, v16
    v_sub_u32 v17, v11, v17
    v_lshrrev_b32 v18, 2, v17
    v_mul_u32_u24 v12, 52429, v18
    v_lshrrev_b32 v12, 18, v12
    v_mul_u32_u24 v13, 20, v12
    v_sub_u32 v13, v17, v13
    v_mov_b32 v11, v16
    v_cmp_le_u32 vcc, 640, v9
    v_cmp_gt_u32 s[52:53], 20, v13
    s_nop 1
    s_and_b64 vcc, vcc, s[52:53]
    s_and_saveexec_b64 s[50:51], vcc
    v_lshlrev_b32 v16, 17, v12
    v_lshl_add_u32 v16, v8, 6, v16
    v_lshrrev_b32 v17, 3, v13
    v_lshrrev_b32 v18, 2, v8
    v_and_b32 v18, 3, v18
    v_xor_b32 v17, v17, v18
    v_lshl_add_u32 v17, v17, 4, v16
    v_and_b32 v18, 7, v13
    v_lshl_add_u32 v17, v18, 1, v17
    v_lshl_add_u32 v16, v13, 1, v16
    v_cmp_eq_u32 vcc, 0, v11
    s_and_saveexec_b64 s[52:53], vcc
    buffer_store_dwordx2 v[14:15], v17, s[24:27], 0 offen
    v_cmp_eq_u32 vcc, 16, v13
    s_and_saveexec_b64 s[54:55], vcc
    v_mov_b32 v18, 0
    v_mov_b32 v19, 0
    buffer_store_dwordx2 v[18:19], v17, s[24:27], 0 offen offset:8
    v_lshrrev_b32 v18, 2, v8
    v_and_b32 v18, 3, v18
    v_xor_b32 v18, 3, v18
    v_and_b32 v19, 0xffffffc0, v17
    v_lshl_add_u32 v18, v18, 4, v19
    v_mov_b32 v28, 0
    v_mov_b32 v29, 0
    v_mov_b32 v30, 0
    v_mov_b32 v31, 0
    buffer_store_dwordx4 v[28:31], v18, s[24:27], 0 offen
    s_mov_b64 exec, s[50:51]
    v_cmp_ne_u32 vcc, 0, v11
    v_cmp_le_u32 s[52:53], s56, v9
    s_and_b64 vcc, vcc, s[52:53]
    v_cmp_gt_u32 s[52:53], 20, v13
    s_nop 1
    s_and_b64 vcc, vcc, s[52:53]
    s_and_saveexec_b64 s[52:53], vcc
    buffer_store_dwordx2 v[14:15], v16, s[28:31], 0 offen
    v_cmp_eq_u32 vcc, 16, v13
    s_and_saveexec_b64 s[54:55], vcc
    v_mov_b32 v18, 0x3f80
    v_mov_b32 v19, 0
    buffer_store_dwordx2 v[18:19], v16, s[28:31], 0 offen offset:8
    s_mov_b64 exec, -1
    v_add_u32 v9, 16, v5
    v_cmp_gt_u32 vcc, 640, v9
    s_and_saveexec_b64 s[50:51], vcc
    v_mul_f32 v16, s49, v88
    v_mul_f32 v17, s49, v89
    v_mul_f32 v18, s49, v90
    v_mul_f32 v19, s49, v91
    v_cvt_pk_bf16_f32 v14, v16, v17
    v_cvt_pk_bf16_f32 v15, v18, v19
    v_mul_u32_u24 v10, 1280, v8
    v_lshl_add_u32 v10, v9, 1, v10
    buffer_store_dwordx2 v[14:15], v10, s[20:23], 0 offen
    s_mov_b64 exec, s[50:51]
    v_cvt_pk_bf16_f32 v14, v88, v89
    v_cvt_pk_bf16_f32 v15, v90, v91
    v_subrev_u32 v11, 640, v9
    v_cmp_le_u32 vcc, 640, v11
    s_nop 1
    v_cndmask_b32 v16, 0, 1, vcc
    v_mul_u32_u24 v17, 640, v16
    v_sub_u32 v17, v11, v17
    v_lshrrev_b32 v18, 2, v17
    v_mul_u32_u24 v12, 52429, v18
    v_lshrrev_b32 v12, 18, v12
    v_mul_u32_u24 v13, 20, v12
    v_sub_u32 v13, v17, v13
    v_mov_b32 v11, v16
    v_cmp_le_u32 vcc, 640, v9
    v_cmp_gt_u32 s[52:53], 20, v13
    s_nop 1
    s_and_b64 vcc, vcc, s[52:53]
    s_and_saveexec_b64 s[50:51], vcc
    v_lshlrev_b32 v16, 17, v12
    v_lshl_add_u32 v16, v8, 6, v16
    v_lshrrev_b32 v17, 3, v13
    v_lshrrev_b32 v18, 2, v8
    v_and_b32 v18, 3, v18
    v_xor_b32 v17, v17, v18
    v_lshl_add_u32 v17, v17, 4, v16
    v_and_b32 v18, 7, v13
    v_lshl_add_u32 v17, v18, 1, v17
    v_lshl_add_u32 v16, v13, 1, v16
    v_cmp_eq_u32 vcc, 0, v11
    s_and_saveexec_b64 s[52:53], vcc
    buffer_store_dwordx2 v[14:15], v17, s[24:27], 0 offen
    v_cmp_eq_u32 vcc, 16, v13
    s_and_saveexec_b64 s[54:55], vcc
    v_mov_b32 v18, 0
    v_mov_b32 v19, 0
    buffer_store_dwordx2 v[18:19], v17, s[24:27], 0 offen offset:8
    v_lshrrev_b32 v18, 2, v8
    v_and_b32 v18, 3, v18
    v_xor_b32 v18, 3, v18
    v_and_b32 v19, 0xffffffc0, v17
    v_lshl_add_u32 v18, v18, 4, v19
    v_mov_b32 v28, 0
    v_mov_b32 v29, 0
    v_mov_b32 v30, 0
    v_mov_b32 v31, 0
    buffer_store_dwordx4 v[28:31], v18, s[24:27], 0 offen
    s_mov_b64 exec, s[50:51]
    v_cmp_ne_u32 vcc, 0, v11
    v_cmp_le_u32 s[52:53], s56, v9
    s_and_b64 vcc, vcc, s[52:53]
    v_cmp_gt_u32 s[52:53], 20, v13
    s_nop 1
    s_and_b64 vcc, vcc, s[52:53]
    s_and_saveexec_b64 s[52:53], vcc
    buffer_store_dwordx2 v[14:15], v16, s[28:31], 0 offen
    v_cmp_eq_u32 vcc, 16, v13
    s_and_saveexec_b64 s[54:55], vcc
    v_mov_b32 v18, 0x3f80
    v_mov_b32 v19, 0
    buffer_store_dwordx2 v[18:19], v16, s[28:31], 0 offen offset:8
    s_mov_b64 exec, -1
    v_add_u32 v9, 24, v5
    v_cmp_gt_u32 vcc, 640, v9
    s_and_saveexec_b64 s[50:51], vcc
    v_mul_f32 v16, s49, v92
    v_mul_f32 v17, s49, v93
    v_mul_f32 v18, s49, v94
    v_mul_f32 v19, s49, v95
    v_cvt_pk_bf16_f32 v14, v16, v17
    v_cvt_pk_bf16_f32 v15, v18, v19
    v_mul_u32_u24 v10, 1280, v8
    v_lshl_add_u32 v10, v9, 1, v10
    buffer_store_dwordx2 v[14:15], v10, s[20:23], 0 offen
    s_mov_b64 exec, s[50:51]
    v_cvt_pk_bf16_f32 v14, v92, v93
    v_cvt_pk_bf16_f32 v15, v94, v95
    v_subrev_u32 v11, 640, v9
    v_cmp_le_u32 vcc, 640, v11
    s_nop 1
    v_cndmask_b32 v16, 0, 1, vcc
    v_mul_u32_u24 v17, 640, v16
    v_sub_u32 v17, v11, v17
    v_lshrrev_b32 v18, 2, v17
    v_mul_u32_u24 v12, 52429, v18
    v_lshrrev_b32 v12, 18, v12
    v_mul_u32_u24 v13, 20, v12
    v_sub_u32 v13, v17, v13
    v_mov_b32 v11, v16
    v_cmp_le_u32 vcc, 640, v9
    v_cmp_gt_u32 s[52:53], 20, v13
    s_nop 1
    s_and_b64 vcc, vcc, s[52:53]
    s_and_saveexec_b64 s[50:51], vcc
    v_lshlrev_b32 v16, 17, v12
    v_lshl_add_u32 v16, v8, 6, v16
    v_lshrrev_b32 v17, 3, v13
    v_lshrrev_b32 v18, 2, v8
    v_and_b32 v18, 3, v18
    v_xor_b32 v17, v17, v18
    v_lshl_add_u32 v17, v17, 4, v16
    v_and_b32 v18, 7, v13
    v_lshl_add_u32 v17, v18, 1, v17
    v_lshl_add_u32 v16, v13, 1, v16
    v_cmp_eq_u32 vcc, 0, v11
    s_and_saveexec_b64 s[52:53], vcc
    buffer_store_dwordx2 v[14:15], v17, s[24:27], 0 offen
    v_cmp_eq_u32 vcc, 16, v13
    s_and_saveexec_b64 s[54:55], vcc
    v_mov_b32 v18, 0
    v_mov_b32 v19, 0
    buffer_store_dwordx2 v[18:19], v17, s[24:27], 0 offen offset:8
    v_lshrrev_b32 v18, 2, v8
    v_and_b32 v18, 3, v18
    v_xor_b32 v18, 3, v18
    v_and_b32 v19, 0xffffffc0, v17
    v_lshl_add_u32 v18, v18, 4, v19
    v_mov_b32 v28, 0
    v_mov_b32 v29, 0
    v_mov_b32 v30, 0
    v_mov_b32 v31, 0
    buffer_store_dwordx4 v[28:31], v18, s[24:27], 0 offen
    s_mov_b64 exec, s[50:51]
    v_cmp_ne_u32 vcc, 0, v11
    v_cmp_le_u32 s[52:53], s56, v9
    s_and_b64 vcc, vcc, s[52:53]
    v_cmp_gt_u32 s[52:53], 20, v13
    s_nop 1
    s_and_b64 vcc, vcc, s[52:53]
    s_and_saveexec_b64 s[52:53], vcc
    buffer_store_dwordx2 v[14:15], v16, s[28:31], 0 offen
    v_cmp_eq_u32 vcc, 16, v13
    s_and_saveexec_b64 s[54:55], vcc
    v_mov_b32 v18, 0x3f80
    v_mov_b32 v19, 0
    buffer_store_dwordx2 v[18:19], v16, s[28:31], 0 offen offset:8
    s_mov_b64 exec, -1
    v_add_u32 v8, 0, v4
    v_fma_f32 v96, -v20, v48, v96
    v_mul_f32 v96, v22, v96
    v_fma_f32 v97, -v20, v49, v97
    v_mul_f32 v97, v22, v97
    v_fma_f32 v98, -v20, v50, v98
    v_mul_f32 v98, v22, v98
    v_fma_f32 v99, -v20, v51, v99
    v_mul_f32 v99, v22, v99
    v_fma_f32 v100, -v20, v52, v100
    v_mul_f32 v100, v22, v100
    v_fma_f32 v101, -v20, v53, v101
    v_mul_f32 v101, v22, v101
    v_fma_f32 v102, -v20, v54, v102
    v_mul_f32 v102, v22, v102
    v_fma_f32 v103, -v20, v55, v103
    v_mul_f32 v103, v22, v103
    v_fma_f32 v104, -v20, v56, v104
    v_mul_f32 v104, v22, v104
    v_fma_f32 v105, -v20, v57, v105
    v_mul_f32 v105, v22, v105
    v_fma_f32 v106, -v20, v58, v106
    v_mul_f32 v106, v22, v106
    v_fma_f32 v107, -v20, v59, v107
    v_mul_f32 v107, v22, v107
    v_fma_f32 v108, -v20, v60, v108
    v_mul_f32 v108, v22, v108
    v_fma_f32 v109, -v20, v61, v109
    v_mul_f32 v109, v22, v109
    v_fma_f32 v110, -v20, v62, v110
    v_mul_f32 v110, v22, v110
    v_fma_f32 v111, -v20, v63, v111
    v_mul_f32 v111, v22, v111
    v_add_u32 v9, 32, v5
    v_cmp_gt_u32 vcc, 640, v9
    s_and_saveexec_b64 s[50:51], vcc
    v_mul_f32 v16, s49, v96
    v_mul_f32 v17, s49, v97
    v_mul_f32 v18, s49, v98
    v_mul_f32 v19, s49, v99
    v_cvt_pk_bf16_f32 v14, v16, v17
    v_cvt_pk_bf16_f32 v15, v18, v19
    v_mul_u32_u24 v10, 1280, v8
    v_lshl_add_u32 v10, v9, 1, v10
    buffer_store_dwordx2 v[14:15], v10, s[20:23], 0 offen
    s_mov_b64 exec, s[50:51]
    v_cvt_pk_bf16_f32 v14, v96, v97
    v_cvt_pk_bf16_f32 v15, v98, v99
    v_subrev_u32 v11, 640, v9
    v_cmp_le_u32 vcc, 640, v11
    s_nop 1
    v_cndmask_b32 v16, 0, 1, vcc
    v_mul_u32_u24 v17, 640, v16
    v_sub_u32 v17, v11, v17
    v_lshrrev_b32 v18, 2, v17
    v_mul_u32_u24 v12, 52429, v18
    v_lshrrev_b32 v12, 18, v12
    v_mul_u32_u24 v13, 20, v12
    v_sub_u32 v13, v17, v13
    v_mov_b32 v11, v16
    v_cmp_le_u32 vcc, 640, v9
    v_cmp_gt_u32 s[52:53], 20, v13
    s_nop 1
    s_and_b64 vcc, vcc, s[52:53]
    s_and_saveexec_b64 s[50:51], vcc
    v_lshlrev_b32 v16, 17, v12
    v_lshl_add_u32 v16, v8, 6, v16
    v_lshrrev_b32 v17, 3, v13
    v_lshrrev_b32 v18, 2, v8
    v_and_b32 v18, 3, v18
    v_xor_b32 v17, v17, v18
    v_lshl_add_u32 v17, v17, 4, v16
    v_and_b32 v18, 7, v13
    v_lshl_add_u32 v17, v18, 1, v17
    v_lshl_add_u32 v16, v13, 1, v16
    v_cmp_eq_u32 vcc, 0, v11
    s_and_saveexec_b64 s[52:53], vcc
    buffer_store_dwordx2 v[14:15], v17, s[24:27], 0 offen
    v_cmp_eq_u32 vcc, 16, v13
    s_and_saveexec_b64 s[54:55], vcc
    v_mov_b32 v18, 0
    v_mov_b32 v19, 0
    buffer_store_dwordx2 v[18:19], v17, s[24:27], 0 offen offset:8
    v_lshrrev_b32 v18, 2, v8
    v_and_b32 v18, 3, v18
    v_xor_b32 v18, 3, v18
    v_and_b32 v19, 0xffffffc0, v17
    v_lshl_add_u32 v18, v18, 4, v19
    v_mov_b32 v28, 0
    v_mov_b32 v29, 0
    v_mov_b32 v30, 0
    v_mov_b32 v31, 0
    buffer_store_dwordx4 v[28:31], v18, s[24:27], 0 offen
    s_mov_b64 exec, s[50:51]
    v_cmp_ne_u32 vcc, 0, v11
    v_cmp_le_u32 s[52:53], s56, v9
    s_and_b64 vcc, vcc, s[52:53]
    v_cmp_gt_u32 s[52:53], 20, v13
    s_nop 1
    s_and_b64 vcc, vcc, s[52:53]
    s_and_saveexec_b64 s[52:53], vcc
    buffer_store_dwordx2 v[14:15], v16, s[28:31], 0 offen
    v_cmp_eq_u32 vcc, 16, v13
    s_and_saveexec_b64 s[54:55], vcc
    v_mov_b32 v18, 0x3f80
    v_mov_b32 v19, 0
    buffer_store_dwordx2 v[18:19], v16, s[28:31], 0 offen offset:8
    s_mov_b64 exec, -1
    v_add_u32 v9, 40, v5
    v_cmp_gt_u32 vcc, 640, v9
    s_and_saveexec_b64 s[50:51], vcc
    v_mul_f32 v16, s49, v100
    v_mul_f32 v17, s49, v101
    v_mul_f32 v18, s49, v102
    v_mul_f32 v19, s49, v103
    v_cvt_pk_bf16_f32 v14, v16, v17
    v_cvt_pk_bf16_f32 v15, v18, v19
    v_mul_u32_u24 v10, 1280, v8
    v_lshl_add_u32 v10, v9, 1, v10
    buffer_store_dwordx2 v[14:15], v10, s[20:23], 0 offen
    s_mov_b64 exec, s[50:51]
    v_cvt_pk_bf16_f32 v14, v100, v101
    v_cvt_pk_bf16_f32 v15, v102, v103
    v_subrev_u32 v11, 640, v9
    v_cmp_le_u32 vcc, 640, v11
    s_nop 1
    v_cndmask_b32 v16, 0, 1, vcc
    v_mul_u32_u24 v17, 640, v16
    v_sub_u32 v17, v11, v17
    v_lshrrev_b32 v18, 2, v17
    v_mul_u32_u24 v12, 52429, v18
    v_lshrrev_b32 v12, 18, v12
    v_mul_u32_u24 v13, 20, v12
    v_sub_u32 v13, v17, v13
    v_mov_b32 v11, v16
    v_cmp_le_u32 vcc, 640, v9
    v_cmp_gt_u32 s[52:53], 20, v13
    s_nop 1
    s_and_b64 vcc, vcc, s[52:53]
    s_and_saveexec_b64 s[50:51], vcc
    v_lshlrev_b32 v16, 17, v12
    v_lshl_add_u32 v16, v8, 6, v16
    v_lshrrev_b32 v17, 3, v13
    v_lshrrev_b32 v18, 2, v8
    v_and_b32 v18, 3, v18
    v_xor_b32 v17, v17, v18
    v_lshl_add_u32 v17, v17, 4, v16
    v_and_b32 v18, 7, v13
    v_lshl_add_u32 v17, v18, 1, v17
    v_lshl_add_u32 v16, v13, 1, v16
    v_cmp_eq_u32 vcc, 0, v11
    s_and_saveexec_b64 s[52:53], vcc
    buffer_store_dwordx2 v[14:15], v17, s[24:27], 0 offen
    v_cmp_eq_u32 vcc, 16, v13
    s_and_saveexec_b64 s[54:55], vcc
    v_mov_b32 v18, 0
    v_mov_b32 v19, 0
    buffer_store_dwordx2 v[18:19], v17, s[24:27], 0 offen offset:8
    v_lshrrev_b32 v18, 2, v8
    v_and_b32 v18, 3, v18
    v_xor_b32 v18, 3, v18
    v_and_b32 v19, 0xffffffc0, v17
    v_lshl_add_u32 v18, v18, 4, v19
    v_mov_b32 v28, 0
    v_mov_b32 v29, 0
    v_mov_b32 v30, 0
    v_mov_b32 v31, 0
    buffer_store_dwordx4 v[28:31], v18, s[24:27], 0 offen
    s_mov_b64 exec, s[50:51]
    v_cmp_ne_u32 vcc, 0, v11
    v_cmp_le_u32 s[52:53], s56, v9
    s_and_b64 vcc, vcc, s[52:53]
    v_cmp_gt_u32 s[52:53], 20, v13
    s_nop 1
    s_and_b64 vcc, vcc, s[52:53]
    s_and_saveexec_b64 s[52:53], vcc
    buffer_store_dwordx2 v[14:15], v16, s[28:31], 0 offen
    v_cmp_eq_u32 vcc, 16, v13
    s_and_saveexec_b64 s[54:55], vcc
    v_mov_b32 v18, 0x3f80
    v_mov_b32 v19, 0
    buffer_store_dwordx2 v[18:19], v16, s[28:31], 0 offen offset:8
    s_mov_b64 exec, -1
    v_add_u32 v9, 48, v5
    v_cmp_gt_u32 vcc, 640, v9
    s_and_saveexec_b64 s[50:51], vcc
    v_mul_f32 v16, s49, v104
    v_mul_f32 v17, s49, v105
    v_mul_f32 v18, s49, v106
    v_mul_f32 v19, s49, v107
    v_cvt_pk_bf16_f32 v14, v16, v17
    v_cvt_pk_bf16_f32 v15, v18, v19
    v_mul_u32_u24 v10, 1280, v8
    v_lshl_add_u32 v10, v9, 1, v10
    buffer_store_dwordx2 v[14:15], v10, s[20:23], 0 offen
    s_mov_b64 exec, s[50:51]
    v_cvt_pk_bf16_f32 v14, v104, v105
    v_cvt_pk_bf16_f32 v15, v106, v107
    v_subrev_u32 v11, 640, v9
    v_cmp_le_u32 vcc, 640, v11
    s_nop 1
    v_cndmask_b32 v16, 0, 1, vcc
    v_mul_u32_u24 v17, 640, v16
    v_sub_u32 v17, v11, v17
    v_lshrrev_b32 v18, 2, v17
    v_mul_u32_u24 v12, 52429, v18
    v_lshrrev_b32 v12, 18, v12
    v_mul_u32_u24 v13, 20, v12
    v_sub_u32 v13, v17, v13
    v_mov_b32 v11, v16
    v_cmp_le_u32 vcc, 640, v9
    v_cmp_gt_u32 s[52:53], 20, v13
    s_nop 1
    s_and_b64 vcc, vcc, s[52:53]
    s_and_saveexec_b64 s[50:51], vcc
    v_lshlrev_b32 v16, 17, v12
    v_lshl_add_u32 v16, v8, 6, v16
    v_lshrrev_b32 v17, 3, v13
    v_lshrrev_b32 v18, 2, v8
    v_and_b32 v18, 3, v18
    v_xor_b32 v17, v17, v18
    v_lshl_add_u32 v17, v17, 4, v16
    v_and_b32 v18, 7, v13
    v_lshl_add_u32 v17, v18, 1, v17
    v_lshl_add_u32 v16, v13, 1, v16
    v_cmp_eq_u32 vcc, 0, v11
    s_and_saveexec_b64 s[52:53], vcc
    buffer_store_dwordx2 v[14:15], v17, s[24:27], 0 offen
    v_cmp_eq_u32 vcc, 16, v13
    s_and_saveexec_b64 s[54:55], vcc
    v_mov_b32 v18, 0
    v_mov_b32 v19, 0
    buffer_store_dwordx2 v[18:19], v17, s[24:27], 0 offen offset:8
    v_lshrrev_b32 v18, 2, v8
    v_and_b32 v18, 3, v18
    v_xor_b32 v18, 3, v18
    v_and_b32 v19, 0xffffffc0, v17
    v_lshl_add_u32 v18, v18, 4, v19
    v_mov_b32 v28, 0
    v_mov_b32 v29, 0
    v_mov_b32 v30, 0
    v_mov_b32 v31, 0
    buffer_store_dwordx4 v[28:31], v18, s[24:27], 0 offen
    s_mov_b64 exec, s[50:51]
    v_cmp_ne_u32 vcc, 0, v11
    v_cmp_le_u32 s[52:53], s56, v9
    s_and_b64 vcc, vcc, s[52:53]
    v_cmp_gt_u32 s[52:53], 20, v13
    s_nop 1
    s_and_b64 vcc, vcc, s[52:53]
    s_and_saveexec_b64 s[52:53], vcc
    buffer_store_dwordx2 v[14:15], v16, s[28:31], 0 offen
    v_cmp_eq_u32 vcc, 16, v13
    s_and_saveexec_b64 s[54:55], vcc
    v_mov_b32 v18, 0x3f80
    v_mov_b32 v19, 0
    buffer_store_dwordx2 v[18:19], v16, s[28:31], 0 offen offset:8
    s_mov_b64 exec, -1
    v_add_u32 v9, 56, v5
    v_cmp_gt_u32 vcc, 640, v9
    s_and_saveexec_b64 s[50:51], vcc
    v_mul_f32 v16, s49, v108
    v_mul_f32 v17, s49, v109
    v_mul_f32 v18, s49, v110
    v_mul_f32 v19, s49, v111
    v_cvt_pk_bf16_f32 v14, v16, v17
    v_cvt_pk_bf16_f32 v15, v18, v19
    v_mul_u32_u24 v10, 1280, v8
    v_lshl_add_u32 v10, v9, 1, v10
    buffer_store_dwordx2 v[14:15], v10, s[20:23], 0 offen
    s_mov_b64 exec, s[50:51]
    v_cvt_pk_bf16_f32 v14, v108, v109
    v_cvt_pk_bf16_f32 v15, v110, v111
    v_subrev_u32 v11, 640, v9
    v_cmp_le_u32 vcc, 640, v11
    s_nop 1
    v_cndmask_b32 v16, 0, 1, vcc
    v_mul_u32_u24 v17, 640, v16
    v_sub_u32 v17, v11, v17
    v_lshrrev_b32 v18, 2, v17
    v_mul_u32_u24 v12, 52429, v18
    v_lshrrev_b32 v12, 18, v12
    v_mul_u32_u24 v13, 20, v12
    v_sub_u32 v13, v17, v13
    v_mov_b32 v11, v16
    v_cmp_le_u32 vcc, 640, v9
    v_cmp_gt_u32 s[52:53], 20, v13
    s_nop 1
    s_and_b64 vcc, vcc, s[52:53]
    s_and_saveexec_b64 s[50:51], vcc
    v_lshlrev_b32 v16, 17, v12
    v_lshl_add_u32 v16, v8, 6, v16
    v_lshrrev_b32 v17, 3, v13
    v_lshrrev_b32 v18, 2, v8
    v_and_b32 v18, 3, v18
    v_xor_b32 v17, v17, v18
    v_lshl_add_u32 v17, v17, 4, v16
    v_and_b32 v18, 7, v13
    v_lshl_add_u32 v17, v18, 1, v17
    v_lshl_add_u32 v16, v13, 1, v16
    v_cmp_eq_u32 vcc, 0, v11
    s_and_saveexec_b64 s[52:53], vcc
    buffer_store_dwordx2 v[14:15], v17, s[24:27], 0 offen
    v_cmp_eq_u32 vcc, 16, v13
    s_and_saveexec_b64 s[54:55], vcc
    v_mov_b32 v18, 0
    v_mov_b32 v19, 0
    buffer_store_dwordx2 v[18:19], v17, s[24:27], 0 offen offset:8
    v_lshrrev_b32 v18, 2, v8
    v_and_b32 v18, 3, v18
    v_xor_b32 v18, 3, v18
    v_and_b32 v19, 0xffffffc0, v17
    v_lshl_add_u32 v18, v18, 4, v19
    v_mov_b32 v28, 0
    v_mov_b32 v29, 0
    v_mov_b32 v30, 0
    v_mov_b32 v31, 0
    buffer_store_dwordx4 v[28:31], v18, s[24:27], 0 offen
    s_mov_b64 exec, s[50:51]
    v_cmp_ne_u32 vcc, 0, v11
    v_cmp_le_u32 s[52:53], s56, v9
    s_and_b64 vcc, vcc, s[52:53]
    v_cmp_gt_u32 s[52:53], 20, v13
    s_nop 1
    s_and_b64 vcc, vcc, s[52:53]
    s_and_saveexec_b64 s[52:53], vcc
    buffer_store_dwordx2 v[14:15], v16, s[28:31], 0 offen
    v_cmp_eq_u32 vcc, 16, v13
    s_and_saveexec_b64 s[54:55], vcc
    v_mov_b32 v18, 0x3f80
    v_mov_b32 v19, 0
    buffer_store_dwordx2 v[18:19], v16, s[28:31], 0 offen offset:8
    s_mov_b64 exec, -1
    v_add_u32 v8, 32, v4
    v_fma_f32 v112, -v21, v48, v112
    v_mul_f32 v112, v23, v112
    v_fma_f32 v113, -v21, v49, v113
    v_mul_f32 v113, v23, v113
    v_fma_f32 v114, -v21, v50, v114
    v_mul_f32 v114, v23, v114
    v_fma_f32 v115, -v21, v51, v115
    v_mul_f32 v115, v23, v115
    v_fma_f32 v116, -v21, v52, v116
    v_mul_f32 v116, v23, v116
    v_fma_f32 v117, -v21, v53, v117
    v_mul_f32 v117, v23, v117
    v_fma_f32 v118, -v21, v54, v118
    v_mul_f32 v118, v23, v118
    v_fma_f32 v119, -v21, v55, v119
    v_mul_f32 v119, v23, v119
    v_fma_f32 v120, -v21, v56, v120
    v_mul_f32 v120, v23, v120
    v_fma_f32 v121, -v21, v57, v121
    v_mul_f32 v121, v23, v121
    v_fma_f32 v122, -v21, v58, v122
    v_mul_f32 v122, v23, v122
    v_fma_f32 v123, -v21, v59, v123
    v_mul_f32 v123, v23, v123
    v_fma_f32 v124, -v21, v60, v124
    v_mul_f32 v124, v23, v124
    v_fma_f32 v125, -v21, v61, v125
    v_mul_f32 v125, v23, v125
    v_fma_f32 v126, -v21, v62, v126
    v_mul_f32 v126, v23, v126
    v_fma_f32 v127, -v21, v63, v127
    v_mul_f32 v127, v23, v127
    v_add_u32 v9, 32, v5
    v_cmp_gt_u32 vcc, 640, v9
    s_and_saveexec_b64 s[50:51], vcc
    v_mul_f32 v16, s49, v112
    v_mul_f32 v17, s49, v113
    v_mul_f32 v18, s49, v114
    v_mul_f32 v19, s49, v115
    v_cvt_pk_bf16_f32 v14, v16, v17
    v_cvt_pk_bf16_f32 v15, v18, v19
    v_mul_u32_u24 v10, 1280, v8
    v_lshl_add_u32 v10, v9, 1, v10
    buffer_store_dwordx2 v[14:15], v10, s[20:23], 0 offen
    s_mov_b64 exec, s[50:51]
    v_cvt_pk_bf16_f32 v14, v112, v113
    v_cvt_pk_bf16_f32 v15, v114, v115
    v_subrev_u32 v11, 640, v9
    v_cmp_le_u32 vcc, 640, v11
    s_nop 1
    v_cndmask_b32 v16, 0, 1, vcc
    v_mul_u32_u24 v17, 640, v16
    v_sub_u32 v17, v11, v17
    v_lshrrev_b32 v18, 2, v17
    v_mul_u32_u24 v12, 52429, v18
    v_lshrrev_b32 v12, 18, v12
    v_mul_u32_u24 v13, 20, v12
    v_sub_u32 v13, v17, v13
    v_mov_b32 v11, v16
    v_cmp_le_u32 vcc, 640, v9
    v_cmp_gt_u32 s[52:53], 20, v13
    s_nop 1
    s_and_b64 vcc, vcc, s[52:53]
    s_and_saveexec_b64 s[50:51], vcc
    v_lshlrev_b32 v16, 17, v12
    v_lshl_add_u32 v16, v8, 6, v16
    v_lshrrev_b32 v17, 3, v13
    v_lshrrev_b32 v18, 2, v8
    v_and_b32 v18, 3, v18
    v_xor_b32 v17, v17, v18
    v_lshl_add_u32 v17, v17, 4, v16
    v_and_b32 v18, 7, v13
    v_lshl_add_u32 v17, v18, 1, v17
    v_lshl_add_u32 v16, v13, 1, v16
    v_cmp_eq_u32 vcc, 0, v11
    s_and_saveexec_b64 s[52:53], vcc
    buffer_store_dwordx2 v[14:15], v17, s[24:27], 0 offen
    v_cmp_eq_u32 vcc, 16, v13
    s_and_saveexec_b64 s[54:55], vcc
    v_mov_b32 v18, 0
    v_mov_b32 v19, 0
    buffer_store_dwordx2 v[18:19], v17, s[24:27], 0 offen offset:8
    v_lshrrev_b32 v18, 2, v8
    v_and_b32 v18, 3, v18
    v_xor_b32 v18, 3, v18
    v_and_b32 v19, 0xffffffc0, v17
    v_lshl_add_u32 v18, v18, 4, v19
    v_mov_b32 v28, 0
    v_mov_b32 v29, 0
    v_mov_b32 v30, 0
    v_mov_b32 v31, 0
    buffer_store_dwordx4 v[28:31], v18, s[24:27], 0 offen
    s_mov_b64 exec, s[50:51]
    v_cmp_ne_u32 vcc, 0, v11
    v_cmp_le_u32 s[52:53], s56, v9
    s_and_b64 vcc, vcc, s[52:53]
    v_cmp_gt_u32 s[52:53], 20, v13
    s_nop 1
    s_and_b64 vcc, vcc, s[52:53]
    s_and_saveexec_b64 s[52:53], vcc
    buffer_store_dwordx2 v[14:15], v16, s[28:31], 0 offen
    v_cmp_eq_u32 vcc, 16, v13
    s_and_saveexec_b64 s[54:55], vcc
    v_mov_b32 v18, 0x3f80
    v_mov_b32 v19, 0
    buffer_store_dwordx2 v[18:19], v16, s[28:31], 0 offen offset:8
    s_mov_b64 exec, -1
    v_add_u32 v9, 40, v5
    v_cmp_gt_u32 vcc, 640, v9
    s_and_saveexec_b64 s[50:51], vcc
    v_mul_f32 v16, s49, v116
    v_mul_f32 v17, s49, v117
    v_mul_f32 v18, s49, v118
    v_mul_f32 v19, s49, v119
    v_cvt_pk_bf16_f32 v14, v16, v17
    v_cvt_pk_bf16_f32 v15, v18, v19
    v_mul_u32_u24 v10, 1280, v8
    v_lshl_add_u32 v10, v9, 1, v10
    buffer_store_dwordx2 v[14:15], v10, s[20:23], 0 offen
    s_mov_b64 exec, s[50:51]
    v_cvt_pk_bf16_f32 v14, v116, v117
    v_cvt_pk_bf16_f32 v15, v118, v119
    v_subrev_u32 v11, 640, v9
    v_cmp_le_u32 vcc, 640, v11
    s_nop 1
    v_cndmask_b32 v16, 0, 1, vcc
    v_mul_u32_u24 v17, 640, v16
    v_sub_u32 v17, v11, v17
    v_lshrrev_b32 v18, 2, v17
    v_mul_u32_u24 v12, 52429, v18
    v_lshrrev_b32 v12, 18, v12
    v_mul_u32_u24 v13, 20, v12
    v_sub_u32 v13, v17, v13
    v_mov_b32 v11, v16
    v_cmp_le_u32 vcc, 640, v9
    v_cmp_gt_u32 s[52:53], 20, v13
    s_nop 1
    s_and_b64 vcc, vcc, s[52:53]
    s_and_saveexec_b64 s[50:51], vcc
    v_lshlrev_b32 v16, 17, v12
    v_lshl_add_u32 v16, v8, 6, v16
    v_lshrrev_b32 v17, 3, v13
    v_lshrrev_b32 v18, 2, v8
    v_and_b32 v18, 3, v18
    v_xor_b32 v17, v17, v18
    v_lshl_add_u32 v17, v17, 4, v16
    v_and_b32 v18, 7, v13
    v_lshl_add_u32 v17, v18, 1, v17
    v_lshl_add_u32 v16, v13, 1, v16
    v_cmp_eq_u32 vcc, 0, v11
    s_and_saveexec_b64 s[52:53], vcc
    buffer_store_dwordx2 v[14:15], v17, s[24:27], 0 offen
    v_cmp_eq_u32 vcc, 16, v13
    s_and_saveexec_b64 s[54:55], vcc
    v_mov_b32 v18, 0
    v_mov_b32 v19, 0
    buffer_store_dwordx2 v[18:19], v17, s[24:27], 0 offen offset:8
    v_lshrrev_b32 v18, 2, v8
    v_and_b32 v18, 3, v18
    v_xor_b32 v18, 3, v18
    v_and_b32 v19, 0xffffffc0, v17
    v_lshl_add_u32 v18, v18, 4, v19
    v_mov_b32 v28, 0
    v_mov_b32 v29, 0
    v_mov_b32 v30, 0
    v_mov_b32 v31, 0
    buffer_store_dwordx4 v[28:31], v18, s[24:27], 0 offen
    s_mov_b64 exec, s[50:51]
    v_cmp_ne_u32 vcc, 0, v11
    v_cmp_le_u32 s[52:53], s56, v9
    s_and_b64 vcc, vcc, s[52:53]
    v_cmp_gt_u32 s[52:53], 20, v13
    s_nop 1
    s_and_b64 vcc, vcc, s[52:53]
    s_and_saveexec_b64 s[52:53], vcc
    buffer_store_dwordx2 v[14:15], v16, s[28:31], 0 offen
    v_cmp_eq_u32 vcc, 16, v13
    s_and_saveexec_b64 s[54:55], vcc
    v_mov_b32 v18, 0x3f80
    v_mov_b32 v19, 0
    buffer_store_dwordx2 v[18:19], v16, s[28:31], 0 offen offset:8
    s_mov_b64 exec, -1
    v_add_u32 v9, 48, v5
    v_cmp_gt_u32 vcc, 640, v9
    s_and_saveexec_b64 s[50:51], vcc
    v_mul_f32 v16, s49, v120
    v_mul_f32 v17, s49, v121
    v_mul_f32 v18, s49, v122
    v_mul_f32 v19, s49, v123
    v_cvt_pk_bf16_f32 v14, v16, v17
    v_cvt_pk_bf16_f32 v15, v18, v19
    v_mul_u32_u24 v10, 1280, v8
    v_lshl_add_u32 v10, v9, 1, v10
    buffer_store_dwordx2 v[14:15], v10, s[20:23], 0 offen
    s_mov_b64 exec, s[50:51]
    v_cvt_pk_bf16_f32 v14, v120, v121
    v_cvt_pk_bf16_f32 v15, v122, v123
    v_subrev_u32 v11, 640, v9
    v_cmp_le_u32 vcc, 640, v11
    s_nop 1
    v_cndmask_b32 v16, 0, 1, vcc
    v_mul_u32_u24 v17, 640, v16
    v_sub_u32 v17, v11, v17
    v_lshrrev_b32 v18, 2, v17
    v_mul_u32_u24 v12, 52429, v18
    v_lshrrev_b32 v12, 18, v12
    v_mul_u32_u24 v13, 20, v12
    v_sub_u32 v13, v17, v13
    v_mov_b32 v11, v16
    v_cmp_le_u32 vcc, 640, v9
    v_cmp_gt_u32 s[52:53], 20, v13
    s_nop 1
    s_and_b64 vcc, vcc, s[52:53]
    s_and_saveexec_b64 s[50:51], vcc
    v_lshlrev_b32 v16, 17, v12
    v_lshl_add_u32 v16, v8, 6, v16
    v_lshrrev_b32 v17, 3, v13
    v_lshrrev_b32 v18, 2, v8
    v_and_b32 v18, 3, v18
    v_xor_b32 v17, v17, v18
    v_lshl_add_u32 v17, v17, 4, v16
    v_and_b32 v18, 7, v13
    v_lshl_add_u32 v17, v18, 1, v17
    v_lshl_add_u32 v16, v13, 1, v16
    v_cmp_eq_u32 vcc, 0, v11
    s_and_saveexec_b64 s[52:53], vcc
    buffer_store_dwordx2 v[14:15], v17, s[24:27], 0 offen
    v_cmp_eq_u32 vcc, 16, v13
    s_and_saveexec_b64 s[54:55], vcc
    v_mov_b32 v18, 0
    v_mov_b32 v19, 0
    buffer_store_dwordx2 v[18:19], v17, s[24:27], 0 offen offset:8
    v_lshrrev_b32 v18, 2, v8
    v_and_b32 v18, 3, v18
    v_xor_b32 v18, 3, v18
    v_and_b32 v19, 0xffffffc0, v17
    v_lshl_add_u32 v18, v18, 4, v19
    v_mov_b32 v28, 0
    v_mov_b32 v29, 0
    v_mov_b32 v30, 0
    v_mov_b32 v31, 0
    buffer_store_dwordx4 v[28:31], v18, s[24:27], 0 offen
    s_mov_b64 exec, s[50:51]
    v_cmp_ne_u32 vcc, 0, v11
    v_cmp_le_u32 s[52:53], s56, v9
    s_and_b64 vcc, vcc, s[52:53]
    v_cmp_gt_u32 s[52:53], 20, v13
    s_nop 1
    s_and_b64 vcc, vcc, s[52:53]
    s_and_saveexec_b64 s[52:53], vcc
    buffer_store_dwordx2 v[14:15], v16, s[28:31], 0 offen
    v_cmp_eq_u32 vcc, 16, v13
    s_and_saveexec_b64 s[54:55], vcc
    v_mov_b32 v18, 0x3f80
    v_mov_b32 v19, 0
    buffer_store_dwordx2 v[18:19], v16, s[28:31], 0 offen offset:8
    s_mov_b64 exec, -1
    v_add_u32 v9, 56, v5
    v_cmp_gt_u32 vcc, 640, v9
    s_and_saveexec_b64 s[50:51], vcc
    v_mul_f32 v16, s49, v124
    v_mul_f32 v17, s49, v125
    v_mul_f32 v18, s49, v126
    v_mul_f32 v19, s49, v127
    v_cvt_pk_bf16_f32 v14, v16, v17
    v_cvt_pk_bf16_f32 v15, v18, v19
    v_mul_u32_u24 v10, 1280, v8
    v_lshl_add_u32 v10, v9, 1, v10
    buffer_store_dwordx2 v[14:15], v10, s[20:23], 0 offen
    s_mov_b64 exec, s[50:51]
    v_cvt_pk_bf16_f32 v14, v124, v125
    v_cvt_pk_bf16_f32 v15, v126, v127
    v_subrev_u32 v11, 640, v9
    v_cmp_le_u32 vcc, 640, v11
    s_nop 1
    v_cndmask_b32 v16, 0, 1, vcc
    v_mul_u32_u24 v17, 640, v16
    v_sub_u32 v17, v11, v17
    v_lshrrev_b32 v18, 2, v17
    v_mul_u32_u24 v12, 52429, v18
    v_lshrrev_b32 v12, 18, v12
    v_mul_u32_u24 v13, 20, v12
    v_sub_u32 v13, v17, v13
    v_mov_b32 v11, v16
    v_cmp_le_u32 vcc, 640, v9
    v_cmp_gt_u32 s[52:53], 20, v13
    s_nop 1
    s_and_b64 vcc, vcc, s[52:53]
    s_and_saveexec_b64 s[50:51], vcc
    v_lshlrev_b32 v16, 17, v12
    v_lshl_add_u32 v16, v8, 6, v16
    v_lshrrev_b32 v17, 3, v13
    v_lshrrev_b32 v18, 2, v8
    v_and_b32 v18, 3, v18
    v_xor_b32 v17, v17, v18
    v_lshl_add_u32 v17, v17, 4, v16
    v_and_b32 v18, 7, v13
    v_lshl_add_u32 v17, v18, 1, v17
    v_lshl_add_u32 v16, v13, 1, v16
    v_cmp_eq_u32 vcc, 0, v11
    s_and_saveexec_b64 s[52:53], vcc
    buffer_store_dwordx2 v[14:15], v17, s[24:27], 0 offen
    v_cmp_eq_u32 vcc, 16, v13
    s_and_saveexec_b64 s[54:55], vcc
    v_mov_b32 v18, 0
    v_mov_b32 v19, 0
    buffer_store_dwordx2 v[18:19], v17, s[24:27], 0 offen offset:8
    v_lshrrev_b32 v18, 2, v8
    v_and_b32 v18, 3, v18
    v_xor_b32 v18, 3, v18
    v_and_b32 v19, 0xffffffc0, v17
    v_lshl_add_u32 v18, v18, 4, v19
    v_mov_b32 v28, 0
    v_mov_b32 v29, 0
    v_mov_b32 v30, 0
    v_mov_b32 v31, 0
    buffer_store_dwordx4 v[28:31], v18, s[24:27], 0 offen
    s_mov_b64 exec, s[50:51]
    v_cmp_ne_u32 vcc, 0, v11
    v_cmp_le_u32 s[52:53], s56, v9
    s_and_b64 vcc, vcc, s[52:53]
    v_cmp_gt_u32 s[52:53], 20, v13
    s_nop 1
    s_and_b64 vcc, vcc, s[52:53]
    s_and_saveexec_b64 s[52:53], vcc
    buffer_store_dwordx2 v[14:15], v16, s[28:31], 0 offen
    v_cmp_eq_u32 vcc, 16, v13
    s_and_saveexec_b64 s[54:55], vcc
    v_mov_b32 v18, 0x3f80
    v_mov_b32 v19, 0
    buffer_store_dwordx2 v[18:19], v16, s[28:31], 0 offen offset:8
    s_mov_b64 exec, -1
    s_waitcnt vmcnt(0)
il_qkvB1_kernel_done:
    s_endpgm
.globl il_opB1_kernel
.p2align 8
.type il_opB1_kernel,@function
il_opB1_kernel:
    s_cmp_ge_u32 s2, 160
    s_cbranch_scc1 il_opB1_kernel_done
    s_load_dwordx2 s[4:5], s[0:1], 80
    s_load_dwordx2 s[12:13], s[0:1], 56
    s_load_dwordx2 s[42:43], s[0:1], 64
    s_and_b32 s34, s2, 15
    s_lshr_b32 s35, s2, 4
    s_mov_b32 s37, s35
    s_mul_i32 s34, s34, 128
    s_mul_i32 s35, s35, 64
    v_and_b32 v1, 63, v0
    v_lshrrev_b32 v2, 6, v0
    v_lshrrev_b32 v3, 5, v1
    s_waitcnt lgkmcnt(0)
    s_add_u32 s8, s4, 10485760
    s_addc_u32 s9, s5, 0
    s_mov_b32 s10, 2621440
    s_mov_b32 s11, 0x00020000
    s_mov_b32 s14, 819200
    s_mov_b32 s15, 0x00020000
    s_mov_b32 s20, s42
    s_mov_b32 s21, s43
    s_mov_b32 s22, 2621440
    s_mov_b32 s23, 0x00020000
    s_add_u32 s24, s4, 5242880
    s_addc_u32 s25, s5, 0
    s_mov_b32 s26, 2621440
    s_mov_b32 s27, 0x00020000
    s_mov_b32 s36, 0x3f803f80
    v_lshrrev_b32 v17, 3, v1
    v_mul_u32_u24 v18, 32, v2
    v_add_u32 v18, v18, v17
    v_and_b32 v19, 7, v1
    v_lshrrev_b32 v16, 1, v17
    v_xor_b32 v16, v16, v19
    v_lshlrev_b32 v16, 4, v16
    v_add_u32 v4, s34, v18
    v_add_u32 v4, 0, v4
    s_mov_b32 s3, 1280
    v_mul_lo_u32 v4, v4, s3
    v_add_u32 v4, v4, v16
    v_lshrrev_b32 v16, 1, v17
    v_xor_b32 v16, 4, v16
    v_xor_b32 v16, v16, v19
    v_lshlrev_b32 v16, 4, v16
    v_add_u32 v5, s34, v18
    v_add_u32 v5, 8, v5
    s_mov_b32 s3, 1280
    v_mul_lo_u32 v5, v5, s3
    v_add_u32 v5, v5, v16
    v_lshrrev_b32 v16, 1, v17
    v_xor_b32 v16, v16, v19
    v_lshlrev_b32 v16, 4, v16
    v_add_u32 v6, s34, v18
    v_add_u32 v6, 16, v6
    s_mov_b32 s3, 1280
    v_mul_lo_u32 v6, v6, s3
    v_add_u32 v6, v6, v16
    v_lshrrev_b32 v16, 1, v17
    v_xor_b32 v16, 4, v16
    v_xor_b32 v16, v16, v19
    v_lshlrev_b32 v16, 4, v16
    v_add_u32 v7, s34, v18
    v_add_u32 v7, 24, v7
    s_mov_b32 s3, 1280
    v_mul_lo_u32 v7, v7, s3
    v_add_u32 v7, v7, v16
    v_lshrrev_b32 v16, 2, v1
    v_lshl_add_u32 v16, v2, 4, v16
    v_and_b32 v17, 3, v1
    v_lshlrev_b32 v17, 4, v17
    s_mov_b32 s38, 1280
    s_mov_b32 s39, s35
    v_mul_lo_u32 v16, v16, s38
    v_add_u32 v16, v16, v17
    s_lshl_b32 s3, s39, 1
    v_add_u32 v8, s3, v16
    v_add_u32 v9, 64, v8
    v_and_b32 v16, 31, v1
    v_and_b32 v17, 1, v2
    v_mul_u32_u24 v17, 64, v17
    v_add_u32 v17, v17, v16
    v_lshrrev_b32 v16, 1, v16
    v_and_b32 v16, 7, v16
    v_lshlrev_b32 v17, 7, v17
    v_add_u32 v18, 0, v3
    v_xor_b32 v18, v18, v16
    v_lshl_add_u32 v12, v18, 4, v17
    v_add_u32 v18, 2, v3
    v_xor_b32 v18, v18, v16
    v_lshl_add_u32 v13, v18, 4, v17
    v_add_u32 v18, 4, v3
    v_xor_b32 v18, v18, v16
    v_lshl_add_u32 v14, v18, 4, v17
    v_add_u32 v18, 6, v3
    v_xor_b32 v18, v18, v16
    v_lshl_add_u32 v15, v18, 4, v17
    v_lshrrev_b32 v17, 4, v1
    v_and_b32 v17, 1, v17
    v_lshlrev_b32 v17, 5, v17
    v_and_b32 v18, 15, v1
    v_lshrrev_b32 v18, 2, v18
    v_lshl_add_u32 v18, v3, 3, v18
    v_lshl_add_u32 v17, v18, 6, v17
    v_and_b32 v18, 3, v1
    v_lshl_add_u32 v17, v18, 3, v17
    v_lshrrev_b32 v18, 1, v2
    v_mul_u32_u24 v18, 4096, v18
    v_add3_u32 v16, v17, v18, 0
    v_add_u32 v16, 16384, v16
    v_mov_b32 v64, 0
    v_mov_b32 v65, 0
    v_mov_b32 v66, 0
    v_mov_b32 v67, 0
    v_mov_b32 v68, 0
    v_mov_b32 v69, 0
    v_mov_b32 v70, 0
    v_mov_b32 v71, 0
    v_mov_b32 v72, 0
    v_mov_b32 v73, 0
    v_mov_b32 v74, 0
    v_mov_b32 v75, 0
    v_mov_b32 v76, 0
    v_mov_b32 v77, 0
    v_mov_b32 v78, 0
    v_mov_b32 v79, 0
    v_mov_b32 v80, 0
    v_mov_b32 v81, 0
    v_mov_b32 v82, 0
    v_mov_b32 v83, 0
    v_mov_b32 v84, 0
    v_mov_b32 v85, 0
    v_mov_b32 v86, 0
    v_mov_b32 v87, 0
    v_mov_b32 v88, 0
    v_mov_b32 v89, 0
    v_mov_b32 v90, 0
    v_mov_b32 v91, 0
    v_mov_b32 v92, 0
    v_mov_b32 v93, 0
    v_mov_b32 v94, 0
    v_mov_b32 v95, 0
    v_mov_b32 v20, 0
    v_mov_b32 v21, 0
    v_mov_b32 v22, 0
    v_mov_b32 v23, 0
    v_mov_b32 v24, 0
    v_mov_b32 v25, 0
    v_mov_b32 v26, 0
    v_mov_b32 v27, 0
    s_mov_b32 s32, 0
    s_mov_b32 s33, 0
    v_readfirstlane_b32 s3, v2
    s_mul_i32 s3, s3, 4096
    s_add_u32 s3, s3, 0
    s_mov_b32 m0, s3
    s_nop 0
    buffer_load_dwordx4 v4, s[8:11], s32 offen lds
    v_readfirstlane_b32 s3, v2
    s_mul_i32 s3, s3, 4096
    s_add_u32 s3, s3, 1024
    s_mov_b32 m0, s3
    s_nop 0
    buffer_load_dwordx4 v5, s[8:11], s32 offen lds
    v_readfirstlane_b32 s3, v2
    s_mul_i32 s3, s3, 4096
    s_add_u32 s3, s3, 2048
    s_mov_b32 m0, s3
    s_nop 0
    buffer_load_dwordx4 v6, s[8:11], s32 offen lds
    v_readfirstlane_b32 s3, v2
    s_mul_i32 s3, s3, 4096
    s_add_u32 s3, s3, 3072
    s_mov_b32 m0, s3
    s_nop 0
    buffer_load_dwordx4 v7, s[8:11], s32 offen lds
    v_readfirstlane_b32 s3, v2
    s_lshl_b32 s3, s3, 10
    s_add_u32 s3, s3, 16384
    s_mov_b32 m0, s3
    s_nop 0
    buffer_load_dwordx4 v8, s[12:15], s33 offen lds
    v_readfirstlane_b32 s3, v2
    s_lshl_b32 s3, s3, 10
    s_add_u32 s3, s3, 20480
    s_mov_b32 m0, s3
    s_nop 0
    buffer_load_dwordx4 v9, s[12:15], s33 offen lds
    s_add_u32 s32, s32, 128
    s_mul_i32 s3, s38, 64
    s_add_u32 s33, s33, s3
    s_mov_b32 s48, 0
il_opB1_kernel_loop:
    s_waitcnt vmcnt(0)
    s_barrier
    s_add_u32 s3, s48, 0
    s_cmp_ge_u32 s3, 9
    s_cbranch_scc1 il_opB1_kernel_nopf0
    v_readfirstlane_b32 s3, v2
    s_mul_i32 s3, s3, 4096
    s_add_u32 s3, s3, 24576
    s_mov_b32 m0, s3
    s_nop 0
    buffer_load_dwordx4 v4, s[8:11], s32 offen lds
    v_readfirstlane_b32 s3, v2
    s_mul_i32 s3, s3, 4096
    s_add_u32 s3, s3, 25600
    s_mov_b32 m0, s3
    s_nop 0
    buffer_load_dwordx4 v5, s[8:11], s32 offen lds
    v_readfirstlane_b32 s3, v2
    s_mul_i32 s3, s3, 4096
    s_add_u32 s3, s3, 26624
    s_mov_b32 m0, s3
    s_nop 0
    buffer_load_dwordx4 v6, s[8:11], s32 offen lds
    v_readfirstlane_b32 s3, v2
    s_mul_i32 s3, s3, 4096
    s_add_u32 s3, s3, 27648
    s_mov_b32 m0, s3
    s_nop 0
    buffer_load_dwordx4 v7, s[8:11], s32 offen lds
    v_readfirstlane_b32 s3, v2
    s_lshl_b32 s3, s3, 10
    s_add_u32 s3, s3, 40960
    s_mov_b32 m0, s3
    s_nop 0
    buffer_load_dwordx4 v8, s[12:15], s33 offen lds
    v_readfirstlane_b32 s3, v2
    s_lshl_b32 s3, s3, 10
    s_add_u32 s3, s3, 45056
    s_mov_b32 m0, s3
    s_nop 0
    buffer_load_dwordx4 v9, s[12:15], s33 offen lds
    s_add_u32 s32, s32, 128
    s_mul_i32 s3, s38, 64
    s_add_u32 s33, s33, s3
il_opB1_kernel_nopf0:
    ds_read_b128 v[32:35], v12 offset:0
    ds_read_b128 v[36:39], v12 offset:4096
    ds_read_b64_tr_b16 v[40:41], v16 offset:0
    ds_read_b64_tr_b16 v[42:43], v16 offset:256
    s_waitcnt lgkmcnt(0)
    ds_read_b128 v[44:47], v13 offset:0
    ds_read_b128 v[48:51], v13 offset:4096
    ds_read_b64_tr_b16 v[52:53], v16 offset:1024
    ds_read_b64_tr_b16 v[54:55], v16 offset:1280
    v_mfma_f32_32x32x16_bf16 v[64:79], v[40:43], v[32:35], v[64:79]
    v_mfma_f32_32x32x16_bf16 v[80:95], v[40:43], v[36:39], v[80:95]
    s_waitcnt lgkmcnt(0)
    ds_read_b128 v[32:35], v14 offset:0
    ds_read_b128 v[36:39], v14 offset:4096
    ds_read_b64_tr_b16 v[40:41], v16 offset:2048
    ds_read_b64_tr_b16 v[42:43], v16 offset:2304
    v_mfma_f32_32x32x16_bf16 v[64:79], v[52:55], v[44:47], v[64:79]
    v_mfma_f32_32x32x16_bf16 v[80:95], v[52:55], v[48:51], v[80:95]
    s_waitcnt lgkmcnt(0)
    ds_read_b128 v[44:47], v15 offset:0
    ds_read_b128 v[48:51], v15 offset:4096
    ds_read_b64_tr_b16 v[52:53], v16 offset:3072
    ds_read_b64_tr_b16 v[54:55], v16 offset:3328
    v_mfma_f32_32x32x16_bf16 v[64:79], v[40:43], v[32:35], v[64:79]
    v_mfma_f32_32x32x16_bf16 v[80:95], v[40:43], v[36:39], v[80:95]
    s_waitcnt lgkmcnt(0)
    v_mfma_f32_32x32x16_bf16 v[64:79], v[52:55], v[44:47], v[64:79]
    v_mfma_f32_32x32x16_bf16 v[80:95], v[52:55], v[48:51], v[80:95]
    s_waitcnt vmcnt(0)
    s_barrier
    s_add_u32 s3, s48, 1
    s_cmp_ge_u32 s3, 9
    s_cbranch_scc1 il_opB1_kernel_nopf1
    v_readfirstlane_b32 s3, v2
    s_mul_i32 s3, s3, 4096
    s_add_u32 s3, s3, 0
    s_mov_b32 m0, s3
    s_nop 0
    buffer_load_dwordx4 v4, s[8:11], s32 offen lds
    v_readfirstlane_b32 s3, v2
    s_mul_i32 s3, s3, 4096
    s_add_u32 s3, s3, 1024
    s_mov_b32 m0, s3
    s_nop 0
    buffer_load_dwordx4 v5, s[8:11], s32 offen lds
    v_readfirstlane_b32 s3, v2
    s_mul_i32 s3, s3, 4096
    s_add_u32 s3, s3, 2048
    s_mov_b32 m0, s3
    s_nop 0
    buffer_load_dwordx4 v6, s[8:11], s32 offen lds
    v_readfirstlane_b32 s3, v2
    s_mul_i32 s3, s3, 4096
    s_add_u32 s3, s3, 3072
    s_mov_b32 m0, s3
    s_nop 0
    buffer_load_dwordx4 v7, s[8:11], s32 offen lds
    v_readfirstlane_b32 s3, v2
    s_lshl_b32 s3, s3, 10
    s_add_u32 s3, s3, 16384
    s_mov_b32 m0, s3
    s_nop 0
    buffer_load_dwordx4 v8, s[12:15], s33 offen lds
    v_readfirstlane_b32 s3, v2
    s_lshl_b32 s3, s3, 10
    s_add_u32 s3, s3, 20480
    s_mov_b32 m0, s3
    s_nop 0
    buffer_load_dwordx4 v9, s[12:15], s33 offen lds
    s_add_u32 s32, s32, 128
    s_mul_i32 s3, s38, 64
    s_add_u32 s33, s33, s3
il_opB1_kernel_nopf1:
    ds_read_b128 v[32:35], v12 offset:24576
    ds_read_b128 v[36:39], v12 offset:28672
    ds_read_b64_tr_b16 v[40:41], v16 offset:24576
    ds_read_b64_tr_b16 v[42:43], v16 offset:24832
    s_waitcnt lgkmcnt(0)
    ds_read_b128 v[44:47], v13 offset:24576
    ds_read_b128 v[48:51], v13 offset:28672
    ds_read_b64_tr_b16 v[52:53], v16 offset:25600
    ds_read_b64_tr_b16 v[54:55], v16 offset:25856
    v_mfma_f32_32x32x16_bf16 v[64:79], v[40:43], v[32:35], v[64:79]
    v_mfma_f32_32x32x16_bf16 v[80:95], v[40:43], v[36:39], v[80:95]
    s_waitcnt lgkmcnt(0)
    ds_read_b128 v[32:35], v14 offset:24576
    ds_read_b128 v[36:39], v14 offset:28672
    ds_read_b64_tr_b16 v[40:41], v16 offset:26624
    ds_read_b64_tr_b16 v[42:43], v16 offset:26880
    v_mfma_f32_32x32x16_bf16 v[64:79], v[52:55], v[44:47], v[64:79]
    v_mfma_f32_32x32x16_bf16 v[80:95], v[52:55], v[48:51], v[80:95]
    s_waitcnt lgkmcnt(0)
    ds_read_b128 v[44:47], v15 offset:24576
    ds_read_b128 v[48:51], v15 offset:28672
    ds_read_b64_tr_b16 v[52:53], v16 offset:27648
    ds_read_b64_tr_b16 v[54:55], v16 offset:27904
    v_mfma_f32_32x32x16_bf16 v[64:79], v[40:43], v[32:35], v[64:79]
    v_mfma_f32_32x32x16_bf16 v[80:95], v[40:43], v[36:39], v[80:95]
    s_waitcnt lgkmcnt(0)
    v_mfma_f32_32x32x16_bf16 v[64:79], v[52:55], v[44:47], v[64:79]
    v_mfma_f32_32x32x16_bf16 v[80:95], v[52:55], v[48:51], v[80:95]
    s_add_u32 s48, s48, 2
    s_cmp_lt_u32 s48, 10
    s_cbranch_scc1 il_opB1_kernel_loop
    s_nop 15
    s_nop 7
    v_and_b32 v4, 31, v1
    v_and_b32 v5, 1, v2
    v_mul_u32_u24 v5, 64, v5
    v_add3_u32 v4, v4, v5, s34
    v_lshrrev_b32 v5, 1, v2
    v_mul_u32_u24 v5, 32, v5
    v_lshl_add_u32 v5, v3, 2, v5
    v_add_u32 v5, s35, v5
    v_add_u32 v8, 0, v4
    v_add_u32 v9, 0, v5
    v_mul_u32_u24 v10, 1280, v8
    v_lshl_add_u32 v10, v9, 1, v10
    buffer_load_dwordx2 v[12:13], v10, s[24:27], 0 offen
    v_cvt_pk_bf16_f32 v14, v64, v65
    v_cvt_pk_bf16_f32 v15, v66, v67
    s_waitcnt vmcnt(0)
    v_lshlrev_b32 v16, 16, v14
    v_and_b32 v17, 0xffff0000, v14
    v_lshlrev_b32 v18, 16, v12
    v_and_b32 v19, 0xffff0000, v12
    v_add_f32 v16, v16, v18
    v_add_f32 v17, v17, v19
    v_cvt_pk_bf16_f32 v14, v16, v17
    v_lshlrev_b32 v16, 16, v15
    v_and_b32 v17, 0xffff0000, v15
    v_lshlrev_b32 v18, 16, v13
    v_and_b32 v19, 0xffff0000, v13
    v_add_f32 v16, v16, v18
    v_add_f32 v17, v17, v19
    v_cvt_pk_bf16_f32 v15, v16, v17
    buffer_store_dwordx2 v[14:15], v10, s[20:23], 0 offen
    v_add_u32 v9, 8, v5
    v_mul_u32_u24 v10, 1280, v8
    v_lshl_add_u32 v10, v9, 1, v10
    buffer_load_dwordx2 v[12:13], v10, s[24:27], 0 offen
    v_cvt_pk_bf16_f32 v14, v68, v69
    v_cvt_pk_bf16_f32 v15, v70, v71
    s_waitcnt vmcnt(0)
    v_lshlrev_b32 v16, 16, v14
    v_and_b32 v17, 0xffff0000, v14
    v_lshlrev_b32 v18, 16, v12
    v_and_b32 v19, 0xffff0000, v12
    v_add_f32 v16, v16, v18
    v_add_f32 v17, v17, v19
    v_cvt_pk_bf16_f32 v14, v16, v17
    v_lshlrev_b32 v16, 16, v15
    v_and_b32 v17, 0xffff0000, v15
    v_lshlrev_b32 v18, 16, v13
    v_and_b32 v19, 0xffff0000, v13
    v_add_f32 v16, v16, v18
    v_add_f32 v17, v17, v19
    v_cvt_pk_bf16_f32 v15, v16, v17
    buffer_store_dwordx2 v[14:15], v10, s[20:23], 0 offen
    v_add_u32 v9, 16, v5
    v_mul_u32_u24 v10, 1280, v8
    v_lshl_add_u32 v10, v9, 1, v10
    buffer_load_dwordx2 v[12:13], v10, s[24:27], 0 offen
    v_cvt_pk_bf16_f32 v14, v72, v73
    v_cvt_pk_bf16_f32 v15, v74, v75
    s_waitcnt vmcnt(0)
    v_lshlrev_b32 v16, 16, v14
    v_and_b32 v17, 0xffff0000, v14
    v_lshlrev_b32 v18, 16, v12
    v_and_b32 v19, 0xffff0000, v12
    v_add_f32 v16, v16, v18
    v_add_f32 v17, v17, v19
    v_cvt_pk_bf16_f32 v14, v16, v17
    v_lshlrev_b32 v16, 16, v15
    v_and_b32 v17, 0xffff0000, v15
    v_lshlrev_b32 v18, 16, v13
    v_and_b32 v19, 0xffff0000, v13
    v_add_f32 v16, v16, v18
    v_add_f32 v17, v17, v19
    v_cvt_pk_bf16_f32 v15, v16, v17
    buffer_store_dwordx2 v[14:15], v10, s[20:23], 0 offen
    v_add_u32 v9, 24, v5
    v_mul_u32_u24 v10, 1280, v8
    v_lshl_add_u32 v10, v9, 1, v10
    buffer_load_dwordx2 v[12:13], v10, s[24:27], 0 offen
    v_cvt_pk_bf16_f32 v14, v76, v77
    v_cvt_pk_bf16_f32 v15, v78, v79
    s_waitcnt vmcnt(0)
    v_lshlrev_b32 v16, 16, v14
    v_and_b32 v17, 0xffff0000, v14
    v_lshlrev_b32 v18, 16, v12
    v_and_b32 v19, 0xffff0000, v12
    v_add_f32 v16, v16, v18
    v_add_f32 v17, v17, v19
    v_cvt_pk_bf16_f32 v14, v16, v17
    v_lshlrev_b32 v16, 16, v15
    v_and_b32 v17, 0xffff0000, v15
    v_lshlrev_b32 v18, 16, v13
    v_and_b32 v19, 0xffff0000, v13
    v_add_f32 v16, v16, v18
    v_add_f32 v17, v17, v19
    v_cvt_pk_bf16_f32 v15, v16, v17
    buffer_store_dwordx2 v[14:15], v10, s[20:23], 0 offen
    v_add_u32 v8, 32, v4
    v_add_u32 v9, 0, v5
    v_mul_u32_u24 v10, 1280, v8
    v_lshl_add_u32 v10, v9, 1, v10
    buffer_load_dwordx2 v[12:13], v10, s[24:27], 0 offen
    v_cvt_pk_bf16_f32 v14, v80, v81
    v_cvt_pk_bf16_f32 v15, v82, v83
    s_waitcnt vmcnt(0)
    v_lshlrev_b32 v16, 16, v14
    v_and_b32 v17, 0xffff0000, v14
    v_lshlrev_b32 v18, 16, v12
    v_and_b32 v19, 0xffff0000, v12
    v_add_f32 v16, v16, v18
    v_add_f32 v17, v17, v19
    v_cvt_pk_bf16_f32 v14, v16, v17
    v_lshlrev_b32 v16, 16, v15
    v_and_b32 v17, 0xffff0000, v15
    v_lshlrev_b32 v18, 16, v13
    v_and_b32 v19, 0xffff0000, v13
    v_add_f32 v16, v16, v18
    v_add_f32 v17, v17, v19
    v_cvt_pk_bf16_f32 v15, v16, v17
    buffer_store_dwordx2 v[14:15], v10, s[20:23], 0 offen
    v_add_u32 v9, 8, v5
    v_mul_u32_u24 v10, 1280, v8
    v_lshl_add_u32 v10, v9, 1, v10
    buffer_load_dwordx2 v[12:13], v10, s[24:27], 0 offen
    v_cvt_pk_bf16_f32 v14, v84, v85
    v_cvt_pk_bf16_f32 v15, v86, v87
    s_waitcnt vmcnt(0)
    v_lshlrev_b32 v16, 16, v14
    v_and_b32 v17, 0xffff0000, v14
    v_lshlrev_b32 v18, 16, v12
    v_and_b32 v19, 0xffff0000, v12
    v_add_f32 v16, v16, v18
    v_add_f32 v17, v17, v19
    v_cvt_pk_bf16_f32 v14, v16, v17
    v_lshlrev_b32 v16, 16, v15
    v_and_b32 v17, 0xffff0000, v15
    v_lshlrev_b32 v18, 16, v13
    v_and_b32 v19, 0xffff0000, v13
    v_add_f32 v16, v16, v18
    v_add_f32 v17, v17, v19
    v_cvt_pk_bf16_f32 v15, v16, v17
    buffer_store_dwordx2 v[14:15], v10, s[20:23], 0 offen
    v_add_u32 v9, 16, v5
    v_mul_u32_u24 v10, 1280, v8
    v_lshl_add_u32 v10, v9, 1, v10
    buffer_load_dwordx2 v[12:13], v10, s[24:27], 0 offen
    v_cvt_pk_bf16_f32 v14, v88, v89
    v_cvt_pk_bf16_f32 v15, v90, v91
    s_waitcnt vmcnt(0)
    v_lshlrev_b32 v16, 16, v14
    v_and_b32 v17, 0xffff0000, v14
    v_lshlrev_b32 v18, 16, v12
    v_and_b32 v19, 0xffff0000, v12
    v_add_f32 v16, v16, v18
    v_add_f32 v17, v17, v19
    v_cvt_pk_bf16_f32 v14, v16, v17
    v_lshlrev_b32 v16, 16, v15
    v_and_b32 v17, 0xffff0000, v15
    v_lshlrev_b32 v18, 16, v13
    v_and_b32 v19, 0xffff0000, v13
    v_add_f32 v16, v16, v18
    v_add_f32 v17, v17, v19
    v_cvt_pk_bf16_f32 v15, v16, v17
    buffer_store_dwordx2 v[14:15], v10, s[20:23], 0 offen
    v_add_u32 v9, 24, v5
    v_mul_u32_u24 v10, 1280, v8
    v_lshl_add_u32 v10, v9, 1, v10
    buffer_load_dwordx2 v[12:13], v10, s[24:27], 0 offen
    v_cvt_pk_bf16_f32 v14, v92, v93
    v_cvt_pk_bf16_f32 v15, v94, v95
    s_waitcnt vmcnt(0)
    v_lshlrev_b32 v16, 16, v14
    v_and_b32 v17, 0xffff0000, v14
    v_lshlrev_b32 v18, 16, v12
    v_and_b32 v19, 0xffff0000, v12
    v_add_f32 v16, v16, v18
    v_add_f32 v17, v17, v19
    v_cvt_pk_bf16_f32 v14, v16, v17
    v_lshlrev_b32 v16, 16, v15
    v_and_b32 v17, 0xffff0000, v15
    v_lshlrev_b32 v18, 16, v13
    v_and_b32 v19, 0xffff0000, v13
    v_add_f32 v16, v16, v18
    v_add_f32 v17, v17, v19
    v_cvt_pk_bf16_f32 v15, v16, v17
    buffer_store_dwordx2 v[14:15], v10, s[20:23], 0 offen
    s_waitcnt vmcnt(0)
il_opB1_kernel_done:
    s_endpgm
.section .rodata,"a"
.p2align 6
.amdhsa_kernel il_qkvA0_kernel
  .amdhsa_next_free_vgpr 96
  .amdhsa_next_free_sgpr 64
  .amdhsa_accum_offset 96
  .amdhsa_group_segment_fixed_size 0
  .amdhsa_kernarg_size 88
  .amdhsa_user_sgpr_count 2
  .amdhsa_user_sgpr_kernarg_segment_ptr 1
  .amdhsa_system_sgpr_workgroup_id_x 1
.end_amdhsa_kernel
.p2align 6
.amdhsa_kernel il_attnA_kernel
  .amdhsa_next_free_vgpr 128
  .amdhsa_next_free_sgpr 64
  .amdhsa_accum_offset 128
  .amdhsa_group_segment_fixed_size 0
  .amdhsa_kernarg_size 88
  .amdhsa_user_sgpr_count 2
  .amdhsa_user_sgpr_kernarg_segment_ptr 1
  .amdhsa_system_sgpr_workgroup_id_x 1
.end_amdhsa_kernel
.p2align 6
.amdhsa_kernel il_opA0_kernel
  .amdhsa_next_free_vgpr 96
  .amdhsa_next_free_sgpr 64
  .amdhsa_accum_offset 96
  .amdhsa_group_segment_fixed_size 0
  .amdhsa_kernarg_size 88
  .amdhsa_user_sgpr_count 2
  .amdhsa_user_sgpr_kernarg_segment_ptr 1
  .amdhsa_system_sgpr_workgroup_id_x 1
.end_amdhsa_kernel
.p2align 6
.amdhsa_kernel il_qkvB0_kernel
  .amdhsa_next_free_vgpr 128
  .amdhsa_next_free_sgpr 64
  .amdhsa_accum_offset 128
  .amdhsa_group_segment_fixed_size 0
  .amdhsa_kernarg_size 88
  .amdhsa_user_sgpr_count 2
  .amdhsa_user_sgpr_kernarg_segment_ptr 1
  .amdhsa_system_sgpr_workgroup_id_x 1
.end_amdhsa_kernel
.p2align 6
.amdhsa_kernel il_attnB_kernel
  .amdhsa_next_free_vgpr 128
  .amdhsa_next_free_sgpr 64
  .amdhsa_accum_offset 128
  .amdhsa_group_segment_fixed_size 0
  .amdhsa_kernarg_size 88
  .amdhsa_user_sgpr_count 2
  .amdhsa_user_sgpr_kernarg_segment_ptr 1
  .amdhsa_system_sgpr_workgroup_id_x 1
.end_amdhsa_kernel
.p2align 6
.amdhsa_kernel il_opB0_kernel
  .amdhsa_next_free_vgpr 96
  .amdhsa_next_free_sgpr 64
  .amdhsa_accum_offset 96
  .amdhsa_group_segment_fixed_size 0
  .amdhsa_kernarg_size 88
  .amdhsa_user_sgpr_count 2
  .amdhsa_user_sgpr_kernarg_segment_ptr 1
  .amdhsa_system_sgpr_workgroup_id_x 1
.end_amdhsa_kernel
.p2align 6
.amdhsa_kernel il_qkvA1_kernel
  .amdhsa_next_free_vgpr 96
  .amdhsa_next_free_sgpr 64
  .amdhsa_accum_offset 96
  .amdhsa_group_segment_fixed_size 0
  .amdhsa_kernarg_size 88
  .amdhsa_user_sgpr_count 2
  .amdhsa_user_sgpr_kernarg_segment_ptr 1
  .amdhsa_system_sgpr_workgroup_id_x 1
.end_amdhsa_kernel
.p2align 6
.amdhsa_kernel il_opA1_kernel
  .amdhsa_next_free_vgpr 96
  .amdhsa_next_free_sgpr 64
  .amdhsa_accum_offset 96
  .amdhsa_group_segment_fixed_size 0
  .amdhsa_kernarg_size 88
  .amdhsa_user_sgpr_count 2
  .amdhsa_user_sgpr_kernarg_segment_ptr 1
  .amdhsa_system_sgpr_workgroup_id_x 1
.end_amdhsa_kernel
.p2align 6
.amdhsa_kernel il_qkvB1_kernel
  .amdhsa_next_free_vgpr 128
  .amdhsa_next_free_sgpr 64
  .amdhsa_accum_offset 128
  .amdhsa_group_segment_fixed_size 0
  .amdhsa_kernarg_size 88
  .amdhsa_user_sgpr_count 2
  .amdhsa_user_sgpr_kernarg_segment_ptr 1
  .amdhsa_system_sgpr_workgroup_id_x 1
.end_amdhsa_kernel
.p2align 6
.amdhsa_kernel il_opB1_kernel
  .amdhsa_next_free_vgpr 96
  .amdhsa_next_free_sgpr 64
  .amdhsa_accum_offset 96
  .amdhsa_group_segment_fixed_size 0
  .amdhsa_kernarg_size 88
  .amdhsa_user_sgpr_count 2
  .amdhsa_user_sgpr_kernarg_segment_ptr 1
  .amdhsa_system_sgpr_workgroup_id_x 1
.end_amdhsa_kernel
```
